```python
import torch

def _softmax(x, axis=-1):
    return torch.softmax(x, dim=axis)
def _gelu(x):
    return torch.nn.functional.gelu(x, approximate="tanh")
def _silu(x):
    return torch.nn.functional.silu(x)
def _sigmoid(x):
    return torch.sigmoid(x)
def _layernorm(x, axis=-1, eps=1e-5):
    m = x.mean(dim=axis, keepdim=True)
    v = x.var(dim=axis, keepdim=True, unbiased=False)
    return (x - m) / torch.sqrt(v + eps)
def _scatter_add(tgt, idx, src, axis=0):
    return tgt.clone().index_add_(axis, idx, src)
def _segment_sum(src, seg, n):
    out = torch.zeros((n,) + src.shape[1:], dtype=src.dtype)
    return out.index_add_(0, seg, src)
def _pad(x, pw):
    flat = tuple(v for pair in reversed(pw) for v in pair)
    return torch.nn.functional.pad(x, flat)

kernel_name = 'concat_heads__linear_kernel_hedgehog__ssm_conv_s4d__prompt'

def setup_inputs():

    _w = (lambda a: (lambda t: t.to(torch.bfloat16) if t.is_floating_point() else t)(torch.as_tensor(a)))
    def _A_setup():
        B, S, D, H = 1, 2048, 640, 32
        Dh = D // H
        return {
            "x": _w((lambda *s: torch.randn(*s, dtype=torch.bfloat16) * 0.4)(B, S, D)),
            "wqkv": _w((lambda *s: torch.randn(*s, dtype=torch.bfloat16) * 0.4)(D, 3 * D)),
            "w_phi": _w((lambda *s: torch.randn(*s, dtype=torch.bfloat16) * 0.4)(H, Dh, Dh) * (Dh ** -0.5)),
            "wo": _w((lambda *s: torch.randn(*s, dtype=torch.bfloat16) * 0.05)(D, D)),
        }
    _A_in = _A_setup()

    def _B_setup():
        Bsz, L, D, N = 1, 2048, 640, 128
        return {
            "u": _w((lambda *s: torch.randn(*s, dtype=torch.bfloat16) * 0.05)(Bsz, L, D)),
            "log_A_real": _w((lambda *s: torch.randn(*s, dtype=torch.bfloat16) * 3.2)(D, N) * 0.5),
            "A_imag": _w((lambda *s: torch.randn(*s, dtype=torch.bfloat16) * 0.2)(D, N) * 3.14),
            "C_real": _w((lambda *s: torch.randn(*s, dtype=torch.bfloat16) * 3.2)(D, N) / N ** 0.5),
            "C_imag": _w((lambda *s: torch.randn(*s, dtype=torch.bfloat16) * 3.2)(D, N) / N ** 0.5),
            "log_dt": _w((lambda *s: torch.randn(*s, dtype=torch.bfloat16) * 0.2)(D) * 0.5 - 4.0),
            "D_skip": _w((lambda *s: torch.randn(*s, dtype=torch.bfloat16) * 0.4)(D)),
        }
    _B_in = _B_setup()

    return {
        "A_x": _A_in["x"],
        "A_wqkv": _A_in["wqkv"],
        "A_w_phi": _A_in["w_phi"],
        "A_wo": _A_in["wo"],
        "B_u": _B_in["u"],
        "B_log_A_real": _B_in["log_A_real"],
        "B_A_imag": _B_in["A_imag"],
        "B_C_real": _B_in["C_real"],
        "B_C_imag": _B_in["C_imag"],
        "B_log_dt": _B_in["log_dt"],
        "B_D_skip": _B_in["D_skip"],
    }

def reference(A_x, A_wqkv, A_w_phi, A_wo, B_u, B_log_A_real, B_A_imag, B_C_real, B_C_imag, B_log_dt, B_D_skip):
    def _A_ref(x, wqkv, w_phi, wo):
        B, S, D = x.shape
        H = 32; Dh = D // H
        qkv = (lambda x, *d: x.permute(*d))((x @ wqkv).reshape(B, S, 3, H, Dh), 2, 0, 3, 1, 4)
        q, k, v = qkv[0], qkv[1], qkv[2]
        pq = torch.einsum("bhsd,hdf->bhsf", q, w_phi)
        pk = torch.einsum("bhsd,hdf->bhsf", k, w_phi)
        phi_q = torch.concatenate([_softmax(pq, axis=-1), _softmax(-pq, axis=-1)], axis=-1)
        phi_k = torch.concatenate([_softmax(pk, axis=-1), _softmax(-pk, axis=-1)], axis=-1)
        kv = torch.einsum("bhsf,bhsd->bhfd", phi_k, v)
        z  = torch.einsum("bhsf->bhf", phi_k)
        num = torch.einsum("bhqf,bhfd->bhqd", phi_q, kv)
        den = torch.einsum("bhqf,bhf->bhq", phi_q, z)[..., None] + 1e-6
        o = num / den
        return (lambda x, *d: x.permute(*d))(o, 0, 2, 1, 3).reshape(B, S, D) @ wo

    def _B_ref(u, log_A_real, A_imag, C_real, C_imag, log_dt, D_skip):
        L = u.shape[1]
        dt = torch.exp(log_dt)
        A = -torch.exp(log_A_real) + 1j * A_imag
        C = (C_real + 1j * C_imag) * dt[:, None]
        pos = (lambda x, dt: x.to(dt))(torch.arange(L), log_dt.dtype)
        P = torch.exp((A * dt[:, None])[:, :, None] * pos[None, None, :])
        K = 2.0 * torch.einsum("dn,dnl->dl", C, P).real
        L2 = 2 * L
        u_t = (lambda x, *d: x.permute(*d))(u, 0, 2, 1)
        Kf = (lambda x, *a, **k: torch.fft.rfft(x.float(), *a, **k))(K, L2)
        Uf = (lambda x, *a, **k: torch.fft.rfft(x.float(), *a, **k))(u_t, L2)
        y = (lambda x, *a, **k: torch.fft.irfft(x, *a, **k).to(torch.bfloat16))(Uf * Kf[None, :, :], L2)[:, :, :L]
        y = (lambda x, *d: x.permute(*d))(y, 0, 2, 1)
        return y + u * D_skip[None, None, :]

    a = _A_ref(A_x, A_wqkv, A_w_phi, A_wo)
    b = _B_ref(B_u, B_log_A_real, B_A_imag, B_C_real, B_C_imag, B_log_dt, B_D_skip)
    return torch.concatenate([a, b], axis=-1)
```

```asm
; @launch grid=(256,1,1) block=(256,1,1) lds=163840
.amdgcn_target "amdgcn-amd-amdhsa--gfx950"
.text
.globl concat_heads__linear_kernel_hedgehog__ssm_conv_s4d__prompt_kernel
.p2align 8
.type concat_heads__linear_kernel_hedgehog__ssm_conv_s4d__prompt_kernel,@function
concat_heads__linear_kernel_hedgehog__ssm_conv_s4d__prompt_kernel:
  s_load_dwordx2 s[44:45], s[0:1], 0
  s_load_dwordx2 s[48:49], s[0:1], 8
  s_load_dwordx16 s[16:31], s[0:1], 0
  s_load_dwordx8 s[32:39], s[0:1], 64
  s_load_dwordx4 s[40:43], s[0:1], 96
  s_cmp_ge_u32 s2, 256
  s_cbranch_scc1 L_end
  v_lshrrev_b32 v1, 6, v0
  v_and_b32 v0, 63, v0
  v_readfirstlane_b32 s4, v1
  s_and_b32 s8, s2, 7
  s_lshr_b32 s9, s2, 3
  s_lshr_b32 s5, s8, 1
  s_lshl_b32 s5, s5, 2
  s_and_b32 s10, s9, 3
  s_add_u32 s5, s5, s10
  s_and_b32 s10, s8, 1
  s_lshl_b32 s10, s10, 2
  s_bfe_u32 s3, s9, 0x20002
  s_add_u32 s10, s10, s3
  s_getpc_b64 s[6:7]
L_pc:
  s_lshl_b32 s3, s9, 2
  s_add_u32 s3, s3, s4
  s_mul_i32 s3, s3, 384
  v_and_b32 v1, 3, v0
  v_lshl_add_u32 v1, v1, 7, s3
  v_min_u32 v1, TABLES+3712-L_pc, v1
  global_load_dword v23, v1, s[6:7]
  s_cmp_ge_u32 s9, 16
  s_cbranch_scc1 L_notA
  s_mov_b32 s46, 2621440
  s_mov_b32 s47, 0x20000
  v_lshrrev_b32 v19, 3, v0
  v_and_b32 v20, 7, v0
  v_lshrrev_b32 v21, 4, v0
  v_xor_b32 v22, v20, v21
  v_mul_u32_u24 v19, 1280, v19
  v_lshl_add_u32 v1, v22, 4, v19
  v_xor_b32 v2, 64, v1
  v_add_u32 v2, 9216, v2
  v_add_u32 v3, 18432, v1
  v_add_u32 v4, 18432, v2
  s_lshl_b32 s70, s5, 2
  s_add_u32 s70, s70, s4
  s_mul_i32 s68, s70, 40960
  s_and_b32 s8, s4, 1
  s_mul_i32 s8, s8, 122880
  s_mul_i32 s71, s10, 160
  s_add_u32 s8, s8, s71
  s_lshr_b32 s70, s4, 1
  s_mul_i32 s69, s70, 1280
  s_add_u32 s69, s69, s8
  s_add_u32 s69, s69, 1280
  s_mul_i32 s63, s70, 245760
  s_add_u32 s63, s63, s8
  s_lshl_b32 s15, s4, 14
  s_mul_i32 s3, s4, 5120
  s_mov_b32 s50, 2457600
  s_mov_b32 s51, 0x20000
  s_add_u32 m0, s15, 0
  s_add_u32 s7, s68, 0
  v_add_u32 v19, 0, v0
  v_mul_u32_u24 v20, 6554, v19
  v_lshrrev_b32 v20, 16, v20
  v_mul_u32_u24 v21, 3680, v20
  v_lshl_add_u32 v5, v19, 4, v21
  v_bfe_u32 v19, v20, 2, 1
  v_bfe_u32 v20, v20, 3, 1
  v_sub_u32 v19, v19, v20
  v_mul_i32_i24 v19, 15360, v19
  v_add_u32 v5, v5, v19
  v_add_u32 v19, 64, v0
  v_mul_u32_u24 v20, 6554, v19
  v_lshrrev_b32 v20, 16, v20
  v_mul_u32_u24 v21, 3680, v20
  v_lshl_add_u32 v6, v0, 4, v21
  v_bfe_u32 v19, v20, 2, 1
  v_bfe_u32 v20, v20, 3, 1
  v_sub_u32 v19, v19, v20
  v_mul_i32_i24 v19, 15360, v19
  v_add_u32 v6, v6, v19
  s_waitcnt lgkmcnt(0)
  buffer_load_dwordx4 v1, s[44:47], s7 offen offset:0 lds
  buffer_load_dwordx4 v2, s[44:47], s7 offen offset:1024 lds
  buffer_load_dwordx4 v3, s[44:47], s7 offen offset:2048 lds
  buffer_load_dwordx4 v4, s[44:47], s7 offen offset:3072 lds
  s_add_u32 m0, s3, 108544
  s_add_u32 s7, s69, 0
  buffer_load_dwordx4 v5, s[48:51], s7 offen offset:0 lds
  buffer_load_dwordx4 v6, s[48:51], s7 offen offset:1024 lds
  v_add_u32 v19, 128, v0
  v_mul_u32_u24 v20, 6554, v19
  v_lshrrev_b32 v20, 16, v20
  v_mul_u32_u24 v21, 3680, v20
  v_lshl_add_u32 v7, v0, 4, v21
  v_bfe_u32 v19, v20, 2, 1
  v_bfe_u32 v20, v20, 3, 1
  v_sub_u32 v19, v19, v20
  v_mul_i32_i24 v19, 15360, v19
  v_add_u32 v7, v7, v19
  buffer_load_dwordx4 v7, s[48:51], s7 offen offset:2048 lds
  v_add_u32 v19, 192, v0
  v_mul_u32_u24 v20, 6554, v19
  v_lshrrev_b32 v20, 16, v20
  v_mul_u32_u24 v21, 3680, v20
  v_lshl_add_u32 v8, v0, 4, v21
  v_bfe_u32 v19, v20, 2, 1
  v_bfe_u32 v20, v20, 3, 1
  v_sub_u32 v19, v19, v20
  v_mul_i32_i24 v19, 15360, v19
  v_add_u32 v8, v8, v19
  buffer_load_dwordx4 v8, s[48:51], s7 offen offset:3072 lds
  s_addk_i32 m0, 0x1000
  v_add_u32 v19, 256, v0
  v_mul_u32_u24 v20, 6554, v19
  v_lshrrev_b32 v20, 16, v20
  v_mul_u32_u24 v21, 3680, v20
  v_lshl_add_u32 v9, v19, 4, v21
  v_bfe_u32 v19, v20, 2, 1
  v_bfe_u32 v20, v20, 3, 1
  v_sub_u32 v19, v19, v20
  v_mul_i32_i24 v19, 15360, v19
  v_add_u32 v9, v9, v19
  buffer_load_dwordx4 v9, s[48:51], s7 offen offset:0 lds
  s_mov_b32 s32, s20
  s_add_u32 m0, s15, 4096
  s_add_u32 s7, s68, 128
  s_mov_b32 s33, s21
  s_mov_b32 s34, 25600
  s_mov_b32 s35, 0x20000
  s_mov_b32 s52, s42
  s_mov_b32 s53, s43
  s_mov_b32 s54, 268435456
  s_mov_b32 s55, 0x20000
  s_mov_b32 s56, s38
  s_mov_b32 s57, s39
  s_mov_b32 s58, 5242880
  s_mov_b32 s59, 0x20000
  s_mov_b32 s64, s22
  s_mov_b32 s65, s23
  s_mov_b32 s66, 819200
  s_mov_b32 s67, 0x20000
  v_mov_b32 v20, 0
  buffer_load_dword v29, v20, s[52:55], 0 offen sc1
  s_mul_i32 s6, s4, 40960
  s_add_u32 s6, s6, s71
  v_lshlrev_b32 v19, 4, v0
  buffer_load_dwordx4 v1, s[44:47], s7 offen offset:0 lds
  v_mov_b32 v112, 0
  v_mov_b32 v113, 0
  v_mov_b32 v114, 0
  v_mov_b32 v115, 0
  v_add_u32 v20, 153600, v19
  ds_write_b128 v20, v[112:115]
  v_and_b32 v19, 15, v0
  v_lshrrev_b32 v20, 4, v0
  v_lshrrev_b32 v21, 1, v19
  v_xor_b32 v21, v21, v20
  v_lshlrev_b32 v22, 7, v19
  buffer_load_dwordx4 v2, s[44:47], s7 offen offset:1024 lds
  v_add_u32 v22, s15, v22
  v_lshl_add_u32 v10, v21, 4, v22
  v_xor_b32 v11, 64, v10
  s_mul_i32 s70, s4, 16896
  v_mul_u32_u24 v15, 528, v19
  v_add_u32 v15, s70, v15
  v_mul_u32_u24 v22, 48, v20
  v_add_u32 v27, v15, v22
  v_mul_u32_u24 v22, 80, v20
  v_add_u32 v15, v15, v22
  v_bfe_u32 v21, v0, 2, 2
  buffer_load_dwordx4 v3, s[44:47], s7 offen offset:2048 lds
  v_and_b32 v22, 3, v0
  v_and_b32 v18, 1, v20
  v_lshl_add_u32 v17, v18, 2, v21
  v_lshrrev_b32 v25, 1, v20
  v_lshl_add_u32 v18, v25, 4, v17
  v_lshl_add_u32 v17, v25, 3, v17
  v_mul_u32_u24 v18, 160, v18
  v_mul_u32_u24 v25, 40, v22
  v_add_u32 v18, v18, v25
  v_add_u32 v12, 47104, v18
  v_add_u32 v13, 108544, v18
  buffer_load_dwordx4 v4, s[44:47], s7 offen offset:3072 lds
  s_add_u32 m0, s3, 129024
  s_add_u32 s7, s69, 245760
  v_mul_u32_u24 v18, 800, v22
  v_mul_u32_u24 v25, 40, v21
  v_add_u32 v18, v18, v25
  v_add_u32 v18, 149504, v18
  v_mov_b32 v14, 153600
  v_cmp_eq_u32 vcc, v22, v20
  v_mul_u32_u24 v17, 1056, v17
  v_lshl_add_u32 v17, v22, 3, v17
  v_cndmask_b32 v14, v14, v18, vcc
  s_mul_i32 s70, s4, 48
  s_addk_i32 s70, 320
  v_add_u32 v16, s70, v17
  buffer_load_dwordx4 v5, s[48:51], s7 offen offset:0 lds
  s_mul_i32 s70, s4, 80
  v_add_u32 v17, s70, v17
  v_min_u32 v25, 1, v22
  v_sub_u32 v25, v25, v22
  v_lshl_add_u32 v30, v25, 3, v16
  v_lshl_add_u32 v31, v25, 3, v17
  s_lshl_b32 s70, s10, 2
  s_add_u32 s70, s70, s4
  s_mul_i32 s70, s70, 4096
  s_add_u32 s70, s70, 65536
  v_lshlrev_b32 v18, 2, v0
  v_add_u32 v18, s70, v18
  v_lshrrev_b32 v21, 2, v19
  buffer_load_dwordx4 v6, s[48:51], s7 offen offset:1024 lds
  v_mul_u32_u24 v25, 2304, v21
  v_mul_u32_u24 v22, 96, v22
  v_add_u32 v25, v25, v22
  v_add_u32 v25, 154624, v25
  v_cmp_eq_u32 vcc, v21, v20
  v_mov_b32 v22, -1
  s_mov_b32 s12, 0x3fb8aa3b
  s_mov_b32 s13, 0x3fb8aa3b
  v_cndmask_b32 v25, v22, v25, vcc
  v_mov_b32 v28, 0x3f80
  v_add_u32 v19, 0, v0
  buffer_load_dwordx4 v7, s[48:51], s7 offen offset:2048 lds
  v_mul_u32_u24 v20, 6554, v19
  v_lshrrev_b32 v20, 16, v20
  v_mul_u32_u24 v21, 1120, v20
  v_lshl_add_u32 v252, v19, 4, v21
  v_add_u32 v19, 64, v0
  v_mul_u32_u24 v20, 6554, v19
  v_lshrrev_b32 v20, 16, v20
  v_mul_u32_u24 v21, 1120, v20
  v_lshl_add_u32 v253, v0, 4, v21
  v_add_u32 v19, 128, v0
  v_mul_u32_u24 v20, 6554, v19
  buffer_load_dwordx4 v8, s[48:51], s7 offen offset:3072 lds
  s_addk_i32 m0, 0x1000
  v_lshrrev_b32 v20, 16, v20
  v_mul_u32_u24 v21, 1120, v20
  v_lshl_add_u32 v254, v0, 4, v21
  v_add_u32 v19, 192, v0
  v_mul_u32_u24 v20, 6554, v19
  v_lshrrev_b32 v20, 16, v20
  v_mul_u32_u24 v21, 1120, v20
  v_lshl_add_u32 v255, v0, 4, v21
  v_add_u32 v19, 256, v0
  v_mul_u32_u24 v20, 6554, v19
  v_lshrrev_b32 v20, 16, v20
  buffer_load_dwordx4 v9, s[48:51], s7 offen offset:0 lds
  v_mul_u32_u24 v21, 1120, v20
  v_lshl_add_u32 v26, v19, 4, v21
  v_lshlrev_b32 v19, 4, v0
  s_mul_i32 s70, s10, 3200
  s_lshl_b32 s71, s4, 10
  s_add_u32 s70, s70, s71
  s_add_u32 m0, s71, 149504
  s_nop 0
  buffer_load_dwordx4 v19, s[32:35], s70 offen lds
  s_getpc_b64 s[34:35]
A_pc:
  s_add_u32 s34, s34, TABLE_A-A_pc
  s_addc_u32 s35, s35, 0
  s_waitcnt vmcnt(11)
  s_waitcnt lgkmcnt(0)
  s_barrier
  ds_read_b128 a[0:3], v10 offset:0
  ds_read_b128 a[4:7], v10 offset:2048
  ds_read_b64_tr_b16 v[112:113], v13 offset:0
  ds_read_b64_tr_b16 v[114:115], v13 offset:1280
  ds_read_b64_tr_b16 v[116:117], v13 offset:8
  ds_read_b64_tr_b16 v[118:119], v13 offset:1288
  ds_read_b64_tr_b16 v[120:121], v13 offset:16
  ds_read_b64_tr_b16 v[122:123], v13 offset:1296
  ds_read_b64_tr_b16 v[124:125], v13 offset:24
  ds_read_b64_tr_b16 v[126:127], v13 offset:1304
  ds_read_b64_tr_b16 v[128:129], v13 offset:32
  ds_read_b64_tr_b16 v[130:131], v13 offset:1312
  ds_read_b64_tr_b16 v[132:133], v13 offset:10240
  ds_read_b64_tr_b16 v[134:135], v13 offset:11520
  ds_read_b64_tr_b16 v[136:137], v13 offset:10248
  ds_read_b64_tr_b16 v[138:139], v13 offset:11528
  ds_read_b64_tr_b16 v[140:141], v13 offset:10256
  ds_read_b64_tr_b16 v[142:143], v13 offset:11536
  ds_read_b64_tr_b16 v[144:145], v13 offset:10264
  ds_read_b64_tr_b16 v[146:147], v13 offset:11544
  ds_read_b64_tr_b16 v[148:149], v13 offset:10272
  ds_read_b64_tr_b16 v[150:151], v13 offset:11552
  s_waitcnt lgkmcnt(15)
  v_mfma_f32_16x16x32_bf16 v[32:35], v[112:115], a[0:3], 0
  ds_read_b128 a[8:11], v11 offset:0
  ds_read_b128 a[12:15], v11 offset:2048
  s_add_u32 m0, s15, 8192
  s_add_u32 s7, s68, 256
  v_mfma_f32_16x16x32_bf16 v[52:55], v[112:115], a[4:7], 0
  ds_read_b64_tr_b16 v[152:153], v13 offset:5120
  ds_read_b64_tr_b16 v[154:155], v13 offset:6400
  v_mfma_f32_16x16x32_bf16 v[36:39], v[116:119], a[0:3], 0
  ds_read_b64_tr_b16 v[156:157], v13 offset:5128
  buffer_load_dwordx4 v1, s[44:47], s7 offen offset:0 lds
  v_mfma_f32_16x16x32_bf16 v[56:59], v[116:119], a[4:7], 0
  ds_read_b64_tr_b16 v[158:159], v13 offset:6408
  s_waitcnt lgkmcnt(15)
  v_mfma_f32_16x16x32_bf16 v[40:43], v[120:123], a[0:3], 0
  ds_read_b64_tr_b16 v[160:161], v13 offset:5136
  buffer_load_dwordx4 v2, s[44:47], s7 offen offset:1024 lds
  v_mfma_f32_16x16x32_bf16 v[60:63], v[120:123], a[4:7], 0
  ds_read_b64_tr_b16 v[162:163], v13 offset:6416
  v_mfma_f32_16x16x32_bf16 v[44:47], v[124:127], a[0:3], 0
  ds_read_b64_tr_b16 v[164:165], v13 offset:5144
  buffer_load_dwordx4 v3, s[44:47], s7 offen offset:2048 lds
  v_mfma_f32_16x16x32_bf16 v[64:67], v[124:127], a[4:7], 0
  ds_read_b64_tr_b16 v[166:167], v13 offset:6424
  v_mfma_f32_16x16x32_bf16 v[48:51], v[128:131], a[0:3], 0
  ds_read_b64_tr_b16 v[168:169], v13 offset:5152
  buffer_load_dwordx4 v4, s[44:47], s7 offen offset:3072 lds
  s_add_u32 m0, s3, 67584
  s_add_u32 s7, s69, 491520
  v_mfma_f32_16x16x32_bf16 v[68:71], v[128:131], a[4:7], 0
  ds_read_b64_tr_b16 v[170:171], v13 offset:6432
  s_waitcnt lgkmcnt(15)
  v_mfma_f32_16x16x32_bf16 v[72:75], v[132:135], a[0:3], 0
  ds_read_b64_tr_b16 v[172:173], v13 offset:15360
  buffer_load_dwordx4 v5, s[48:51], s7 offen offset:0 lds
  v_mfma_f32_16x16x32_bf16 v[92:95], v[132:135], a[4:7], 0
  ds_read_b64_tr_b16 v[174:175], v13 offset:16640
  v_mfma_f32_16x16x32_bf16 v[76:79], v[136:139], a[0:3], 0
  ds_read_b64_tr_b16 v[176:177], v13 offset:15368
  v_mfma_f32_16x16x32_bf16 v[96:99], v[136:139], a[4:7], 0
  ds_read_b64_tr_b16 v[178:179], v13 offset:16648
  buffer_load_dwordx4 v6, s[48:51], s7 offen offset:1024 lds
  v_mfma_f32_16x16x32_bf16 v[80:83], v[140:143], a[0:3], 0
  ds_read_b64_tr_b16 v[180:181], v13 offset:15376
  v_mfma_f32_16x16x32_bf16 v[100:103], v[140:143], a[4:7], 0
  ds_read_b64_tr_b16 v[182:183], v13 offset:16656
  buffer_load_dwordx4 v7, s[48:51], s7 offen offset:2048 lds
  s_waitcnt lgkmcnt(15)
  v_mfma_f32_16x16x32_bf16 v[84:87], v[144:147], a[0:3], 0
  ds_read_b64_tr_b16 v[184:185], v13 offset:15384
  v_mfma_f32_16x16x32_bf16 v[104:107], v[144:147], a[4:7], 0
  ds_read_b64_tr_b16 v[186:187], v13 offset:16664
  buffer_load_dwordx4 v8, s[48:51], s7 offen offset:3072 lds
  s_addk_i32 m0, 0x1000
  v_mfma_f32_16x16x32_bf16 v[88:91], v[148:151], a[0:3], 0
  ds_read_b64_tr_b16 v[188:189], v13 offset:15392
  v_mfma_f32_16x16x32_bf16 v[108:111], v[148:151], a[4:7], 0
  ds_read_b64_tr_b16 v[190:191], v13 offset:16672
  buffer_load_dwordx4 v9, s[48:51], s7 offen offset:0 lds
  s_waitcnt lgkmcnt(15)
  v_mfma_f32_16x16x32_bf16 v[32:35], v[152:155], a[8:11], v[32:35]
  v_mfma_f32_16x16x32_bf16 v[52:55], v[152:155], a[12:15], v[52:55]
  s_waitcnt vmcnt(10)
  s_barrier
  v_mfma_f32_16x16x32_bf16 v[36:39], v[156:159], a[8:11], v[36:39]
  ds_read_b128 a[16:19], v10 offset:4096
  ds_read_b128 a[20:23], v10 offset:6144
  s_add_u32 m0, s15, 12288
  s_add_u32 s7, s68, 384
  v_mfma_f32_16x16x32_bf16 v[56:59], v[156:159], a[12:15], v[56:59]
  ds_read_b64_tr_b16 v[112:113], v13 offset:20480
  ds_read_b64_tr_b16 v[114:115], v13 offset:21760
  s_waitcnt lgkmcnt(15)
  v_mfma_f32_16x16x32_bf16 v[40:43], v[160:163], a[8:11], v[40:43]
  ds_read_b64_tr_b16 v[116:117], v13 offset:20488
  ds_read_b64_tr_b16 v[118:119], v13 offset:21768
  v_mfma_f32_16x16x32_bf16 v[60:63], v[160:163], a[12:15], v[60:63]
  ds_read_b64_tr_b16 v[120:121], v13 offset:20496
  ds_read_b64_tr_b16 v[122:123], v13 offset:21776
  buffer_load_dwordx4 v1, s[44:47], s7 offen offset:0 lds
  v_mfma_f32_16x16x32_bf16 v[44:47], v[164:167], a[8:11], v[44:47]
  ds_read_b64_tr_b16 v[124:125], v13 offset:20504
  v_mfma_f32_16x16x32_bf16 v[64:67], v[164:167], a[12:15], v[64:67]
  ds_read_b64_tr_b16 v[126:127], v13 offset:21784
  s_waitcnt lgkmcnt(15)
  v_mfma_f32_16x16x32_bf16 v[48:51], v[168:171], a[8:11], v[48:51]
  ds_read_b64_tr_b16 v[128:129], v13 offset:20512
  v_mfma_f32_16x16x32_bf16 v[68:71], v[168:171], a[12:15], v[68:71]
  ds_read_b64_tr_b16 v[130:131], v13 offset:21792
  buffer_load_dwordx4 v2, s[44:47], s7 offen offset:1024 lds
  v_mfma_f32_16x16x32_bf16 v[72:75], v[172:175], a[8:11], v[72:75]
  ds_read_b64_tr_b16 v[132:133], v13 offset:30720
  v_mfma_f32_16x16x32_bf16 v[92:95], v[172:175], a[12:15], v[92:95]
  ds_read_b64_tr_b16 v[134:135], v13 offset:32000
  v_mfma_f32_16x16x32_bf16 v[76:79], v[176:179], a[8:11], v[76:79]
  ds_read_b64_tr_b16 v[136:137], v13 offset:30728
  v_mfma_f32_16x16x32_bf16 v[96:99], v[176:179], a[12:15], v[96:99]
  ds_read_b64_tr_b16 v[138:139], v13 offset:32008
  s_waitcnt lgkmcnt(15)
  v_mfma_f32_16x16x32_bf16 v[80:83], v[180:183], a[8:11], v[80:83]
  ds_read_b64_tr_b16 v[140:141], v13 offset:30736
  buffer_load_dwordx4 v3, s[44:47], s7 offen offset:2048 lds
  v_mfma_f32_16x16x32_bf16 v[100:103], v[180:183], a[12:15], v[100:103]
  ds_read_b64_tr_b16 v[142:143], v13 offset:32016
  v_mfma_f32_16x16x32_bf16 v[84:87], v[184:187], a[8:11], v[84:87]
  ds_read_b64_tr_b16 v[144:145], v13 offset:30744
  v_mfma_f32_16x16x32_bf16 v[104:107], v[184:187], a[12:15], v[104:107]
  ds_read_b64_tr_b16 v[146:147], v13 offset:32024
  buffer_load_dwordx4 v4, s[44:47], s7 offen offset:3072 lds
  s_add_u32 m0, s3, 88064
  s_add_u32 s7, s69, 737280
  v_mfma_f32_16x16x32_bf16 v[88:91], v[188:191], a[8:11], v[88:91]
  ds_read_b64_tr_b16 v[148:149], v13 offset:30752
  v_mfma_f32_16x16x32_bf16 v[108:111], v[188:191], a[12:15], v[108:111]
  ds_read_b64_tr_b16 v[150:151], v13 offset:32032
  s_waitcnt lgkmcnt(15)
  v_mfma_f32_16x16x32_bf16 v[32:35], v[112:115], a[16:19], v[32:35]
  ds_read_b128 a[24:27], v11 offset:4096
  ds_read_b128 a[28:31], v11 offset:6144
  v_mfma_f32_16x16x32_bf16 v[52:55], v[112:115], a[20:23], v[52:55]
  ds_read_b64_tr_b16 v[152:153], v13 offset:25600
  ds_read_b64_tr_b16 v[154:155], v13 offset:26880
  buffer_load_dwordx4 v5, s[48:51], s7 offen offset:0 lds
  v_mfma_f32_16x16x32_bf16 v[36:39], v[116:119], a[16:19], v[36:39]
  ds_read_b64_tr_b16 v[156:157], v13 offset:25608
  v_mfma_f32_16x16x32_bf16 v[56:59], v[116:119], a[20:23], v[56:59]
  ds_read_b64_tr_b16 v[158:159], v13 offset:26888
  s_waitcnt lgkmcnt(15)
  v_mfma_f32_16x16x32_bf16 v[40:43], v[120:123], a[16:19], v[40:43]
  ds_read_b64_tr_b16 v[160:161], v13 offset:25616
  v_mfma_f32_16x16x32_bf16 v[60:63], v[120:123], a[20:23], v[60:63]
  ds_read_b64_tr_b16 v[162:163], v13 offset:26896
  v_mfma_f32_16x16x32_bf16 v[44:47], v[124:127], a[16:19], v[44:47]
  ds_read_b64_tr_b16 v[164:165], v13 offset:25624
  buffer_load_dwordx4 v6, s[48:51], s7 offen offset:1024 lds
  v_mfma_f32_16x16x32_bf16 v[64:67], v[124:127], a[20:23], v[64:67]
  ds_read_b64_tr_b16 v[166:167], v13 offset:26904
  v_mfma_f32_16x16x32_bf16 v[48:51], v[128:131], a[16:19], v[48:51]
  ds_read_b64_tr_b16 v[168:169], v13 offset:25632
  v_mfma_f32_16x16x32_bf16 v[68:71], v[128:131], a[20:23], v[68:71]
  ds_read_b64_tr_b16 v[170:171], v13 offset:26912
  buffer_load_dwordx4 v7, s[48:51], s7 offen offset:2048 lds
  s_waitcnt lgkmcnt(15)
  v_mfma_f32_16x16x32_bf16 v[72:75], v[132:135], a[16:19], v[72:75]
  ds_read_b64_tr_b16 v[172:173], v13 offset:35840
  v_mfma_f32_16x16x32_bf16 v[92:95], v[132:135], a[20:23], v[92:95]
  ds_read_b64_tr_b16 v[174:175], v13 offset:37120
  v_mfma_f32_16x16x32_bf16 v[76:79], v[136:139], a[16:19], v[76:79]
  ds_read_b64_tr_b16 v[176:177], v13 offset:35848
  v_mfma_f32_16x16x32_bf16 v[96:99], v[136:139], a[20:23], v[96:99]
  ds_read_b64_tr_b16 v[178:179], v13 offset:37128
  buffer_load_dwordx4 v8, s[48:51], s7 offen offset:3072 lds
  s_addk_i32 m0, 0x1000
  v_mfma_f32_16x16x32_bf16 v[80:83], v[140:143], a[16:19], v[80:83]
  ds_read_b64_tr_b16 v[180:181], v13 offset:35856
  v_mfma_f32_16x16x32_bf16 v[100:103], v[140:143], a[20:23], v[100:103]
  ds_read_b64_tr_b16 v[182:183], v13 offset:37136
  s_waitcnt lgkmcnt(15)
  v_mfma_f32_16x16x32_bf16 v[84:87], v[144:147], a[16:19], v[84:87]
  ds_read_b64_tr_b16 v[184:185], v13 offset:35864
  v_mfma_f32_16x16x32_bf16 v[104:107], v[144:147], a[20:23], v[104:107]
  ds_read_b64_tr_b16 v[186:187], v13 offset:37144
  buffer_load_dwordx4 v9, s[48:51], s7 offen offset:0 lds
  v_mfma_f32_16x16x32_bf16 v[88:91], v[148:151], a[16:19], v[88:91]
  ds_read_b64_tr_b16 v[188:189], v13 offset:35872
  v_mfma_f32_16x16x32_bf16 v[108:111], v[148:151], a[20:23], v[108:111]
  ds_read_b64_tr_b16 v[190:191], v13 offset:37152
  s_waitcnt lgkmcnt(15)
  v_mfma_f32_16x16x32_bf16 v[32:35], v[152:155], a[24:27], v[32:35]
  v_mfma_f32_16x16x32_bf16 v[52:55], v[152:155], a[28:31], v[52:55]
  s_waitcnt vmcnt(9)
  s_barrier
  v_mfma_f32_16x16x32_bf16 v[36:39], v[156:159], a[24:27], v[36:39]
  ds_read_b128 a[32:35], v10 offset:8192
  ds_read_b128 a[36:39], v10 offset:10240
  ds_read_b64_tr_b16 a[160:161], v14 offset:0
  v_mfma_f32_16x16x32_bf16 v[56:59], v[156:159], a[28:31], v[56:59]
  ds_read_b64_tr_b16 v[112:113], v12 offset:20480
  ds_read_b64_tr_b16 v[114:115], v12 offset:21760
  s_add_u32 m0, s15, 0
  s_add_u32 s7, s68, 512
  s_waitcnt lgkmcnt(15)
  v_mfma_f32_16x16x32_bf16 v[40:43], v[160:163], a[24:27], v[40:43]
  ds_read_b64_tr_b16 v[116:117], v12 offset:20488
  ds_read_b64_tr_b16 v[118:119], v12 offset:21768
  ds_read_b64_tr_b16 a[162:163], v14 offset:160
  v_mfma_f32_16x16x32_bf16 v[60:63], v[160:163], a[28:31], v[60:63]
  ds_read_b64_tr_b16 v[120:121], v12 offset:20496
  ds_read_b64_tr_b16 v[122:123], v12 offset:21776
  ds_read_b64_tr_b16 a[164:165], v14 offset:320
  v_mfma_f32_16x16x32_bf16 v[44:47], v[164:167], a[24:27], v[44:47]
  ds_read_b64_tr_b16 v[124:125], v12 offset:20504
  v_mfma_f32_16x16x32_bf16 v[64:67], v[164:167], a[28:31], v[64:67]
  ds_read_b64_tr_b16 v[126:127], v12 offset:21784
  buffer_load_dwordx4 v1, s[44:47], s7 offen offset:0 lds
  v_mfma_f32_16x16x32_bf16 v[48:51], v[168:171], a[24:27], v[48:51]
  ds_read_b64_tr_b16 v[128:129], v12 offset:20512
  ds_read_b64_tr_b16 a[166:167], v14 offset:480
  v_mfma_f32_16x16x32_bf16 v[68:71], v[168:171], a[28:31], v[68:71]
  ds_read_b64_tr_b16 v[130:131], v12 offset:21792
  buffer_load_dwordx4 v2, s[44:47], s7 offen offset:1024 lds
  s_waitcnt lgkmcnt(15)
  v_mfma_f32_16x16x32_bf16 v[72:75], v[172:175], a[24:27], v[72:75]
  ds_read_b64_tr_b16 v[132:133], v12 offset:30720
  v_mfma_f32_16x16x32_bf16 v[92:95], v[172:175], a[28:31], v[92:95]
  ds_read_b64_tr_b16 v[134:135], v12 offset:32000
  ds_read_b64_tr_b16 a[170:171], v14 offset:640
  v_mfma_f32_16x16x32_bf16 v[76:79], v[176:179], a[24:27], v[76:79]
  ds_read_b64_tr_b16 v[136:137], v12 offset:30728
  ds_read_b64_tr_b16 a[172:173], v14 offset:8
  v_mfma_f32_16x16x32_bf16 v[96:99], v[176:179], a[28:31], v[96:99]
  ds_read_b64_tr_b16 v[138:139], v12 offset:32008
  buffer_load_dwordx4 v3, s[44:47], s7 offen offset:2048 lds
  v_mfma_f32_16x16x32_bf16 v[80:83], v[180:183], a[24:27], v[80:83]
  ds_read_b64_tr_b16 v[140:141], v12 offset:30736
  v_mfma_f32_16x16x32_bf16 v[100:103], v[180:183], a[28:31], v[100:103]
  ds_read_b64_tr_b16 v[142:143], v12 offset:32016
  ds_read_b64_tr_b16 a[174:175], v14 offset:168
  v_mfma_f32_16x16x32_bf16 v[84:87], v[184:187], a[24:27], v[84:87]
  ds_read_b64_tr_b16 v[144:145], v12 offset:30744
  ds_read_b64_tr_b16 a[176:177], v14 offset:328
  v_mfma_f32_16x16x32_bf16 v[104:107], v[184:187], a[28:31], v[104:107]
  ds_read_b64_tr_b16 v[146:147], v12 offset:32024
  buffer_load_dwordx4 v4, s[44:47], s7 offen offset:3072 lds
  s_add_u32 m0, s3, 108544
  s_add_u32 s7, s69, 983040
  v_mfma_f32_16x16x32_bf16 v[88:91], v[188:191], a[24:27], v[88:91]
  ds_read_b64_tr_b16 v[148:149], v12 offset:30752
  v_mfma_f32_16x16x32_bf16 v[108:111], v[188:191], a[28:31], v[108:111]
  ds_read_b64_tr_b16 v[150:151], v12 offset:32032
  ds_read_b64_tr_b16 a[178:179], v14 offset:488
  s_waitcnt lgkmcnt(15)
  v_mfma_f32_16x16x32_bf16 v[32:35], v[112:115], a[32:35], v[32:35]
  ds_read_b128 a[40:43], v11 offset:8192
  ds_read_b128 a[44:47], v11 offset:10240
  ds_read_b64_tr_b16 a[182:183], v14 offset:648
  v_mfma_f32_16x16x32_bf16 v[52:55], v[112:115], a[36:39], v[52:55]
  ds_read_b64_tr_b16 v[152:153], v12 offset:25600
  ds_read_b64_tr_b16 v[154:155], v12 offset:26880
  buffer_load_dwordx4 v5, s[48:51], s7 offen offset:0 lds
  v_mfma_f32_16x16x32_bf16 v[36:39], v[116:119], a[32:35], v[36:39]
  ds_read_b64_tr_b16 v[156:157], v12 offset:25608
  v_mfma_f32_16x16x32_bf16 v[56:59], v[116:119], a[36:39], v[56:59]
  ds_read_b64_tr_b16 v[158:159], v12 offset:26888
  ds_read_b64_tr_b16 a[184:185], v14 offset:16
  v_mfma_f32_16x16x32_bf16 v[40:43], v[120:123], a[32:35], v[40:43]
  ds_read_b64_tr_b16 v[160:161], v12 offset:25616
  ds_read_b64_tr_b16 a[186:187], v14 offset:176
  v_mfma_f32_16x16x32_bf16 v[60:63], v[120:123], a[36:39], v[60:63]
  ds_read_b64_tr_b16 v[162:163], v12 offset:26896
  buffer_load_dwordx4 v6, s[48:51], s7 offen offset:1024 lds
  v_mfma_f32_16x16x32_bf16 v[44:47], v[124:127], a[32:35], v[44:47]
  ds_read_b64_tr_b16 v[164:165], v12 offset:25624
  v_mfma_f32_16x16x32_bf16 v[64:67], v[124:127], a[36:39], v[64:67]
  ds_read_b64_tr_b16 v[166:167], v12 offset:26904
  ds_read_b64_tr_b16 a[188:189], v14 offset:336
  v_mfma_f32_16x16x32_bf16 v[48:51], v[128:131], a[32:35], v[48:51]
  ds_read_b64_tr_b16 v[168:169], v12 offset:25632
  buffer_load_dwordx4 v7, s[48:51], s7 offen offset:2048 lds
  v_mfma_f32_16x16x32_bf16 v[68:71], v[128:131], a[36:39], v[68:71]
  ds_read_b64_tr_b16 v[170:171], v12 offset:26912
  s_waitcnt lgkmcnt(15)
  v_mfma_f32_16x16x32_bf16 v[72:75], v[132:135], a[32:35], v[72:75]
  ds_read_b64_tr_b16 v[172:173], v12 offset:35840
  ds_read_b64_tr_b16 a[190:191], v14 offset:496
  v_mfma_f32_16x16x32_bf16 v[92:95], v[132:135], a[36:39], v[92:95]
  ds_read_b64_tr_b16 v[174:175], v12 offset:37120
  ds_read_b64_tr_b16 a[194:195], v14 offset:656
  v_mfma_f32_16x16x32_bf16 v[76:79], v[136:139], a[32:35], v[76:79]
  ds_read_b64_tr_b16 v[176:177], v12 offset:35848
  buffer_load_dwordx4 v8, s[48:51], s7 offen offset:3072 lds
  s_addk_i32 m0, 0x1000
  v_mfma_f32_16x16x32_bf16 v[96:99], v[136:139], a[36:39], v[96:99]
  ds_read_b64_tr_b16 v[178:179], v12 offset:37128
  ds_read_b64_tr_b16 a[196:197], v14 offset:24
  v_mfma_f32_16x16x32_bf16 v[80:83], v[140:143], a[32:35], v[80:83]
  ds_read_b64_tr_b16 v[180:181], v12 offset:35856
  v_mfma_f32_16x16x32_bf16 v[100:103], v[140:143], a[36:39], v[100:103]
  ds_read_b64_tr_b16 v[182:183], v12 offset:37136
  ds_read_b64_tr_b16 a[198:199], v14 offset:184
  v_mfma_f32_16x16x32_bf16 v[84:87], v[144:147], a[32:35], v[84:87]
  ds_read_b64_tr_b16 v[184:185], v12 offset:35864
  buffer_load_dwordx4 v9, s[48:51], s7 offen offset:0 lds
  v_mfma_f32_16x16x32_bf16 v[104:107], v[144:147], a[36:39], v[104:107]
  ds_read_b64_tr_b16 v[186:187], v12 offset:37144
  ds_read_b64_tr_b16 a[200:201], v14 offset:344
  v_mfma_f32_16x16x32_bf16 v[88:91], v[148:151], a[32:35], v[88:91]
  ds_read_b64_tr_b16 v[188:189], v12 offset:35872
  v_mfma_f32_16x16x32_bf16 v[108:111], v[148:151], a[36:39], v[108:111]
  ds_read_b64_tr_b16 v[190:191], v12 offset:37152
  s_waitcnt lgkmcnt(15)
  v_mfma_f32_16x16x32_bf16 v[32:35], v[152:155], a[40:43], v[32:35]
  v_mfma_f32_16x16x32_bf16 v[52:55], v[152:155], a[44:47], v[52:55]
  s_waitcnt vmcnt(9)
  s_barrier
  v_mfma_f32_16x16x32_bf16 v[36:39], v[156:159], a[40:43], v[36:39]
  ds_read_b128 a[48:51], v10 offset:12288
  ds_read_b128 a[52:55], v10 offset:14336
  ds_read_b64_tr_b16 a[202:203], v14 offset:504
  v_mfma_f32_16x16x32_bf16 v[56:59], v[156:159], a[44:47], v[56:59]
  ds_read_b64_tr_b16 v[112:113], v12 offset:40960
  ds_read_b64_tr_b16 v[114:115], v12 offset:42240
  s_add_u32 m0, s15, 4096
  s_add_u32 s7, s68, 640
  v_mfma_f32_16x16x32_bf16 v[40:43], v[160:163], a[40:43], v[40:43]
  ds_read_b64_tr_b16 v[116:117], v12 offset:40968
  ds_read_b64_tr_b16 v[118:119], v12 offset:42248
  ds_read_b64_tr_b16 a[206:207], v14 offset:664
  v_mfma_f32_16x16x32_bf16 v[60:63], v[160:163], a[44:47], v[60:63]
  ds_read_b64_tr_b16 v[120:121], v12 offset:40976
  ds_read_b64_tr_b16 v[122:123], v12 offset:42256
  v_mfma_f32_16x16x32_bf16 v[44:47], v[164:167], a[40:43], v[44:47]
  ds_read_b64_tr_b16 v[124:125], v12 offset:40984
  ds_read_b64_tr_b16 a[208:209], v14 offset:32
  v_mfma_f32_16x16x32_bf16 v[64:67], v[164:167], a[44:47], v[64:67]
  ds_read_b64_tr_b16 v[126:127], v12 offset:42264
  buffer_load_dwordx4 v1, s[44:47], s7 offen offset:0 lds
  v_mfma_f32_16x16x32_bf16 v[48:51], v[168:171], a[40:43], v[48:51]
  ds_read_b64_tr_b16 v[128:129], v12 offset:40992
  ds_read_b64_tr_b16 a[210:211], v14 offset:192
  v_mfma_f32_16x16x32_bf16 v[68:71], v[168:171], a[44:47], v[68:71]
  ds_read_b64_tr_b16 v[130:131], v12 offset:42272
  s_waitcnt lgkmcnt(15)
  v_mfma_f32_16x16x32_bf16 v[72:75], v[172:175], a[40:43], v[72:75]
  ds_read_b64_tr_b16 v[132:133], v12 offset:51200
  buffer_load_dwordx4 v2, s[44:47], s7 offen offset:1024 lds
  v_mfma_f32_16x16x32_bf16 v[92:95], v[172:175], a[44:47], v[92:95]
  ds_read_b64_tr_b16 v[134:135], v12 offset:52480
  ds_read_b64_tr_b16 a[212:213], v14 offset:352
  v_mfma_f32_16x16x32_bf16 v[76:79], v[176:179], a[40:43], v[76:79]
  ds_read_b64_tr_b16 v[136:137], v12 offset:51208
  v_mfma_f32_16x16x32_bf16 v[96:99], v[176:179], a[44:47], v[96:99]
  ds_read_b64_tr_b16 v[138:139], v12 offset:52488
  ds_read_b64_tr_b16 a[214:215], v14 offset:512
  v_mfma_f32_16x16x32_bf16 v[80:83], v[180:183], a[40:43], v[80:83]
  ds_read_b64_tr_b16 v[140:141], v12 offset:51216
  buffer_load_dwordx4 v3, s[44:47], s7 offen offset:2048 lds
  v_mfma_f32_16x16x32_bf16 v[100:103], v[180:183], a[44:47], v[100:103]
  ds_read_b64_tr_b16 v[142:143], v12 offset:52496
  ds_read_b64_tr_b16 a[218:219], v14 offset:672
  v_mfma_f32_16x16x32_bf16 v[84:87], v[184:187], a[40:43], v[84:87]
  ds_read_b64_tr_b16 v[144:145], v12 offset:51224
  v_mfma_f32_16x16x32_bf16 v[104:107], v[184:187], a[44:47], v[104:107]
  ds_read_b64_tr_b16 v[146:147], v12 offset:52504
  v_accvgpr_write_b32 a168, 0
  v_mfma_f32_16x16x32_bf16 v[88:91], v[188:191], a[40:43], v[88:91]
  ds_read_b64_tr_b16 v[148:149], v12 offset:51232
  buffer_load_dwordx4 v4, s[44:47], s7 offen offset:3072 lds
  s_add_u32 m0, s3, 129024
  s_add_u32 s7, s69, 1228800
  v_mfma_f32_16x16x32_bf16 v[108:111], v[188:191], a[44:47], v[108:111]
  ds_read_b64_tr_b16 v[150:151], v12 offset:52512
  s_waitcnt lgkmcnt(15)
  v_mfma_f32_16x16x32_bf16 v[32:35], v[112:115], a[48:51], v[32:35]
  ds_read_b128 a[56:59], v11 offset:12288
  ds_read_b128 a[60:63], v11 offset:14336
  v_accvgpr_write_b32 a169, 0
  v_mfma_f32_16x16x32_bf16 v[52:55], v[112:115], a[52:55], v[52:55]
  ds_read_b64_tr_b16 v[152:153], v12 offset:46080
  ds_read_b64_tr_b16 v[154:155], v12 offset:47360
  buffer_load_dwordx4 v5, s[48:51], s7 offen offset:0 lds
  v_mfma_f32_16x16x32_bf16 v[36:39], v[116:119], a[48:51], v[36:39]
  ds_read_b64_tr_b16 v[156:157], v12 offset:46088
  v_accvgpr_write_b32 a180, 0
  v_mfma_f32_16x16x32_bf16 v[56:59], v[116:119], a[52:55], v[56:59]
  ds_read_b64_tr_b16 v[158:159], v12 offset:47368
  v_mfma_f32_16x16x32_bf16 v[40:43], v[120:123], a[48:51], v[40:43]
  ds_read_b64_tr_b16 v[160:161], v12 offset:46096
  v_accvgpr_write_b32 a181, 0
  v_mfma_f32_16x16x32_bf16 v[60:63], v[120:123], a[52:55], v[60:63]
  ds_read_b64_tr_b16 v[162:163], v12 offset:47376
  buffer_load_dwordx4 v6, s[48:51], s7 offen offset:1024 lds
  v_mfma_f32_16x16x32_bf16 v[44:47], v[124:127], a[48:51], v[44:47]
  ds_read_b64_tr_b16 v[164:165], v12 offset:46104
  v_accvgpr_write_b32 a192, 0
  v_mfma_f32_16x16x32_bf16 v[64:67], v[124:127], a[52:55], v[64:67]
  ds_read_b64_tr_b16 v[166:167], v12 offset:47384
  s_waitcnt lgkmcnt(15)
  v_mfma_f32_16x16x32_bf16 v[48:51], v[128:131], a[48:51], v[48:51]
  ds_read_b64_tr_b16 v[168:169], v12 offset:46112
  v_accvgpr_write_b32 a193, 0
  v_mfma_f32_16x16x32_bf16 v[68:71], v[128:131], a[52:55], v[68:71]
  ds_read_b64_tr_b16 v[170:171], v12 offset:47392
  buffer_load_dwordx4 v7, s[48:51], s7 offen offset:2048 lds
  v_mfma_f32_16x16x32_bf16 v[72:75], v[132:135], a[48:51], v[72:75]
  ds_read_b64_tr_b16 v[172:173], v12 offset:56320
  v_mfma_f32_16x16x32_bf16 v[92:95], v[132:135], a[52:55], v[92:95]
  ds_read_b64_tr_b16 v[174:175], v12 offset:57600
  v_accvgpr_write_b32 a204, 0
  v_mfma_f32_16x16x32_bf16 v[76:79], v[136:139], a[48:51], v[76:79]
  ds_read_b64_tr_b16 v[176:177], v12 offset:56328
  buffer_load_dwordx4 v8, s[48:51], s7 offen offset:3072 lds
  s_addk_i32 m0, 0x1000
  v_mfma_f32_16x16x32_bf16 v[96:99], v[136:139], a[52:55], v[96:99]
  ds_read_b64_tr_b16 v[178:179], v12 offset:57608
  v_accvgpr_write_b32 a205, 0
  v_mfma_f32_16x16x32_bf16 v[80:83], v[140:143], a[48:51], v[80:83]
  ds_read_b64_tr_b16 v[180:181], v12 offset:56336
  v_mfma_f32_16x16x32_bf16 v[100:103], v[140:143], a[52:55], v[100:103]
  ds_read_b64_tr_b16 v[182:183], v12 offset:57616
  v_accvgpr_write_b32 a216, 0
  s_waitcnt lgkmcnt(15)
  v_mfma_f32_16x16x32_bf16 v[84:87], v[144:147], a[48:51], v[84:87]
  ds_read_b64_tr_b16 v[184:185], v12 offset:56344
  buffer_load_dwordx4 v9, s[48:51], s7 offen offset:0 lds
  v_mfma_f32_16x16x32_bf16 v[104:107], v[144:147], a[52:55], v[104:107]
  ds_read_b64_tr_b16 v[186:187], v12 offset:57624
  v_mfma_f32_16x16x32_bf16 v[88:91], v[148:151], a[48:51], v[88:91]
  ds_read_b64_tr_b16 v[188:189], v12 offset:56352
  v_accvgpr_write_b32 a217, 0
  v_mfma_f32_16x16x32_bf16 v[108:111], v[148:151], a[52:55], v[108:111]
  ds_read_b64_tr_b16 v[190:191], v12 offset:57632
  s_waitcnt lgkmcnt(15)
  v_mfma_f32_16x16x32_bf16 v[32:35], v[152:155], a[56:59], v[32:35]
  v_mfma_f32_16x16x32_bf16 v[52:55], v[152:155], a[60:63], v[52:55]
  s_waitcnt vmcnt(9)
  s_barrier
  v_mfma_f32_16x16x32_bf16 v[36:39], v[156:159], a[56:59], v[36:39]
  ds_read_b128 a[64:67], v10 offset:0
  ds_read_b128 a[68:71], v10 offset:2048
  s_add_u32 m0, s15, 8192
  s_add_u32 s7, s68, 768
  v_mfma_f32_16x16x32_bf16 v[56:59], v[156:159], a[60:63], v[56:59]
  ds_read_b64_tr_b16 v[112:113], v13 offset:0
  ds_read_b64_tr_b16 v[114:115], v13 offset:1280
  s_waitcnt lgkmcnt(15)
  v_mfma_f32_16x16x32_bf16 v[40:43], v[160:163], a[56:59], v[40:43]
  ds_read_b64_tr_b16 v[116:117], v13 offset:8
  ds_read_b64_tr_b16 v[118:119], v13 offset:1288
  v_mfma_f32_16x16x32_bf16 v[60:63], v[160:163], a[60:63], v[60:63]
  ds_read_b64_tr_b16 v[120:121], v13 offset:16
  ds_read_b64_tr_b16 v[122:123], v13 offset:1296
  buffer_load_dwordx4 v1, s[44:47], s7 offen offset:0 lds
  v_mfma_f32_16x16x32_bf16 v[44:47], v[164:167], a[56:59], v[44:47]
  ds_read_b64_tr_b16 v[124:125], v13 offset:24
  v_mfma_f32_16x16x32_bf16 v[64:67], v[164:167], a[60:63], v[64:67]
  ds_read_b64_tr_b16 v[126:127], v13 offset:1304
  s_waitcnt lgkmcnt(15)
  v_mfma_f32_16x16x32_bf16 v[48:51], v[168:171], a[56:59], v[48:51]
  ds_read_b64_tr_b16 v[128:129], v13 offset:32
  v_mfma_f32_16x16x32_bf16 v[68:71], v[168:171], a[60:63], v[68:71]
  ds_read_b64_tr_b16 v[130:131], v13 offset:1312
  buffer_load_dwordx4 v2, s[44:47], s7 offen offset:1024 lds
  v_mfma_f32_16x16x32_bf16 v[72:75], v[172:175], a[56:59], v[72:75]
  ds_read_b64_tr_b16 v[132:133], v13 offset:10240
  v_mfma_f32_16x16x32_bf16 v[92:95], v[172:175], a[60:63], v[92:95]
  ds_read_b64_tr_b16 v[134:135], v13 offset:11520
  v_mfma_f32_16x16x32_bf16 v[76:79], v[176:179], a[56:59], v[76:79]
  ds_read_b64_tr_b16 v[136:137], v13 offset:10248
  v_mfma_f32_16x16x32_bf16 v[96:99], v[176:179], a[60:63], v[96:99]
  ds_read_b64_tr_b16 v[138:139], v13 offset:11528
  s_waitcnt lgkmcnt(15)
  v_mfma_f32_16x16x32_bf16 v[80:83], v[180:183], a[56:59], v[80:83]
  ds_read_b64_tr_b16 v[140:141], v13 offset:10256
  buffer_load_dwordx4 v3, s[44:47], s7 offen offset:2048 lds
  v_mfma_f32_16x16x32_bf16 v[100:103], v[180:183], a[60:63], v[100:103]
  ds_read_b64_tr_b16 v[142:143], v13 offset:11536
  v_mfma_f32_16x16x32_bf16 v[84:87], v[184:187], a[56:59], v[84:87]
  ds_read_b64_tr_b16 v[144:145], v13 offset:10264
  v_mfma_f32_16x16x32_bf16 v[104:107], v[184:187], a[60:63], v[104:107]
  ds_read_b64_tr_b16 v[146:147], v13 offset:11544
  buffer_load_dwordx4 v4, s[44:47], s7 offen offset:3072 lds
  s_add_u32 m0, s3, 67584
  s_add_u32 s7, s69, 1474560
  v_mfma_f32_16x16x32_bf16 v[88:91], v[188:191], a[56:59], v[88:91]
  ds_read_b64_tr_b16 v[148:149], v13 offset:10272
  v_mfma_f32_16x16x32_bf16 v[108:111], v[188:191], a[60:63], v[108:111]
  ds_read_b64_tr_b16 v[150:151], v13 offset:11552
  s_waitcnt lgkmcnt(15)
  v_mfma_f32_16x16x32_bf16 v[32:35], v[112:115], a[64:67], v[32:35]
  ds_read_b128 a[72:75], v11 offset:0
  ds_read_b128 a[76:79], v11 offset:2048
  v_mfma_f32_16x16x32_bf16 v[52:55], v[112:115], a[68:71], v[52:55]
  ds_read_b64_tr_b16 v[152:153], v13 offset:5120
  ds_read_b64_tr_b16 v[154:155], v13 offset:6400
  buffer_load_dwordx4 v5, s[48:51], s7 offen offset:0 lds
  v_mfma_f32_16x16x32_bf16 v[36:39], v[116:119], a[64:67], v[36:39]
  ds_read_b64_tr_b16 v[156:157], v13 offset:5128
  v_mfma_f32_16x16x32_bf16 v[56:59], v[116:119], a[68:71], v[56:59]
  ds_read_b64_tr_b16 v[158:159], v13 offset:6408
  s_waitcnt lgkmcnt(15)
  v_mfma_f32_16x16x32_bf16 v[40:43], v[120:123], a[64:67], v[40:43]
  ds_read_b64_tr_b16 v[160:161], v13 offset:5136
  v_mfma_f32_16x16x32_bf16 v[60:63], v[120:123], a[68:71], v[60:63]
  ds_read_b64_tr_b16 v[162:163], v13 offset:6416
  v_mfma_f32_16x16x32_bf16 v[44:47], v[124:127], a[64:67], v[44:47]
  ds_read_b64_tr_b16 v[164:165], v13 offset:5144
  buffer_load_dwordx4 v6, s[48:51], s7 offen offset:1024 lds
  v_mfma_f32_16x16x32_bf16 v[64:67], v[124:127], a[68:71], v[64:67]
  ds_read_b64_tr_b16 v[166:167], v13 offset:6424
  v_mfma_f32_16x16x32_bf16 v[48:51], v[128:131], a[64:67], v[48:51]
  ds_read_b64_tr_b16 v[168:169], v13 offset:5152
  v_mfma_f32_16x16x32_bf16 v[68:71], v[128:131], a[68:71], v[68:71]
  ds_read_b64_tr_b16 v[170:171], v13 offset:6432
  buffer_load_dwordx4 v7, s[48:51], s7 offen offset:2048 lds
  s_waitcnt lgkmcnt(15)
  v_mfma_f32_16x16x32_bf16 v[72:75], v[132:135], a[64:67], v[72:75]
  ds_read_b64_tr_b16 v[172:173], v13 offset:15360
  v_mfma_f32_16x16x32_bf16 v[92:95], v[132:135], a[68:71], v[92:95]
  ds_read_b64_tr_b16 v[174:175], v13 offset:16640
  v_mfma_f32_16x16x32_bf16 v[76:79], v[136:139], a[64:67], v[76:79]
  ds_read_b64_tr_b16 v[176:177], v13 offset:15368
  v_mfma_f32_16x16x32_bf16 v[96:99], v[136:139], a[68:71], v[96:99]
  ds_read_b64_tr_b16 v[178:179], v13 offset:16648
  buffer_load_dwordx4 v8, s[48:51], s7 offen offset:3072 lds
  s_addk_i32 m0, 0x1000
  v_mfma_f32_16x16x32_bf16 v[80:83], v[140:143], a[64:67], v[80:83]
  ds_read_b64_tr_b16 v[180:181], v13 offset:15376
  v_mfma_f32_16x16x32_bf16 v[100:103], v[140:143], a[68:71], v[100:103]
  ds_read_b64_tr_b16 v[182:183], v13 offset:16656
  s_waitcnt lgkmcnt(15)
  v_mfma_f32_16x16x32_bf16 v[84:87], v[144:147], a[64:67], v[84:87]
  ds_read_b64_tr_b16 v[184:185], v13 offset:15384
  v_mfma_f32_16x16x32_bf16 v[104:107], v[144:147], a[68:71], v[104:107]
  ds_read_b64_tr_b16 v[186:187], v13 offset:16664
  buffer_load_dwordx4 v9, s[48:51], s7 offen offset:0 lds
  v_mfma_f32_16x16x32_bf16 v[88:91], v[148:151], a[64:67], v[88:91]
  ds_read_b64_tr_b16 v[188:189], v13 offset:15392
  v_mfma_f32_16x16x32_bf16 v[108:111], v[148:151], a[68:71], v[108:111]
  ds_read_b64_tr_b16 v[190:191], v13 offset:16672
  s_waitcnt lgkmcnt(15)
  v_mfma_f32_16x16x32_bf16 v[32:35], v[152:155], a[72:75], v[32:35]
  v_mfma_f32_16x16x32_bf16 v[52:55], v[152:155], a[76:79], v[52:55]
  s_waitcnt vmcnt(9)
  s_barrier
  v_mfma_f32_16x16x32_bf16 v[36:39], v[156:159], a[72:75], v[36:39]
  ds_read_b128 a[80:83], v10 offset:4096
  ds_read_b128 a[84:87], v10 offset:6144
  s_add_u32 m0, s15, 12288
  s_add_u32 s7, s68, 896
  v_mfma_f32_16x16x32_bf16 v[56:59], v[156:159], a[76:79], v[56:59]
  ds_read_b64_tr_b16 v[112:113], v13 offset:20480
  ds_read_b64_tr_b16 v[114:115], v13 offset:21760
  s_waitcnt lgkmcnt(15)
  v_mfma_f32_16x16x32_bf16 v[40:43], v[160:163], a[72:75], v[40:43]
  ds_read_b64_tr_b16 v[116:117], v13 offset:20488
  ds_read_b64_tr_b16 v[118:119], v13 offset:21768
  v_mfma_f32_16x16x32_bf16 v[60:63], v[160:163], a[76:79], v[60:63]
  ds_read_b64_tr_b16 v[120:121], v13 offset:20496
  ds_read_b64_tr_b16 v[122:123], v13 offset:21776
  buffer_load_dwordx4 v1, s[44:47], s7 offen offset:0 lds
  v_mfma_f32_16x16x32_bf16 v[44:47], v[164:167], a[72:75], v[44:47]
  ds_read_b64_tr_b16 v[124:125], v13 offset:20504
  v_mfma_f32_16x16x32_bf16 v[64:67], v[164:167], a[76:79], v[64:67]
  ds_read_b64_tr_b16 v[126:127], v13 offset:21784
  s_waitcnt lgkmcnt(15)
  v_mfma_f32_16x16x32_bf16 v[48:51], v[168:171], a[72:75], v[48:51]
  ds_read_b64_tr_b16 v[128:129], v13 offset:20512
  v_mfma_f32_16x16x32_bf16 v[68:71], v[168:171], a[76:79], v[68:71]
  ds_read_b64_tr_b16 v[130:131], v13 offset:21792
  buffer_load_dwordx4 v2, s[44:47], s7 offen offset:1024 lds
  v_mfma_f32_16x16x32_bf16 v[72:75], v[172:175], a[72:75], v[72:75]
  ds_read_b64_tr_b16 v[132:133], v13 offset:30720
  v_mfma_f32_16x16x32_bf16 v[92:95], v[172:175], a[76:79], v[92:95]
  ds_read_b64_tr_b16 v[134:135], v13 offset:32000
  v_mfma_f32_16x16x32_bf16 v[76:79], v[176:179], a[72:75], v[76:79]
  ds_read_b64_tr_b16 v[136:137], v13 offset:30728
  v_mfma_f32_16x16x32_bf16 v[96:99], v[176:179], a[76:79], v[96:99]
  ds_read_b64_tr_b16 v[138:139], v13 offset:32008
  s_waitcnt lgkmcnt(15)
  v_mfma_f32_16x16x32_bf16 v[80:83], v[180:183], a[72:75], v[80:83]
  ds_read_b64_tr_b16 v[140:141], v13 offset:30736
  buffer_load_dwordx4 v3, s[44:47], s7 offen offset:2048 lds
  v_mfma_f32_16x16x32_bf16 v[100:103], v[180:183], a[76:79], v[100:103]
  ds_read_b64_tr_b16 v[142:143], v13 offset:32016
  v_mfma_f32_16x16x32_bf16 v[84:87], v[184:187], a[72:75], v[84:87]
  ds_read_b64_tr_b16 v[144:145], v13 offset:30744
  v_mfma_f32_16x16x32_bf16 v[104:107], v[184:187], a[76:79], v[104:107]
  ds_read_b64_tr_b16 v[146:147], v13 offset:32024
  buffer_load_dwordx4 v4, s[44:47], s7 offen offset:3072 lds
  s_add_u32 m0, s3, 88064
  s_add_u32 s7, s69, 1720320
  v_mfma_f32_16x16x32_bf16 v[88:91], v[188:191], a[72:75], v[88:91]
  ds_read_b64_tr_b16 v[148:149], v13 offset:30752
  v_mfma_f32_16x16x32_bf16 v[108:111], v[188:191], a[76:79], v[108:111]
  ds_read_b64_tr_b16 v[150:151], v13 offset:32032
  s_waitcnt lgkmcnt(15)
  v_mfma_f32_16x16x32_bf16 v[32:35], v[112:115], a[80:83], v[32:35]
  ds_read_b128 a[88:91], v11 offset:4096
  ds_read_b128 a[92:95], v11 offset:6144
  v_mfma_f32_16x16x32_bf16 v[52:55], v[112:115], a[84:87], v[52:55]
  ds_read_b64_tr_b16 v[152:153], v13 offset:25600
  ds_read_b64_tr_b16 v[154:155], v13 offset:26880
  buffer_load_dwordx4 v5, s[48:51], s7 offen offset:0 lds
  v_mfma_f32_16x16x32_bf16 v[36:39], v[116:119], a[80:83], v[36:39]
  ds_read_b64_tr_b16 v[156:157], v13 offset:25608
  v_mfma_f32_16x16x32_bf16 v[56:59], v[116:119], a[84:87], v[56:59]
  ds_read_b64_tr_b16 v[158:159], v13 offset:26888
  s_waitcnt lgkmcnt(15)
  v_mfma_f32_16x16x32_bf16 v[40:43], v[120:123], a[80:83], v[40:43]
  ds_read_b64_tr_b16 v[160:161], v13 offset:25616
  v_mfma_f32_16x16x32_bf16 v[60:63], v[120:123], a[84:87], v[60:63]
  ds_read_b64_tr_b16 v[162:163], v13 offset:26896
  v_mfma_f32_16x16x32_bf16 v[44:47], v[124:127], a[80:83], v[44:47]
  ds_read_b64_tr_b16 v[164:165], v13 offset:25624
  buffer_load_dwordx4 v6, s[48:51], s7 offen offset:1024 lds
  v_mfma_f32_16x16x32_bf16 v[64:67], v[124:127], a[84:87], v[64:67]
  ds_read_b64_tr_b16 v[166:167], v13 offset:26904
  v_mfma_f32_16x16x32_bf16 v[48:51], v[128:131], a[80:83], v[48:51]
  ds_read_b64_tr_b16 v[168:169], v13 offset:25632
  v_mfma_f32_16x16x32_bf16 v[68:71], v[128:131], a[84:87], v[68:71]
  ds_read_b64_tr_b16 v[170:171], v13 offset:26912
  buffer_load_dwordx4 v7, s[48:51], s7 offen offset:2048 lds
  s_waitcnt lgkmcnt(15)
  v_mfma_f32_16x16x32_bf16 v[72:75], v[132:135], a[80:83], v[72:75]
  ds_read_b64_tr_b16 v[172:173], v13 offset:35840
  v_mfma_f32_16x16x32_bf16 v[92:95], v[132:135], a[84:87], v[92:95]
  ds_read_b64_tr_b16 v[174:175], v13 offset:37120
  v_mfma_f32_16x16x32_bf16 v[76:79], v[136:139], a[80:83], v[76:79]
  ds_read_b64_tr_b16 v[176:177], v13 offset:35848
  v_mfma_f32_16x16x32_bf16 v[96:99], v[136:139], a[84:87], v[96:99]
  ds_read_b64_tr_b16 v[178:179], v13 offset:37128
  buffer_load_dwordx4 v8, s[48:51], s7 offen offset:3072 lds
  s_addk_i32 m0, 0x1000
  v_mfma_f32_16x16x32_bf16 v[80:83], v[140:143], a[80:83], v[80:83]
  ds_read_b64_tr_b16 v[180:181], v13 offset:35856
  v_mfma_f32_16x16x32_bf16 v[100:103], v[140:143], a[84:87], v[100:103]
  ds_read_b64_tr_b16 v[182:183], v13 offset:37136
  s_waitcnt lgkmcnt(15)
  v_mfma_f32_16x16x32_bf16 v[84:87], v[144:147], a[80:83], v[84:87]
  ds_read_b64_tr_b16 v[184:185], v13 offset:35864
  v_mfma_f32_16x16x32_bf16 v[104:107], v[144:147], a[84:87], v[104:107]
  ds_read_b64_tr_b16 v[186:187], v13 offset:37144
  buffer_load_dwordx4 v9, s[48:51], s7 offen offset:0 lds
  v_mfma_f32_16x16x32_bf16 v[88:91], v[148:151], a[80:83], v[88:91]
  ds_read_b64_tr_b16 v[188:189], v13 offset:35872
  v_mfma_f32_16x16x32_bf16 v[108:111], v[148:151], a[84:87], v[108:111]
  ds_read_b64_tr_b16 v[190:191], v13 offset:37152
  s_waitcnt lgkmcnt(15)
  v_mfma_f32_16x16x32_bf16 v[32:35], v[152:155], a[88:91], v[32:35]
  v_mfma_f32_16x16x32_bf16 v[52:55], v[152:155], a[92:95], v[52:55]
  s_waitcnt vmcnt(9)
  s_barrier
  v_mfma_f32_16x16x32_bf16 v[36:39], v[156:159], a[88:91], v[36:39]
  ds_read_b128 a[96:99], v10 offset:8192
  ds_read_b128 a[100:103], v10 offset:10240
  s_add_u32 m0, s15, 0
  s_add_u32 s7, s68, 1024
  v_mfma_f32_16x16x32_bf16 v[56:59], v[156:159], a[92:95], v[56:59]
  ds_read_b64_tr_b16 v[112:113], v12 offset:20480
  ds_read_b64_tr_b16 v[114:115], v12 offset:21760
  s_waitcnt lgkmcnt(15)
  v_mfma_f32_16x16x32_bf16 v[40:43], v[160:163], a[88:91], v[40:43]
  ds_read_b64_tr_b16 v[116:117], v12 offset:20488
  ds_read_b64_tr_b16 v[118:119], v12 offset:21768
  v_mfma_f32_16x16x32_bf16 v[60:63], v[160:163], a[92:95], v[60:63]
  ds_read_b64_tr_b16 v[120:121], v12 offset:20496
  ds_read_b64_tr_b16 v[122:123], v12 offset:21776
  buffer_load_dwordx4 v1, s[44:47], s7 offen offset:0 lds
  v_mfma_f32_16x16x32_bf16 v[44:47], v[164:167], a[88:91], v[44:47]
  ds_read_b64_tr_b16 v[124:125], v12 offset:20504
  v_mfma_f32_16x16x32_bf16 v[64:67], v[164:167], a[92:95], v[64:67]
  ds_read_b64_tr_b16 v[126:127], v12 offset:21784
  s_waitcnt lgkmcnt(15)
  v_mfma_f32_16x16x32_bf16 v[48:51], v[168:171], a[88:91], v[48:51]
  ds_read_b64_tr_b16 v[128:129], v12 offset:20512
  v_mfma_f32_16x16x32_bf16 v[68:71], v[168:171], a[92:95], v[68:71]
  ds_read_b64_tr_b16 v[130:131], v12 offset:21792
  buffer_load_dwordx4 v2, s[44:47], s7 offen offset:1024 lds
  v_mfma_f32_16x16x32_bf16 v[72:75], v[172:175], a[88:91], v[72:75]
  ds_read_b64_tr_b16 v[132:133], v12 offset:30720
  v_mfma_f32_16x16x32_bf16 v[92:95], v[172:175], a[92:95], v[92:95]
  ds_read_b64_tr_b16 v[134:135], v12 offset:32000
  v_mfma_f32_16x16x32_bf16 v[76:79], v[176:179], a[88:91], v[76:79]
  ds_read_b64_tr_b16 v[136:137], v12 offset:30728
  v_mfma_f32_16x16x32_bf16 v[96:99], v[176:179], a[92:95], v[96:99]
  ds_read_b64_tr_b16 v[138:139], v12 offset:32008
  s_waitcnt lgkmcnt(15)
  v_mfma_f32_16x16x32_bf16 v[80:83], v[180:183], a[88:91], v[80:83]
  ds_read_b64_tr_b16 v[140:141], v12 offset:30736
  buffer_load_dwordx4 v3, s[44:47], s7 offen offset:2048 lds
  v_mfma_f32_16x16x32_bf16 v[100:103], v[180:183], a[92:95], v[100:103]
  ds_read_b64_tr_b16 v[142:143], v12 offset:32016
  v_mfma_f32_16x16x32_bf16 v[84:87], v[184:187], a[88:91], v[84:87]
  ds_read_b64_tr_b16 v[144:145], v12 offset:30744
  v_mfma_f32_16x16x32_bf16 v[104:107], v[184:187], a[92:95], v[104:107]
  ds_read_b64_tr_b16 v[146:147], v12 offset:32024
  buffer_load_dwordx4 v4, s[44:47], s7 offen offset:3072 lds
  s_add_u32 m0, s3, 108544
  s_add_u32 s7, s69, 1966080
  v_mfma_f32_16x16x32_bf16 v[88:91], v[188:191], a[88:91], v[88:91]
  ds_read_b64_tr_b16 v[148:149], v12 offset:30752
  v_mfma_f32_16x16x32_bf16 v[108:111], v[188:191], a[92:95], v[108:111]
  ds_read_b64_tr_b16 v[150:151], v12 offset:32032
  s_waitcnt lgkmcnt(15)
  v_mfma_f32_16x16x32_bf16 v[32:35], v[112:115], a[96:99], v[32:35]
  ds_read_b128 a[104:107], v11 offset:8192
  ds_read_b128 a[108:111], v11 offset:10240
  v_mfma_f32_16x16x32_bf16 v[52:55], v[112:115], a[100:103], v[52:55]
  ds_read_b64_tr_b16 v[152:153], v12 offset:25600
  ds_read_b64_tr_b16 v[154:155], v12 offset:26880
  buffer_load_dwordx4 v5, s[48:51], s7 offen offset:0 lds
  v_mfma_f32_16x16x32_bf16 v[36:39], v[116:119], a[96:99], v[36:39]
  ds_read_b64_tr_b16 v[156:157], v12 offset:25608
  v_mfma_f32_16x16x32_bf16 v[56:59], v[116:119], a[100:103], v[56:59]
  ds_read_b64_tr_b16 v[158:159], v12 offset:26888
  s_waitcnt lgkmcnt(15)
  v_mfma_f32_16x16x32_bf16 v[40:43], v[120:123], a[96:99], v[40:43]
  ds_read_b64_tr_b16 v[160:161], v12 offset:25616
  v_mfma_f32_16x16x32_bf16 v[60:63], v[120:123], a[100:103], v[60:63]
  ds_read_b64_tr_b16 v[162:163], v12 offset:26896
  v_mfma_f32_16x16x32_bf16 v[44:47], v[124:127], a[96:99], v[44:47]
  ds_read_b64_tr_b16 v[164:165], v12 offset:25624
  buffer_load_dwordx4 v6, s[48:51], s7 offen offset:1024 lds
  v_mfma_f32_16x16x32_bf16 v[64:67], v[124:127], a[100:103], v[64:67]
  ds_read_b64_tr_b16 v[166:167], v12 offset:26904
  v_mfma_f32_16x16x32_bf16 v[48:51], v[128:131], a[96:99], v[48:51]
  ds_read_b64_tr_b16 v[168:169], v12 offset:25632
  v_mfma_f32_16x16x32_bf16 v[68:71], v[128:131], a[100:103], v[68:71]
  ds_read_b64_tr_b16 v[170:171], v12 offset:26912
  buffer_load_dwordx4 v7, s[48:51], s7 offen offset:2048 lds
  s_waitcnt lgkmcnt(15)
  v_mfma_f32_16x16x32_bf16 v[72:75], v[132:135], a[96:99], v[72:75]
  ds_read_b64_tr_b16 v[172:173], v12 offset:35840
  v_mfma_f32_16x16x32_bf16 v[92:95], v[132:135], a[100:103], v[92:95]
  ds_read_b64_tr_b16 v[174:175], v12 offset:37120
  v_mfma_f32_16x16x32_bf16 v[76:79], v[136:139], a[96:99], v[76:79]
  ds_read_b64_tr_b16 v[176:177], v12 offset:35848
  v_mfma_f32_16x16x32_bf16 v[96:99], v[136:139], a[100:103], v[96:99]
  ds_read_b64_tr_b16 v[178:179], v12 offset:37128
  buffer_load_dwordx4 v8, s[48:51], s7 offen offset:3072 lds
  s_addk_i32 m0, 0x1000
  v_mfma_f32_16x16x32_bf16 v[80:83], v[140:143], a[96:99], v[80:83]
  ds_read_b64_tr_b16 v[180:181], v12 offset:35856
  v_mfma_f32_16x16x32_bf16 v[100:103], v[140:143], a[100:103], v[100:103]
  ds_read_b64_tr_b16 v[182:183], v12 offset:37136
  s_waitcnt lgkmcnt(15)
  v_mfma_f32_16x16x32_bf16 v[84:87], v[144:147], a[96:99], v[84:87]
  ds_read_b64_tr_b16 v[184:185], v12 offset:35864
  v_mfma_f32_16x16x32_bf16 v[104:107], v[144:147], a[100:103], v[104:107]
  ds_read_b64_tr_b16 v[186:187], v12 offset:37144
  buffer_load_dwordx4 v9, s[48:51], s7 offen offset:0 lds
  v_mfma_f32_16x16x32_bf16 v[88:91], v[148:151], a[96:99], v[88:91]
  ds_read_b64_tr_b16 v[188:189], v12 offset:35872
  v_mfma_f32_16x16x32_bf16 v[108:111], v[148:151], a[100:103], v[108:111]
  ds_read_b64_tr_b16 v[190:191], v12 offset:37152
  s_waitcnt lgkmcnt(15)
  v_mfma_f32_16x16x32_bf16 v[32:35], v[152:155], a[104:107], v[32:35]
  v_mfma_f32_16x16x32_bf16 v[52:55], v[152:155], a[108:111], v[52:55]
  s_waitcnt vmcnt(9)
  s_barrier
  v_mfma_f32_16x16x32_bf16 v[36:39], v[156:159], a[104:107], v[36:39]
  ds_read_b128 a[112:115], v10 offset:12288
  ds_read_b128 a[116:119], v10 offset:14336
  s_add_u32 m0, s15, 4096
  s_add_u32 s7, s68, 1152
  v_mfma_f32_16x16x32_bf16 v[56:59], v[156:159], a[108:111], v[56:59]
  ds_read_b64_tr_b16 v[112:113], v12 offset:40960
  ds_read_b64_tr_b16 v[114:115], v12 offset:42240
  s_waitcnt lgkmcnt(15)
  v_mfma_f32_16x16x32_bf16 v[40:43], v[160:163], a[104:107], v[40:43]
  ds_read_b64_tr_b16 v[116:117], v12 offset:40968
  ds_read_b64_tr_b16 v[118:119], v12 offset:42248
  v_mfma_f32_16x16x32_bf16 v[60:63], v[160:163], a[108:111], v[60:63]
  ds_read_b64_tr_b16 v[120:121], v12 offset:40976
  ds_read_b64_tr_b16 v[122:123], v12 offset:42256
  buffer_load_dwordx4 v1, s[44:47], s7 offen offset:0 lds
  v_mfma_f32_16x16x32_bf16 v[44:47], v[164:167], a[104:107], v[44:47]
  ds_read_b64_tr_b16 v[124:125], v12 offset:40984
  v_mfma_f32_16x16x32_bf16 v[64:67], v[164:167], a[108:111], v[64:67]
  ds_read_b64_tr_b16 v[126:127], v12 offset:42264
  s_waitcnt lgkmcnt(15)
  v_mfma_f32_16x16x32_bf16 v[48:51], v[168:171], a[104:107], v[48:51]
  ds_read_b64_tr_b16 v[128:129], v12 offset:40992
  v_mfma_f32_16x16x32_bf16 v[68:71], v[168:171], a[108:111], v[68:71]
  ds_read_b64_tr_b16 v[130:131], v12 offset:42272
  buffer_load_dwordx4 v2, s[44:47], s7 offen offset:1024 lds
  v_mfma_f32_16x16x32_bf16 v[72:75], v[172:175], a[104:107], v[72:75]
  ds_read_b64_tr_b16 v[132:133], v12 offset:51200
  v_mfma_f32_16x16x32_bf16 v[92:95], v[172:175], a[108:111], v[92:95]
  ds_read_b64_tr_b16 v[134:135], v12 offset:52480
  v_mfma_f32_16x16x32_bf16 v[76:79], v[176:179], a[104:107], v[76:79]
  ds_read_b64_tr_b16 v[136:137], v12 offset:51208
  v_mfma_f32_16x16x32_bf16 v[96:99], v[176:179], a[108:111], v[96:99]
  ds_read_b64_tr_b16 v[138:139], v12 offset:52488
  s_waitcnt lgkmcnt(15)
  v_mfma_f32_16x16x32_bf16 v[80:83], v[180:183], a[104:107], v[80:83]
  ds_read_b64_tr_b16 v[140:141], v12 offset:51216
  buffer_load_dwordx4 v3, s[44:47], s7 offen offset:2048 lds
  v_mfma_f32_16x16x32_bf16 v[100:103], v[180:183], a[108:111], v[100:103]
  ds_read_b64_tr_b16 v[142:143], v12 offset:52496
  v_mfma_f32_16x16x32_bf16 v[84:87], v[184:187], a[104:107], v[84:87]
  ds_read_b64_tr_b16 v[144:145], v12 offset:51224
  v_mfma_f32_16x16x32_bf16 v[104:107], v[184:187], a[108:111], v[104:107]
  ds_read_b64_tr_b16 v[146:147], v12 offset:52504
  buffer_load_dwordx4 v4, s[44:47], s7 offen offset:3072 lds
  s_add_u32 m0, s3, 129024
  s_add_u32 s7, s69, 2211840
  v_mfma_f32_16x16x32_bf16 v[88:91], v[188:191], a[104:107], v[88:91]
  ds_read_b64_tr_b16 v[148:149], v12 offset:51232
  v_mfma_f32_16x16x32_bf16 v[108:111], v[188:191], a[108:111], v[108:111]
  ds_read_b64_tr_b16 v[150:151], v12 offset:52512
  s_waitcnt lgkmcnt(15)
  v_mfma_f32_16x16x32_bf16 v[32:35], v[112:115], a[112:115], v[32:35]
  ds_read_b128 a[120:123], v11 offset:12288
  ds_read_b128 a[124:127], v11 offset:14336
  v_mfma_f32_16x16x32_bf16 v[52:55], v[112:115], a[116:119], v[52:55]
  ds_read_b64_tr_b16 v[152:153], v12 offset:46080
  ds_read_b64_tr_b16 v[154:155], v12 offset:47360
  buffer_load_dwordx4 v5, s[48:51], s7 offen offset:0 lds
  v_mfma_f32_16x16x32_bf16 v[36:39], v[116:119], a[112:115], v[36:39]
  ds_read_b64_tr_b16 v[156:157], v12 offset:46088
  v_mfma_f32_16x16x32_bf16 v[56:59], v[116:119], a[116:119], v[56:59]
  ds_read_b64_tr_b16 v[158:159], v12 offset:47368
  s_waitcnt lgkmcnt(15)
  v_mfma_f32_16x16x32_bf16 v[40:43], v[120:123], a[112:115], v[40:43]
  ds_read_b64_tr_b16 v[160:161], v12 offset:46096
  v_mfma_f32_16x16x32_bf16 v[60:63], v[120:123], a[116:119], v[60:63]
  ds_read_b64_tr_b16 v[162:163], v12 offset:47376
  v_mfma_f32_16x16x32_bf16 v[44:47], v[124:127], a[112:115], v[44:47]
  ds_read_b64_tr_b16 v[164:165], v12 offset:46104
  buffer_load_dwordx4 v6, s[48:51], s7 offen offset:1024 lds
  v_mfma_f32_16x16x32_bf16 v[64:67], v[124:127], a[116:119], v[64:67]
  ds_read_b64_tr_b16 v[166:167], v12 offset:47384
  v_mfma_f32_16x16x32_bf16 v[48:51], v[128:131], a[112:115], v[48:51]
  ds_read_b64_tr_b16 v[168:169], v12 offset:46112
  v_mfma_f32_16x16x32_bf16 v[68:71], v[128:131], a[116:119], v[68:71]
  ds_read_b64_tr_b16 v[170:171], v12 offset:47392
  buffer_load_dwordx4 v7, s[48:51], s7 offen offset:2048 lds
  s_waitcnt lgkmcnt(15)
  v_mfma_f32_16x16x32_bf16 v[72:75], v[132:135], a[112:115], v[72:75]
  ds_read_b64_tr_b16 v[172:173], v12 offset:56320
  v_mfma_f32_16x16x32_bf16 v[92:95], v[132:135], a[116:119], v[92:95]
  ds_read_b64_tr_b16 v[174:175], v12 offset:57600
  v_mfma_f32_16x16x32_bf16 v[76:79], v[136:139], a[112:115], v[76:79]
  ds_read_b64_tr_b16 v[176:177], v12 offset:56328
  v_mfma_f32_16x16x32_bf16 v[96:99], v[136:139], a[116:119], v[96:99]
  ds_read_b64_tr_b16 v[178:179], v12 offset:57608
  buffer_load_dwordx4 v8, s[48:51], s7 offen offset:3072 lds
  s_addk_i32 m0, 0x1000
  v_mfma_f32_16x16x32_bf16 v[80:83], v[140:143], a[112:115], v[80:83]
  ds_read_b64_tr_b16 v[180:181], v12 offset:56336
  v_mfma_f32_16x16x32_bf16 v[100:103], v[140:143], a[116:119], v[100:103]
  ds_read_b64_tr_b16 v[182:183], v12 offset:57616
  s_waitcnt lgkmcnt(15)
  v_mfma_f32_16x16x32_bf16 v[84:87], v[144:147], a[112:115], v[84:87]
  ds_read_b64_tr_b16 v[184:185], v12 offset:56344
  v_mfma_f32_16x16x32_bf16 v[104:107], v[144:147], a[116:119], v[104:107]
  ds_read_b64_tr_b16 v[186:187], v12 offset:57624
  buffer_load_dwordx4 v9, s[48:51], s7 offen offset:0 lds
  v_mfma_f32_16x16x32_bf16 v[88:91], v[148:151], a[112:115], v[88:91]
  ds_read_b64_tr_b16 v[188:189], v12 offset:56352
  v_mfma_f32_16x16x32_bf16 v[108:111], v[148:151], a[116:119], v[108:111]
  ds_read_b64_tr_b16 v[190:191], v12 offset:57632
  s_waitcnt lgkmcnt(15)
  v_mfma_f32_16x16x32_bf16 v[32:35], v[152:155], a[120:123], v[32:35]
  v_mfma_f32_16x16x32_bf16 v[52:55], v[152:155], a[124:127], v[52:55]
  s_waitcnt vmcnt(9)
  s_barrier
  v_mfma_f32_16x16x32_bf16 v[36:39], v[156:159], a[120:123], v[36:39]
  ds_read_b128 a[128:131], v10 offset:0
  ds_read_b128 a[132:135], v10 offset:2048
  v_mov_b32 v192, -1
  v_mfma_f32_16x16x32_bf16 v[56:59], v[156:159], a[124:127], v[56:59]
  ds_read_b64_tr_b16 v[112:113], v13 offset:0
  ds_read_b64_tr_b16 v[114:115], v13 offset:1280
  v_mov_b32 v193, -1
  s_waitcnt lgkmcnt(15)
  v_mfma_f32_16x16x32_bf16 v[40:43], v[160:163], a[120:123], v[40:43]
  ds_read_b64_tr_b16 v[116:117], v13 offset:8
  ds_read_b64_tr_b16 v[118:119], v13 offset:1288
  v_mfma_f32_16x16x32_bf16 v[60:63], v[160:163], a[124:127], v[60:63]
  ds_read_b64_tr_b16 v[120:121], v13 offset:16
  ds_read_b64_tr_b16 v[122:123], v13 offset:1296
  v_mov_b32 v194, -1
  v_mfma_f32_16x16x32_bf16 v[44:47], v[164:167], a[120:123], v[44:47]
  ds_read_b64_tr_b16 v[124:125], v13 offset:24
  v_mfma_f32_16x16x32_bf16 v[64:67], v[164:167], a[124:127], v[64:67]
  ds_read_b64_tr_b16 v[126:127], v13 offset:1304
  v_mov_b32 v195, -1
  s_waitcnt lgkmcnt(15)
  v_mfma_f32_16x16x32_bf16 v[48:51], v[168:171], a[120:123], v[48:51]
  ds_read_b64_tr_b16 v[128:129], v13 offset:32
  v_mfma_f32_16x16x32_bf16 v[68:71], v[168:171], a[124:127], v[68:71]
  ds_read_b64_tr_b16 v[130:131], v13 offset:1312
  s_lshl_b32 s70, s5, 2
  v_mfma_f32_16x16x32_bf16 v[72:75], v[172:175], a[120:123], v[72:75]
  ds_read_b64_tr_b16 v[132:133], v13 offset:10240
  s_add_u32 s70, s70, s4
  v_mfma_f32_16x16x32_bf16 v[92:95], v[172:175], a[124:127], v[92:95]
  ds_read_b64_tr_b16 v[134:135], v13 offset:11520
  v_mfma_f32_16x16x32_bf16 v[76:79], v[176:179], a[120:123], v[76:79]
  ds_read_b64_tr_b16 v[136:137], v13 offset:10248
  s_lshl_b32 s70, s70, 4
  v_mfma_f32_16x16x32_bf16 v[96:99], v[176:179], a[124:127], v[96:99]
  ds_read_b64_tr_b16 v[138:139], v13 offset:11528
  s_waitcnt lgkmcnt(15)
  v_mfma_f32_16x16x32_bf16 v[80:83], v[180:183], a[120:123], v[80:83]
  ds_read_b64_tr_b16 v[140:141], v13 offset:10256
  s_add_u32 s70, s70, s10
  v_mfma_f32_16x16x32_bf16 v[100:103], v[180:183], a[124:127], v[100:103]
  ds_read_b64_tr_b16 v[142:143], v13 offset:11536
  v_mfma_f32_16x16x32_bf16 v[84:87], v[184:187], a[120:123], v[84:87]
  ds_read_b64_tr_b16 v[144:145], v13 offset:10264
  s_mul_i32 s70, s70, 2560
  v_mfma_f32_16x16x32_bf16 v[104:107], v[184:187], a[124:127], v[104:107]
  ds_read_b64_tr_b16 v[146:147], v13 offset:11544
  v_mfma_f32_16x16x32_bf16 v[88:91], v[188:191], a[120:123], v[88:91]
  ds_read_b64_tr_b16 v[148:149], v13 offset:10272
  s_add_u32 s70, s70, 1048576
  v_mfma_f32_16x16x32_bf16 v[108:111], v[188:191], a[124:127], v[108:111]
  ds_read_b64_tr_b16 v[150:151], v13 offset:11552
  s_waitcnt lgkmcnt(15)
  v_mfma_f32_16x16x32_bf16 v[32:35], v[112:115], a[128:131], v[32:35]
  ds_read_b128 a[136:139], v11 offset:0
  ds_read_b128 a[140:143], v11 offset:2048
  v_mfma_f32_16x16x32_bf16 v[52:55], v[112:115], a[132:135], v[52:55]
  ds_read_b64_tr_b16 v[152:153], v13 offset:5120
  ds_read_b64_tr_b16 v[154:155], v13 offset:6400
  s_add_u32 s71, s70, 20480
  v_mfma_f32_16x16x32_bf16 v[36:39], v[116:119], a[128:131], v[36:39]
  ds_read_b64_tr_b16 v[156:157], v13 offset:5128
  v_mfma_f32_16x16x32_bf16 v[56:59], v[116:119], a[132:135], v[56:59]
  ds_read_b64_tr_b16 v[158:159], v13 offset:6408
  v_lshlrev_b32 v19, 4, v0
  s_waitcnt lgkmcnt(15)
  v_mfma_f32_16x16x32_bf16 v[40:43], v[120:123], a[128:131], v[40:43]
  ds_read_b64_tr_b16 v[160:161], v13 offset:5136
  v_mfma_f32_16x16x32_bf16 v[60:63], v[120:123], a[132:135], v[60:63]
  ds_read_b64_tr_b16 v[162:163], v13 offset:6416
  v_lshlrev_b32 v20, 3, v0
  v_mfma_f32_16x16x32_bf16 v[44:47], v[124:127], a[128:131], v[44:47]
  ds_read_b64_tr_b16 v[164:165], v13 offset:5144
  v_mfma_f32_16x16x32_bf16 v[64:67], v[124:127], a[132:135], v[64:67]
  ds_read_b64_tr_b16 v[166:167], v13 offset:6424
  v_add_u32 v20, 0x800, v20
  v_mfma_f32_16x16x32_bf16 v[48:51], v[128:131], a[128:131], v[48:51]
  ds_read_b64_tr_b16 v[168:169], v13 offset:5152
  buffer_store_dwordx4 v[192:195], v19, s[52:55], s70 offen sc1
  v_mfma_f32_16x16x32_bf16 v[68:71], v[128:131], a[132:135], v[68:71]
  ds_read_b64_tr_b16 v[170:171], v13 offset:6432
  s_waitcnt lgkmcnt(15)
  v_mfma_f32_16x16x32_bf16 v[72:75], v[132:135], a[128:131], v[72:75]
  ds_read_b64_tr_b16 v[172:173], v13 offset:15360
  buffer_store_dwordx4 v[192:195], v19, s[52:55], s70 offen offset:1024 sc1
  v_mfma_f32_16x16x32_bf16 v[92:95], v[132:135], a[132:135], v[92:95]
  ds_read_b64_tr_b16 v[174:175], v13 offset:16640
  v_mfma_f32_16x16x32_bf16 v[76:79], v[136:139], a[128:131], v[76:79]
  ds_read_b64_tr_b16 v[176:177], v13 offset:15368
  buffer_store_dwordx2 v[192:193], v20, s[52:55], s70 offen sc1
  v_mfma_f32_16x16x32_bf16 v[96:99], v[136:139], a[132:135], v[96:99]
  ds_read_b64_tr_b16 v[178:179], v13 offset:16648
  v_mfma_f32_16x16x32_bf16 v[80:83], v[140:143], a[128:131], v[80:83]
  ds_read_b64_tr_b16 v[180:181], v13 offset:15376
  buffer_store_dwordx4 v[192:195], v19, s[52:55], s71 offen sc1
  v_mfma_f32_16x16x32_bf16 v[100:103], v[140:143], a[132:135], v[100:103]
  ds_read_b64_tr_b16 v[182:183], v13 offset:16656
  s_waitcnt lgkmcnt(15)
  v_mfma_f32_16x16x32_bf16 v[84:87], v[144:147], a[128:131], v[84:87]
  ds_read_b64_tr_b16 v[184:185], v13 offset:15384
  buffer_store_dwordx4 v[192:195], v19, s[52:55], s71 offen offset:1024 sc1
  v_mfma_f32_16x16x32_bf16 v[104:107], v[144:147], a[132:135], v[104:107]
  ds_read_b64_tr_b16 v[186:187], v13 offset:16664
  buffer_store_dwordx2 v[192:193], v20, s[52:55], s71 offen sc1
  v_mfma_f32_16x16x32_bf16 v[88:91], v[148:151], a[128:131], v[88:91]
  ds_read_b64_tr_b16 v[188:189], v13 offset:15392
  v_mfma_f32_16x16x32_bf16 v[108:111], v[148:151], a[132:135], v[108:111]
  ds_read_b64_tr_b16 v[190:191], v13 offset:16672
  s_waitcnt lgkmcnt(15)
  v_mfma_f32_16x16x32_bf16 v[32:35], v[152:155], a[136:139], v[32:35]
  v_mfma_f32_16x16x32_bf16 v[52:55], v[152:155], a[140:143], v[52:55]
  s_waitcnt vmcnt(6)
  s_barrier
  v_mfma_f32_16x16x32_bf16 v[36:39], v[156:159], a[136:139], v[36:39]
  ds_read_b128 a[144:147], v10 offset:4096
  ds_read_b128 a[148:151], v10 offset:6144
  v_mfma_f32_16x16x32_bf16 v[56:59], v[156:159], a[140:143], v[56:59]
  ds_read_b64_tr_b16 v[112:113], v13 offset:20480
  ds_read_b64_tr_b16 v[114:115], v13 offset:21760
  s_waitcnt lgkmcnt(15)
  v_mfma_f32_16x16x32_bf16 v[40:43], v[160:163], a[136:139], v[40:43]
  ds_read_b64_tr_b16 v[116:117], v13 offset:20488
  ds_read_b64_tr_b16 v[118:119], v13 offset:21768
  v_mfma_f32_16x16x32_bf16 v[60:63], v[160:163], a[140:143], v[60:63]
  ds_read_b64_tr_b16 v[120:121], v13 offset:20496
  ds_read_b64_tr_b16 v[122:123], v13 offset:21776
  v_mfma_f32_16x16x32_bf16 v[44:47], v[164:167], a[136:139], v[44:47]
  ds_read_b64_tr_b16 v[124:125], v13 offset:20504
  v_mfma_f32_16x16x32_bf16 v[64:67], v[164:167], a[140:143], v[64:67]
  ds_read_b64_tr_b16 v[126:127], v13 offset:21784
  s_waitcnt lgkmcnt(15)
  v_mfma_f32_16x16x32_bf16 v[48:51], v[168:171], a[136:139], v[48:51]
  ds_read_b64_tr_b16 v[128:129], v13 offset:20512
  v_mfma_f32_16x16x32_bf16 v[68:71], v[168:171], a[140:143], v[68:71]
  ds_read_b64_tr_b16 v[130:131], v13 offset:21792
  v_lshlrev_b32 v19, 2, v0
  s_mov_b32 s11, 4096
  buffer_load_dword v22, v19, s[52:55], s11 offen sc1
  v_mfma_f32_16x16x32_bf16 v[72:75], v[172:175], a[136:139], v[72:75]
  ds_read_b64_tr_b16 v[132:133], v13 offset:30720
  v_mfma_f32_16x16x32_bf16 v[92:95], v[172:175], a[140:143], v[92:95]
  ds_read_b64_tr_b16 v[134:135], v13 offset:32000
  v_mfma_f32_16x16x32_bf16 v[76:79], v[176:179], a[136:139], v[76:79]
  ds_read_b64_tr_b16 v[136:137], v13 offset:30728
  v_mfma_f32_16x16x32_bf16 v[96:99], v[176:179], a[140:143], v[96:99]
  ds_read_b64_tr_b16 v[138:139], v13 offset:32008
  s_waitcnt lgkmcnt(15)
  v_mfma_f32_16x16x32_bf16 v[80:83], v[180:183], a[136:139], v[80:83]
  ds_read_b64_tr_b16 v[140:141], v13 offset:30736
  v_mfma_f32_16x16x32_bf16 v[100:103], v[180:183], a[140:143], v[100:103]
  ds_read_b64_tr_b16 v[142:143], v13 offset:32016
  v_mfma_f32_16x16x32_bf16 v[84:87], v[184:187], a[136:139], v[84:87]
  ds_read_b64_tr_b16 v[144:145], v13 offset:30744
  global_load_dword v1, v19, s[34:35] offset:0
  v_mfma_f32_16x16x32_bf16 v[104:107], v[184:187], a[140:143], v[104:107]
  ds_read_b64_tr_b16 v[146:147], v13 offset:32024
  v_mfma_f32_16x16x32_bf16 v[88:91], v[188:191], a[136:139], v[88:91]
  ds_read_b64_tr_b16 v[148:149], v13 offset:30752
  v_mfma_f32_16x16x32_bf16 v[108:111], v[188:191], a[140:143], v[108:111]
  ds_read_b64_tr_b16 v[150:151], v13 offset:32032
  s_waitcnt lgkmcnt(15)
  v_mfma_f32_16x16x32_bf16 v[32:35], v[112:115], a[144:147], v[32:35]
  ds_read_b128 a[152:155], v11 offset:4096
  ds_read_b128 a[156:159], v11 offset:6144
  v_mfma_f32_16x16x32_bf16 v[52:55], v[112:115], a[148:151], v[52:55]
  ds_read_b64_tr_b16 v[152:153], v13 offset:25600
  ds_read_b64_tr_b16 v[154:155], v13 offset:26880
  v_mfma_f32_16x16x32_bf16 v[36:39], v[116:119], a[144:147], v[36:39]
  ds_read_b64_tr_b16 v[156:157], v13 offset:25608
  v_mfma_f32_16x16x32_bf16 v[56:59], v[116:119], a[148:151], v[56:59]
  ds_read_b64_tr_b16 v[158:159], v13 offset:26888
  global_load_dword v2, v19, s[34:35] offset:256
  s_waitcnt lgkmcnt(15)
  v_mfma_f32_16x16x32_bf16 v[40:43], v[120:123], a[144:147], v[40:43]
  ds_read_b64_tr_b16 v[160:161], v13 offset:25616
  v_mfma_f32_16x16x32_bf16 v[60:63], v[120:123], a[148:151], v[60:63]
  ds_read_b64_tr_b16 v[162:163], v13 offset:26896
  v_mfma_f32_16x16x32_bf16 v[44:47], v[124:127], a[144:147], v[44:47]
  ds_read_b64_tr_b16 v[164:165], v13 offset:25624
  v_mfma_f32_16x16x32_bf16 v[64:67], v[124:127], a[148:151], v[64:67]
  ds_read_b64_tr_b16 v[166:167], v13 offset:26904
  v_mfma_f32_16x16x32_bf16 v[48:51], v[128:131], a[144:147], v[48:51]
  ds_read_b64_tr_b16 v[168:169], v13 offset:25632
  v_mfma_f32_16x16x32_bf16 v[68:71], v[128:131], a[148:151], v[68:71]
  ds_read_b64_tr_b16 v[170:171], v13 offset:26912
  s_waitcnt lgkmcnt(15)
  v_mfma_f32_16x16x32_bf16 v[72:75], v[132:135], a[144:147], v[72:75]
  ds_read_b64_tr_b16 v[172:173], v13 offset:35840
  global_load_dword v3, v19, s[34:35] offset:512
  v_mfma_f32_16x16x32_bf16 v[92:95], v[132:135], a[148:151], v[92:95]
  ds_read_b64_tr_b16 v[174:175], v13 offset:37120
  v_mfma_f32_16x16x32_bf16 v[76:79], v[136:139], a[144:147], v[76:79]
  ds_read_b64_tr_b16 v[176:177], v13 offset:35848
  v_mfma_f32_16x16x32_bf16 v[96:99], v[136:139], a[148:151], v[96:99]
  ds_read_b64_tr_b16 v[178:179], v13 offset:37128
  v_mfma_f32_16x16x32_bf16 v[80:83], v[140:143], a[144:147], v[80:83]
  ds_read_b64_tr_b16 v[180:181], v13 offset:35856
  v_mfma_f32_16x16x32_bf16 v[100:103], v[140:143], a[148:151], v[100:103]
  ds_read_b64_tr_b16 v[182:183], v13 offset:37136
  s_waitcnt lgkmcnt(15)
  v_mfma_f32_16x16x32_bf16 v[84:87], v[144:147], a[144:147], v[84:87]
  ds_read_b64_tr_b16 v[184:185], v13 offset:35864
  v_mfma_f32_16x16x32_bf16 v[104:107], v[144:147], a[148:151], v[104:107]
  ds_read_b64_tr_b16 v[186:187], v13 offset:37144
  global_load_dword v4, v19, s[34:35] offset:768
  v_mfma_f32_16x16x32_bf16 v[88:91], v[148:151], a[144:147], v[88:91]
  ds_read_b64_tr_b16 v[188:189], v13 offset:35872
  v_mfma_f32_16x16x32_bf16 v[108:111], v[148:151], a[148:151], v[108:111]
  ds_read_b64_tr_b16 v[190:191], v13 offset:37152
  s_waitcnt lgkmcnt(15)
  v_mfma_f32_16x16x32_bf16 v[32:35], v[152:155], a[152:155], v[32:35]
  v_mfma_f32_16x16x32_bf16 v[52:55], v[152:155], a[156:159], v[52:55]
  v_mfma_f32_16x16x32_bf16 v[36:39], v[156:159], a[152:155], v[36:39]
  v_mfma_f32_16x16x32_bf16 v[56:59], v[156:159], a[156:159], v[56:59]
  s_waitcnt lgkmcnt(14)
  v_mfma_f32_16x16x32_bf16 v[40:43], v[160:163], a[152:155], v[40:43]
  v_mfma_f32_16x16x32_bf16 v[60:63], v[160:163], a[156:159], v[60:63]
  s_waitcnt lgkmcnt(12)
  v_mfma_f32_16x16x32_bf16 v[44:47], v[164:167], a[152:155], v[44:47]
  v_mfma_f32_16x16x32_bf16 v[64:67], v[164:167], a[156:159], v[64:67]
  s_waitcnt lgkmcnt(10)
  v_mfma_f32_16x16x32_bf16 v[48:51], v[168:171], a[152:155], v[48:51]
  v_mfma_f32_16x16x32_bf16 v[68:71], v[168:171], a[156:159], v[68:71]
  s_waitcnt lgkmcnt(8)
  v_mfma_f32_16x16x32_bf16 v[72:75], v[172:175], a[152:155], v[72:75]
  v_mfma_f32_16x16x32_bf16 v[92:95], v[172:175], a[156:159], v[92:95]
  s_waitcnt lgkmcnt(6)
  v_mfma_f32_16x16x32_bf16 v[76:79], v[176:179], a[152:155], v[76:79]
  v_mfma_f32_16x16x32_bf16 v[96:99], v[176:179], a[156:159], v[96:99]
  s_waitcnt lgkmcnt(4)
  v_mfma_f32_16x16x32_bf16 v[80:83], v[180:183], a[152:155], v[80:83]
  v_mfma_f32_16x16x32_bf16 v[100:103], v[180:183], a[156:159], v[100:103]
  s_waitcnt lgkmcnt(2)
  v_mfma_f32_16x16x32_bf16 v[84:87], v[184:187], a[152:155], v[84:87]
  v_mfma_f32_16x16x32_bf16 v[104:107], v[184:187], a[156:159], v[104:107]
  s_waitcnt lgkmcnt(0)
  v_mfma_f32_16x16x32_bf16 v[88:91], v[188:191], a[152:155], v[88:91]
  v_mfma_f32_16x16x32_bf16 v[108:111], v[188:191], a[156:159], v[108:111]
  s_barrier
  v_cvt_pk_bf16_f32 v32, v32, v33
  v_cvt_pk_bf16_f32 v33, v34, v35
  v_cvt_pk_bf16_f32 v34, v36, v37
  v_cvt_pk_bf16_f32 v35, v38, v39
  v_cvt_pk_bf16_f32 v36, v40, v41
  v_cvt_pk_bf16_f32 v37, v42, v43
  v_cvt_pk_bf16_f32 v38, v44, v45
  v_cvt_pk_bf16_f32 v39, v46, v47
  v_cvt_pk_bf16_f32 v40, v48, v49
  v_cvt_pk_bf16_f32 v41, v50, v51
  v_mfma_f32_16x16x32_bf16 v[204:207], a[160:163], v[32:35], 0
  v_cvt_pk_bf16_f32 v52, v52, v53
  v_cvt_pk_bf16_f32 v53, v54, v55
  v_mfma_f32_16x16x32_bf16 v[208:211], a[172:175], v[32:35], 0
  v_cvt_pk_bf16_f32 v54, v56, v57
  v_cvt_pk_bf16_f32 v55, v58, v59
  v_mfma_f32_16x16x32_bf16 v[212:215], a[184:187], v[32:35], 0
  v_cvt_pk_bf16_f32 v56, v60, v61
  v_cvt_pk_bf16_f32 v57, v62, v63
  v_mfma_f32_16x16x32_bf16 v[216:219], a[196:199], v[32:35], 0
  v_cvt_pk_bf16_f32 v58, v64, v65
  v_cvt_pk_bf16_f32 v59, v66, v67
  v_mfma_f32_16x16x32_bf16 v[220:223], a[208:211], v[32:35], 0
  v_cvt_pk_bf16_f32 v60, v68, v69
  v_cvt_pk_bf16_f32 v61, v70, v71
  v_mfma_f32_16x16x32_bf16 v[204:207], a[164:167], v[36:39], v[204:207]
  v_cvt_pk_bf16_f32 v72, v72, v73
  v_cvt_pk_bf16_f32 v73, v74, v75
  v_mfma_f32_16x16x32_bf16 v[208:211], a[176:179], v[36:39], v[208:211]
  v_cvt_pk_bf16_f32 v74, v76, v77
  v_cvt_pk_bf16_f32 v75, v78, v79
  v_mfma_f32_16x16x32_bf16 v[212:215], a[188:191], v[36:39], v[212:215]
  v_cvt_pk_bf16_f32 v76, v80, v81
  v_cvt_pk_bf16_f32 v77, v82, v83
  v_mfma_f32_16x16x32_bf16 v[216:219], a[200:203], v[36:39], v[216:219]
  v_cvt_pk_bf16_f32 v78, v84, v85
  v_cvt_pk_bf16_f32 v79, v86, v87
  v_mfma_f32_16x16x32_bf16 v[220:223], a[212:215], v[36:39], v[220:223]
  v_cvt_pk_bf16_f32 v80, v88, v89
  v_cvt_pk_bf16_f32 v81, v90, v91
  v_mfma_f32_16x16x32_bf16 v[204:207], a[168:171], v[38:41], v[204:207]
  v_mov_b32 v82, v28
  v_mov_b32 v83, 0
  v_mfma_f32_16x16x32_bf16 v[208:211], a[180:183], v[38:41], v[208:211]
  v_cvt_pk_bf16_f32 v92, v92, v93
  v_cvt_pk_bf16_f32 v93, v94, v95
  v_mfma_f32_16x16x32_bf16 v[212:215], a[192:195], v[38:41], v[212:215]
  v_cvt_pk_bf16_f32 v94, v96, v97
  v_cvt_pk_bf16_f32 v95, v98, v99
  v_mfma_f32_16x16x32_bf16 v[216:219], a[204:207], v[38:41], v[216:219]
  v_cvt_pk_bf16_f32 v96, v100, v101
  v_cvt_pk_bf16_f32 v97, v102, v103
  v_mfma_f32_16x16x32_bf16 v[220:223], a[216:219], v[38:41], v[220:223]
  v_cvt_pk_bf16_f32 v98, v104, v105
  v_cvt_pk_bf16_f32 v99, v106, v107
  v_cvt_pk_bf16_f32 v100, v108, v109
  v_cvt_pk_bf16_f32 v101, v110, v111
  v_mov_b32 v102, v28
  v_mov_b32 v103, 0
  v_max3_f32 v244, v204, v205, v206
  v_max3_f32 v244, v244, v207, v208
  v_max3_f32 v244, v244, v209, v210
  v_max3_f32 v244, v244, v211, v212
  v_max3_f32 v244, v244, v213, v214
  v_max3_f32 v244, v244, v215, v216
  v_max3_f32 v244, v244, v217, v218
  s_add_u32 m0, s3, 67584
  s_add_u32 s7, s63, 0
  v_max3_f32 v244, v244, v219, v220
  v_max3_f32 v244, v244, v221, v222
  v_max_f32 v244, v244, v223
  v_min3_f32 v245, v204, v205, v206
  v_min3_f32 v245, v245, v207, v208
  v_min3_f32 v245, v245, v209, v210
  v_min3_f32 v245, v245, v211, v212
  v_min3_f32 v245, v245, v213, v214
  v_min3_f32 v245, v245, v215, v216
  v_min3_f32 v245, v245, v217, v218
  v_min3_f32 v245, v245, v219, v220
  v_min3_f32 v245, v245, v221, v222
  v_min_f32 v245, v245, v223
  ds_write_b128 v27, v[72:75] offset:320
  v_mul_f32 v246, s12, v244
  v_mul_f32 v247, s12, v245
  v_pk_fma_f32 v[112:113], v[204:205], s[12:13], v[246:247] op_sel_hi:[1,1,0] neg_lo:[0,0,1] neg_hi:[0,0,1]
  v_pk_fma_f32 v[114:115], v[206:207], s[12:13], v[246:247] op_sel_hi:[1,1,0] neg_lo:[0,0,1] neg_hi:[0,0,1]
  v_pk_fma_f32 v[116:117], v[208:209], s[12:13], v[246:247] op_sel_hi:[1,1,0] neg_lo:[0,0,1] neg_hi:[0,0,1]
  v_pk_fma_f32 v[118:119], v[210:211], s[12:13], v[246:247] op_sel_hi:[1,1,0] neg_lo:[0,0,1] neg_hi:[0,0,1]
  v_pk_fma_f32 v[120:121], v[212:213], s[12:13], v[246:247] op_sel_hi:[1,1,0] neg_lo:[0,0,1] neg_hi:[0,0,1]
  v_pk_fma_f32 v[122:123], v[214:215], s[12:13], v[246:247] op_sel_hi:[1,1,0] neg_lo:[0,0,1] neg_hi:[0,0,1]
  v_pk_fma_f32 v[124:125], v[216:217], s[12:13], v[246:247] op_sel_hi:[1,1,0] neg_lo:[0,0,1] neg_hi:[0,0,1]
  v_pk_fma_f32 v[126:127], v[218:219], s[12:13], v[246:247] op_sel_hi:[1,1,0] neg_lo:[0,0,1] neg_hi:[0,0,1]
  v_pk_fma_f32 v[128:129], v[220:221], s[12:13], v[246:247] op_sel_hi:[1,1,0] neg_lo:[0,0,1] neg_hi:[0,0,1]
  v_pk_fma_f32 v[130:131], v[222:223], s[12:13], v[246:247] op_sel_hi:[1,1,0] neg_lo:[0,0,1] neg_hi:[0,0,1]
  buffer_load_dwordx4 v5, s[48:51], s7 offen offset:0 lds
  v_pk_fma_f32 v[132:133], v[204:205], s[12:13], v[246:247] op_sel:[0,0,1] op_sel_hi:[1,1,1] neg_lo:[1,0,0] neg_hi:[1,0,0]
  v_pk_fma_f32 v[134:135], v[206:207], s[12:13], v[246:247] op_sel:[0,0,1] op_sel_hi:[1,1,1] neg_lo:[1,0,0] neg_hi:[1,0,0]
  v_pk_fma_f32 v[136:137], v[208:209], s[12:13], v[246:247] op_sel:[0,0,1] op_sel_hi:[1,1,1] neg_lo:[1,0,0] neg_hi:[1,0,0]
  v_pk_fma_f32 v[138:139], v[210:211], s[12:13], v[246:247] op_sel:[0,0,1] op_sel_hi:[1,1,1] neg_lo:[1,0,0] neg_hi:[1,0,0]
  v_pk_fma_f32 v[140:141], v[212:213], s[12:13], v[246:247] op_sel:[0,0,1] op_sel_hi:[1,1,1] neg_lo:[1,0,0] neg_hi:[1,0,0]
  v_pk_fma_f32 v[142:143], v[214:215], s[12:13], v[246:247] op_sel:[0,0,1] op_sel_hi:[1,1,1] neg_lo:[1,0,0] neg_hi:[1,0,0]
  v_pk_fma_f32 v[144:145], v[216:217], s[12:13], v[246:247] op_sel:[0,0,1] op_sel_hi:[1,1,1] neg_lo:[1,0,0] neg_hi:[1,0,0]
  v_pk_fma_f32 v[146:147], v[218:219], s[12:13], v[246:247] op_sel:[0,0,1] op_sel_hi:[1,1,1] neg_lo:[1,0,0] neg_hi:[1,0,0]
  v_pk_fma_f32 v[148:149], v[220:221], s[12:13], v[246:247] op_sel:[0,0,1] op_sel_hi:[1,1,1] neg_lo:[1,0,0] neg_hi:[1,0,0]
  v_pk_fma_f32 v[150:151], v[222:223], s[12:13], v[246:247] op_sel:[0,0,1] op_sel_hi:[1,1,1] neg_lo:[1,0,0] neg_hi:[1,0,0]
  v_mfma_f32_16x16x32_bf16 v[152:155], a[160:163], v[52:55], 0
  v_exp_f32 v112, v112
  buffer_load_dwordx4 v6, s[48:51], s7 offen offset:1024 lds
  v_exp_f32 v113, v113
  v_mfma_f32_16x16x32_bf16 v[156:159], a[172:175], v[52:55], 0
  v_exp_f32 v114, v114
  v_exp_f32 v115, v115
  v_mfma_f32_16x16x32_bf16 v[160:163], a[184:187], v[52:55], 0
  v_exp_f32 v116, v116
  ds_write_b128 v27, v[76:79] offset:336
  v_exp_f32 v117, v117
  v_exp_f32 v118, v118
  v_mfma_f32_16x16x32_bf16 v[164:167], a[196:199], v[52:55], 0
  v_exp_f32 v119, v119
  v_exp_f32 v120, v120
  v_mfma_f32_16x16x32_bf16 v[168:171], a[208:211], v[52:55], 0
  buffer_load_dwordx4 v7, s[48:51], s7 offen offset:2048 lds
  v_exp_f32 v121, v121
  v_exp_f32 v122, v122
  v_exp_f32 v123, v123
  v_mfma_f32_16x16x32_bf16 v[152:155], a[164:167], v[56:59], v[152:155]
  v_exp_f32 v124, v124
  v_exp_f32 v125, v125
  v_mfma_f32_16x16x32_bf16 v[156:159], a[176:179], v[56:59], v[156:159]
  buffer_load_dwordx4 v8, s[48:51], s7 offen offset:3072 lds
  s_addk_i32 m0, 0x1000
  v_exp_f32 v126, v126
  v_exp_f32 v127, v127
  v_mfma_f32_16x16x32_bf16 v[160:163], a[188:191], v[56:59], v[160:163]
  v_exp_f32 v128, v128
  v_exp_f32 v129, v129
  v_exp_f32 v130, v130
  ds_write_b128 v27, v[80:83] offset:352
  v_mfma_f32_16x16x32_bf16 v[164:167], a[200:203], v[56:59], v[164:167]
  v_exp_f32 v131, v131
  v_exp_f32 v132, v132
  v_mfma_f32_16x16x32_bf16 v[168:171], a[212:215], v[56:59], v[168:171]
  v_exp_f32 v133, v133
  v_exp_f32 v134, v134
  buffer_load_dwordx4 v9, s[48:51], s7 offen offset:0 lds
  s_add_u32 m0, s3, 88064
  s_add_u32 s7, s63, 491520
  v_exp_f32 v135, v135
  v_mfma_f32_16x16x32_bf16 v[152:155], a[168:171], v[58:61], v[152:155]
  v_exp_f32 v136, v136
  v_exp_f32 v137, v137
  v_mfma_f32_16x16x32_bf16 v[156:159], a[180:183], v[58:61], v[156:159]
  v_exp_f32 v138, v138
  v_exp_f32 v139, v139
  ds_write_b128 v27, v[92:95] offset:8768
  v_mfma_f32_16x16x32_bf16 v[160:163], a[192:195], v[58:61], v[160:163]
  v_exp_f32 v140, v140
  v_exp_f32 v141, v141
  v_exp_f32 v142, v142
  v_mfma_f32_16x16x32_bf16 v[164:167], a[204:207], v[58:61], v[164:167]
  v_exp_f32 v143, v143
  buffer_load_dwordx4 v5, s[48:51], s7 offen offset:0 lds
  v_exp_f32 v144, v144
  v_mfma_f32_16x16x32_bf16 v[168:171], a[216:219], v[58:61], v[168:171]
  v_exp_f32 v145, v145
  v_exp_f32 v146, v146
  v_exp_f32 v147, v147
  v_exp_f32 v148, v148
  v_exp_f32 v149, v149
  buffer_load_dwordx4 v6, s[48:51], s7 offen offset:1024 lds
  v_exp_f32 v150, v150
  v_exp_f32 v151, v151
  v_pk_add_f32 v[248:249], v[112:113], v[114:115]
  v_pk_add_f32 v[248:249], v[248:249], v[116:117]
  v_pk_add_f32 v[248:249], v[248:249], v[118:119]
  v_pk_add_f32 v[248:249], v[248:249], v[120:121]
  v_pk_add_f32 v[248:249], v[248:249], v[122:123]
  v_pk_add_f32 v[248:249], v[248:249], v[124:125]
  v_pk_add_f32 v[248:249], v[248:249], v[126:127]
  ds_write_b128 v27, v[96:99] offset:8784
  v_pk_add_f32 v[248:249], v[248:249], v[128:129]
  v_pk_add_f32 v[248:249], v[248:249], v[130:131]
  v_add_f32 v248, v248, v249
  v_pk_add_f32 v[250:251], v[132:133], v[134:135]
  v_pk_add_f32 v[250:251], v[250:251], v[136:137]
  v_pk_add_f32 v[250:251], v[250:251], v[138:139]
  v_pk_add_f32 v[250:251], v[250:251], v[140:141]
  v_pk_add_f32 v[250:251], v[250:251], v[142:143]
  v_pk_add_f32 v[250:251], v[250:251], v[144:145]
  v_pk_add_f32 v[250:251], v[250:251], v[146:147]
  v_pk_add_f32 v[250:251], v[250:251], v[148:149]
  v_pk_add_f32 v[250:251], v[250:251], v[150:151]
  v_add_f32 v250, v250, v251
  buffer_load_dwordx4 v7, s[48:51], s7 offen offset:2048 lds
  v_rcp_f32 v248, v248
  v_rcp_f32 v250, v250
  v_pk_mul_f32 v[112:113], v[112:113], v[248:249] op_sel_hi:[1,0]
  v_pk_mul_f32 v[114:115], v[114:115], v[248:249] op_sel_hi:[1,0]
  v_pk_mul_f32 v[116:117], v[116:117], v[248:249] op_sel_hi:[1,0]
  v_pk_mul_f32 v[118:119], v[118:119], v[248:249] op_sel_hi:[1,0]
  v_pk_mul_f32 v[120:121], v[120:121], v[248:249] op_sel_hi:[1,0]
  v_pk_mul_f32 v[122:123], v[122:123], v[248:249] op_sel_hi:[1,0]
  v_pk_mul_f32 v[124:125], v[124:125], v[248:249] op_sel_hi:[1,0]
  v_pk_mul_f32 v[126:127], v[126:127], v[248:249] op_sel_hi:[1,0]
  v_pk_mul_f32 v[128:129], v[128:129], v[248:249] op_sel_hi:[1,0]
  buffer_load_dwordx4 v8, s[48:51], s7 offen offset:3072 lds
  s_addk_i32 m0, 0x1000
  v_pk_mul_f32 v[130:131], v[130:131], v[248:249] op_sel_hi:[1,0]
  v_pk_mul_f32 v[132:133], v[132:133], v[250:251] op_sel_hi:[1,0]
  v_pk_mul_f32 v[134:135], v[134:135], v[250:251] op_sel_hi:[1,0]
  v_pk_mul_f32 v[136:137], v[136:137], v[250:251] op_sel_hi:[1,0]
  v_pk_mul_f32 v[138:139], v[138:139], v[250:251] op_sel_hi:[1,0]
  v_pk_mul_f32 v[140:141], v[140:141], v[250:251] op_sel_hi:[1,0]
  v_pk_mul_f32 v[142:143], v[142:143], v[250:251] op_sel_hi:[1,0]
  v_pk_mul_f32 v[144:145], v[144:145], v[250:251] op_sel_hi:[1,0]
  v_pk_mul_f32 v[146:147], v[146:147], v[250:251] op_sel_hi:[1,0]
  v_pk_mul_f32 v[148:149], v[148:149], v[250:251] op_sel_hi:[1,0]
  v_pk_mul_f32 v[150:151], v[150:151], v[250:251] op_sel_hi:[1,0]
  v_cvt_pk_bf16_f32 v224, v112, v113
  ds_write_b128 v27, v[100:103] offset:8800
  v_cvt_pk_bf16_f32 v225, v114, v115
  v_cvt_pk_bf16_f32 v226, v116, v117
  v_cvt_pk_bf16_f32 v227, v118, v119
  v_cvt_pk_bf16_f32 v228, v120, v121
  v_cvt_pk_bf16_f32 v229, v122, v123
  v_cvt_pk_bf16_f32 v230, v124, v125
  v_cvt_pk_bf16_f32 v231, v126, v127
  v_cvt_pk_bf16_f32 v232, v128, v129
  v_cvt_pk_bf16_f32 v233, v130, v131
  v_cvt_pk_bf16_f32 v234, v132, v133
  v_cvt_pk_bf16_f32 v235, v134, v135
  v_cvt_pk_bf16_f32 v236, v136, v137
  v_cvt_pk_bf16_f32 v237, v138, v139
  buffer_load_dwordx4 v9, s[48:51], s7 offen offset:0 lds
  s_add_u32 m0, s3, 108544
  s_add_u32 s7, s63, 983040
  v_cvt_pk_bf16_f32 v238, v140, v141
  v_cvt_pk_bf16_f32 v239, v142, v143
  v_cvt_pk_bf16_f32 v240, v144, v145
  v_cvt_pk_bf16_f32 v241, v146, v147
  v_cvt_pk_bf16_f32 v242, v148, v149
  v_cvt_pk_bf16_f32 v243, v150, v151
  v_max3_f32 v244, v152, v153, v154
  v_max3_f32 v244, v244, v155, v156
  v_max3_f32 v244, v244, v157, v158
  v_max3_f32 v244, v244, v159, v160
  v_max3_f32 v244, v244, v161, v162
  v_max3_f32 v244, v244, v163, v164
  buffer_load_dwordx4 v5, s[48:51], s7 offen offset:0 lds
  v_max3_f32 v244, v244, v165, v166
  v_max3_f32 v244, v244, v167, v168
  v_max3_f32 v244, v244, v169, v170
  v_max_f32 v244, v244, v171
  v_min3_f32 v245, v152, v153, v154
  v_min3_f32 v245, v245, v155, v156
  v_min3_f32 v245, v245, v157, v158
  v_min3_f32 v245, v245, v159, v160
  v_min3_f32 v245, v245, v161, v162
  v_min3_f32 v245, v245, v163, v164
  v_min3_f32 v245, v245, v165, v166
  v_min3_f32 v245, v245, v167, v168
  ds_write_b128 v15, v[224:227] offset:0
  v_min3_f32 v245, v245, v169, v170
  v_min_f32 v245, v245, v171
  v_mul_f32 v246, s12, v244
  v_mul_f32 v247, s12, v245
  v_pk_fma_f32 v[112:113], v[152:153], s[12:13], v[246:247] op_sel_hi:[1,1,0] neg_lo:[0,0,1] neg_hi:[0,0,1]
  v_pk_fma_f32 v[114:115], v[154:155], s[12:13], v[246:247] op_sel_hi:[1,1,0] neg_lo:[0,0,1] neg_hi:[0,0,1]
  v_pk_fma_f32 v[116:117], v[156:157], s[12:13], v[246:247] op_sel_hi:[1,1,0] neg_lo:[0,0,1] neg_hi:[0,0,1]
  v_pk_fma_f32 v[118:119], v[158:159], s[12:13], v[246:247] op_sel_hi:[1,1,0] neg_lo:[0,0,1] neg_hi:[0,0,1]
  v_pk_fma_f32 v[120:121], v[160:161], s[12:13], v[246:247] op_sel_hi:[1,1,0] neg_lo:[0,0,1] neg_hi:[0,0,1]
  v_pk_fma_f32 v[122:123], v[162:163], s[12:13], v[246:247] op_sel_hi:[1,1,0] neg_lo:[0,0,1] neg_hi:[0,0,1]
  v_pk_fma_f32 v[124:125], v[164:165], s[12:13], v[246:247] op_sel_hi:[1,1,0] neg_lo:[0,0,1] neg_hi:[0,0,1]
  buffer_load_dwordx4 v6, s[48:51], s7 offen offset:1024 lds
  v_pk_fma_f32 v[126:127], v[166:167], s[12:13], v[246:247] op_sel_hi:[1,1,0] neg_lo:[0,0,1] neg_hi:[0,0,1]
  v_pk_fma_f32 v[128:129], v[168:169], s[12:13], v[246:247] op_sel_hi:[1,1,0] neg_lo:[0,0,1] neg_hi:[0,0,1]
  v_pk_fma_f32 v[130:131], v[170:171], s[12:13], v[246:247] op_sel_hi:[1,1,0] neg_lo:[0,0,1] neg_hi:[0,0,1]
  v_pk_fma_f32 v[132:133], v[152:153], s[12:13], v[246:247] op_sel:[0,0,1] op_sel_hi:[1,1,1] neg_lo:[1,0,0] neg_hi:[1,0,0]
  v_pk_fma_f32 v[134:135], v[154:155], s[12:13], v[246:247] op_sel:[0,0,1] op_sel_hi:[1,1,1] neg_lo:[1,0,0] neg_hi:[1,0,0]
  v_pk_fma_f32 v[136:137], v[156:157], s[12:13], v[246:247] op_sel:[0,0,1] op_sel_hi:[1,1,1] neg_lo:[1,0,0] neg_hi:[1,0,0]
  v_pk_fma_f32 v[138:139], v[158:159], s[12:13], v[246:247] op_sel:[0,0,1] op_sel_hi:[1,1,1] neg_lo:[1,0,0] neg_hi:[1,0,0]
  v_pk_fma_f32 v[140:141], v[160:161], s[12:13], v[246:247] op_sel:[0,0,1] op_sel_hi:[1,1,1] neg_lo:[1,0,0] neg_hi:[1,0,0]
  v_pk_fma_f32 v[142:143], v[162:163], s[12:13], v[246:247] op_sel:[0,0,1] op_sel_hi:[1,1,1] neg_lo:[1,0,0] neg_hi:[1,0,0]
  v_pk_fma_f32 v[144:145], v[164:165], s[12:13], v[246:247] op_sel:[0,0,1] op_sel_hi:[1,1,1] neg_lo:[1,0,0] neg_hi:[1,0,0]
  v_pk_fma_f32 v[146:147], v[166:167], s[12:13], v[246:247] op_sel:[0,0,1] op_sel_hi:[1,1,1] neg_lo:[1,0,0] neg_hi:[1,0,0]
  v_pk_fma_f32 v[148:149], v[168:169], s[12:13], v[246:247] op_sel:[0,0,1] op_sel_hi:[1,1,1] neg_lo:[1,0,0] neg_hi:[1,0,0]
  buffer_load_dwordx4 v7, s[48:51], s7 offen offset:2048 lds
  v_pk_fma_f32 v[150:151], v[170:171], s[12:13], v[246:247] op_sel:[0,0,1] op_sel_hi:[1,1,1] neg_lo:[1,0,0] neg_hi:[1,0,0]
  v_exp_f32 v112, v112
  v_exp_f32 v113, v113
  v_exp_f32 v114, v114
  v_exp_f32 v115, v115
  v_exp_f32 v116, v116
  ds_write_b128 v15, v[228:231] offset:16
  v_exp_f32 v117, v117
  v_exp_f32 v118, v118
  v_exp_f32 v119, v119
  v_exp_f32 v120, v120
  v_exp_f32 v121, v121
  v_exp_f32 v122, v122
  buffer_load_dwordx4 v8, s[48:51], s7 offen offset:3072 lds
  s_addk_i32 m0, 0x1000
  v_exp_f32 v123, v123
  v_exp_f32 v124, v124
  v_exp_f32 v125, v125
  v_exp_f32 v126, v126
  v_exp_f32 v127, v127
  v_exp_f32 v128, v128
  buffer_load_dwordx4 v9, s[48:51], s7 offen offset:0 lds
  s_add_u32 m0, s3, 129024
  s_add_u32 s7, s63, 1474560
  v_exp_f32 v129, v129
  v_exp_f32 v130, v130
  v_exp_f32 v131, v131
  v_exp_f32 v132, v132
  v_exp_f32 v133, v133
  v_exp_f32 v134, v134
  ds_write_b128 v15, v[232:235] offset:32
  v_exp_f32 v135, v135
  v_exp_f32 v136, v136
  v_exp_f32 v137, v137
  v_exp_f32 v138, v138
  v_exp_f32 v139, v139
  v_exp_f32 v140, v140
  buffer_load_dwordx4 v5, s[48:51], s7 offen offset:0 lds
  v_exp_f32 v141, v141
  v_exp_f32 v142, v142
  v_exp_f32 v143, v143
  v_exp_f32 v144, v144
  v_exp_f32 v145, v145
  buffer_load_dwordx4 v6, s[48:51], s7 offen offset:1024 lds
  v_exp_f32 v146, v146
  v_exp_f32 v147, v147
  v_exp_f32 v148, v148
  v_exp_f32 v149, v149
  v_exp_f32 v150, v150
  v_exp_f32 v151, v151
  ds_write_b128 v15, v[236:239] offset:48
  v_pk_add_f32 v[248:249], v[112:113], v[114:115]
  v_pk_add_f32 v[248:249], v[248:249], v[116:117]
  v_pk_add_f32 v[248:249], v[248:249], v[118:119]
  v_pk_add_f32 v[248:249], v[248:249], v[120:121]
  v_pk_add_f32 v[248:249], v[248:249], v[122:123]
  v_pk_add_f32 v[248:249], v[248:249], v[124:125]
  v_pk_add_f32 v[248:249], v[248:249], v[126:127]
  v_pk_add_f32 v[248:249], v[248:249], v[128:129]
  v_pk_add_f32 v[248:249], v[248:249], v[130:131]
  v_add_f32 v248, v248, v249
  v_pk_add_f32 v[250:251], v[132:133], v[134:135]
  buffer_load_dwordx4 v7, s[48:51], s7 offen offset:2048 lds
  v_pk_add_f32 v[250:251], v[250:251], v[136:137]
  v_pk_add_f32 v[250:251], v[250:251], v[138:139]
  v_pk_add_f32 v[250:251], v[250:251], v[140:141]
  v_pk_add_f32 v[250:251], v[250:251], v[142:143]
  v_pk_add_f32 v[250:251], v[250:251], v[144:145]
  v_pk_add_f32 v[250:251], v[250:251], v[146:147]
  v_pk_add_f32 v[250:251], v[250:251], v[148:149]
  v_pk_add_f32 v[250:251], v[250:251], v[150:151]
  v_add_f32 v250, v250, v251
  v_rcp_f32 v248, v248
  v_rcp_f32 v250, v250
  buffer_load_dwordx4 v8, s[48:51], s7 offen offset:3072 lds
  s_addk_i32 m0, 0x1000
  v_pk_mul_f32 v[112:113], v[112:113], v[248:249] op_sel_hi:[1,0]
  v_pk_mul_f32 v[114:115], v[114:115], v[248:249] op_sel_hi:[1,0]
  v_pk_mul_f32 v[116:117], v[116:117], v[248:249] op_sel_hi:[1,0]
  v_pk_mul_f32 v[118:119], v[118:119], v[248:249] op_sel_hi:[1,0]
  v_pk_mul_f32 v[120:121], v[120:121], v[248:249] op_sel_hi:[1,0]
  v_pk_mul_f32 v[122:123], v[122:123], v[248:249] op_sel_hi:[1,0]
  v_pk_mul_f32 v[124:125], v[124:125], v[248:249] op_sel_hi:[1,0]
  v_pk_mul_f32 v[126:127], v[126:127], v[248:249] op_sel_hi:[1,0]
  v_pk_mul_f32 v[128:129], v[128:129], v[248:249] op_sel_hi:[1,0]
  v_pk_mul_f32 v[130:131], v[130:131], v[248:249] op_sel_hi:[1,0]
  ds_write_b128 v15, v[240:243] offset:64
  v_pk_mul_f32 v[132:133], v[132:133], v[250:251] op_sel_hi:[1,0]
  v_pk_mul_f32 v[134:135], v[134:135], v[250:251] op_sel_hi:[1,0]
  v_pk_mul_f32 v[136:137], v[136:137], v[250:251] op_sel_hi:[1,0]
  v_pk_mul_f32 v[138:139], v[138:139], v[250:251] op_sel_hi:[1,0]
  v_pk_mul_f32 v[140:141], v[140:141], v[250:251] op_sel_hi:[1,0]
  v_pk_mul_f32 v[142:143], v[142:143], v[250:251] op_sel_hi:[1,0]
  v_pk_mul_f32 v[144:145], v[144:145], v[250:251] op_sel_hi:[1,0]
  v_pk_mul_f32 v[146:147], v[146:147], v[250:251] op_sel_hi:[1,0]
  v_pk_mul_f32 v[148:149], v[148:149], v[250:251] op_sel_hi:[1,0]
  v_pk_mul_f32 v[150:151], v[150:151], v[250:251] op_sel_hi:[1,0]
  v_cvt_pk_bf16_f32 v172, v112, v113
  v_cvt_pk_bf16_f32 v173, v114, v115
  buffer_load_dwordx4 v9, s[48:51], s7 offen offset:0 lds
  v_cvt_pk_bf16_f32 v174, v116, v117
  v_cvt_pk_bf16_f32 v175, v118, v119
  v_cvt_pk_bf16_f32 v176, v120, v121
  v_cvt_pk_bf16_f32 v177, v122, v123
  v_cvt_pk_bf16_f32 v178, v124, v125
  v_cvt_pk_bf16_f32 v179, v126, v127
  v_cvt_pk_bf16_f32 v180, v128, v129
  v_cvt_pk_bf16_f32 v181, v130, v131
  v_cvt_pk_bf16_f32 v182, v132, v133
  v_cvt_pk_bf16_f32 v183, v134, v135
  v_cvt_pk_bf16_f32 v184, v136, v137
  v_cvt_pk_bf16_f32 v185, v138, v139
  v_cvt_pk_bf16_f32 v186, v140, v141
  v_cvt_pk_bf16_f32 v187, v142, v143
  v_cvt_pk_bf16_f32 v188, v144, v145
  v_cvt_pk_bf16_f32 v189, v146, v147
  v_cvt_pk_bf16_f32 v190, v148, v149
  v_cvt_pk_bf16_f32 v191, v150, v151
  ds_write_b128 v15, v[172:175] offset:8448
  ds_write_b128 v15, v[176:179] offset:8464
  ds_write_b128 v15, v[180:183] offset:8480
  ds_write_b128 v15, v[184:187] offset:8496
  ds_write_b128 v15, v[188:191] offset:8512
  v_add_u32 v29, 1, v29
  s_mov_b32 s100, -1
  s_mov_b32 s101, 0xffff
  v_readfirstlane_b32 s14, v29
  s_waitcnt vmcnt(24)
  s_nop 0
  v_cmp_ne_u32 vcc, s14, v22
  s_mov_b32 s9, 0
  s_and_b64 vcc, vcc, s[100:101]
  s_cbranch_scc0 A_pz_ok
A_pz:
  buffer_load_dword v22, v19, s[52:55], s11 offen sc1
  s_waitcnt vmcnt(0)
  v_cmp_ne_u32 vcc, s14, v22
  s_add_u32 s9, s9, 1
  s_and_b64 vcc, vcc, s[100:101]
  s_cbranch_scc0 A_pz_ok
  s_sleep 1
  s_cmp_lt_u32 s9, 0x40000
  s_cbranch_scc1 A_pz
A_pz_ok:
  s_lshl_b32 s70, s5, 2
  s_add_u32 s70, s70, s4
  s_lshl_b32 s70, s70, 5
  s_add_u32 s70, s70, s10
  s_lshl_b32 s70, s70, 2
  s_add_u32 s70, s70, 16384
  s_waitcnt vmcnt(0)
  v_mov_b32 v20, s14
  v_mov_b32 v21, 0
  s_mov_b64 exec, 1
  buffer_store_dword v20, v21, s[52:55], s70 offen sc1
  s_mov_b64 exec, -1
  s_waitcnt lgkmcnt(0)
  s_barrier
  s_cmp_lg_u32 s4, 0
  s_cbranch_scc1 A_arr
  v_mov_b32 v14, 1
  v_mov_b32 v21, 0
  s_mov_b64 exec, 1
  global_atomic_add v14, v21, v14, s[40:41] sc0
  s_mov_b64 exec, -1
A_arr:
  ds_read_b64_tr_b16 v[112:113], v16 offset:0
  ds_read_b64_tr_b16 v[114:115], v16 offset:528
  ds_read_b64_tr_b16 v[116:117], v17 offset:0
  ds_read_b64_tr_b16 v[118:119], v17 offset:528
  ds_read_b64_tr_b16 v[120:121], v17 offset:32
  ds_read_b64_tr_b16 v[122:123], v17 offset:560
  ds_read_b64_tr_b16 v[124:125], v31 offset:64
  ds_read_b64_tr_b16 v[126:127], v31 offset:592
  ds_read_b64_tr_b16 v[128:129], v30 offset:32
  ds_read_b64_tr_b16 v[130:131], v30 offset:560
  s_waitcnt lgkmcnt(6)
  v_mfma_f32_16x16x32_bf16 v[32:35], v[112:115], v[116:119], 0
  ds_read_b64_tr_b16 v[132:133], v16 offset:16896
  ds_read_b64_tr_b16 v[134:135], v16 offset:17424
  s_waitcnt lgkmcnt(6)
  v_mfma_f32_16x16x32_bf16 v[36:39], v[112:115], v[120:123], 0
  ds_read_b64_tr_b16 v[136:137], v17 offset:16896
  ds_read_b64_tr_b16 v[138:139], v17 offset:17424
  s_waitcnt lgkmcnt(6)
  v_mfma_f32_16x16x32_bf16 v[40:43], v[112:115], v[124:127], 0
  ds_read_b64_tr_b16 v[140:141], v17 offset:16928
  ds_read_b64_tr_b16 v[142:143], v17 offset:17456
  s_waitcnt lgkmcnt(6)
  v_mfma_f32_16x16x32_bf16 v[44:47], v[128:131], v[116:119], 0
  ds_read_b64_tr_b16 v[144:145], v31 offset:16960
  ds_read_b64_tr_b16 v[146:147], v31 offset:17488
  v_mfma_f32_16x16x32_bf16 v[48:51], v[128:131], v[120:123], 0
  ds_read_b64_tr_b16 v[148:149], v30 offset:16928
  ds_read_b64_tr_b16 v[150:151], v30 offset:17456
  v_mfma_f32_16x16x32_bf16 v[52:55], v[128:131], v[124:127], 0
  s_waitcnt lgkmcnt(6)
  v_mfma_f32_16x16x32_bf16 v[32:35], v[132:135], v[136:139], v[32:35]
  ds_read_b64_tr_b16 v[112:113], v16 offset:33792
  ds_read_b64_tr_b16 v[114:115], v16 offset:34320
  s_waitcnt lgkmcnt(6)
  v_mfma_f32_16x16x32_bf16 v[36:39], v[132:135], v[140:143], v[36:39]
  ds_read_b64_tr_b16 v[116:117], v17 offset:33792
  ds_read_b64_tr_b16 v[118:119], v17 offset:34320
  s_waitcnt lgkmcnt(6)
  v_mfma_f32_16x16x32_bf16 v[40:43], v[132:135], v[144:147], v[40:43]
  ds_read_b64_tr_b16 v[120:121], v17 offset:33824
  ds_read_b64_tr_b16 v[122:123], v17 offset:34352
  s_waitcnt lgkmcnt(6)
  v_mfma_f32_16x16x32_bf16 v[44:47], v[148:151], v[136:139], v[44:47]
  ds_read_b64_tr_b16 v[124:125], v31 offset:33856
  ds_read_b64_tr_b16 v[126:127], v31 offset:34384
  v_mfma_f32_16x16x32_bf16 v[48:51], v[148:151], v[140:143], v[48:51]
  ds_read_b64_tr_b16 v[128:129], v30 offset:33824
  ds_read_b64_tr_b16 v[130:131], v30 offset:34352
  v_mfma_f32_16x16x32_bf16 v[52:55], v[148:151], v[144:147], v[52:55]
  s_waitcnt lgkmcnt(6)
  v_mfma_f32_16x16x32_bf16 v[32:35], v[112:115], v[116:119], v[32:35]
  ds_read_b64_tr_b16 v[132:133], v16 offset:50688
  ds_read_b64_tr_b16 v[134:135], v16 offset:51216
  s_waitcnt lgkmcnt(6)
  v_mfma_f32_16x16x32_bf16 v[36:39], v[112:115], v[120:123], v[36:39]
  ds_read_b64_tr_b16 v[136:137], v17 offset:50688
  ds_read_b64_tr_b16 v[138:139], v17 offset:51216
  s_waitcnt lgkmcnt(6)
  v_mfma_f32_16x16x32_bf16 v[40:43], v[112:115], v[124:127], v[40:43]
  ds_read_b64_tr_b16 v[140:141], v17 offset:50720
  ds_read_b64_tr_b16 v[142:143], v17 offset:51248
  s_waitcnt lgkmcnt(6)
  v_mfma_f32_16x16x32_bf16 v[44:47], v[128:131], v[116:119], v[44:47]
  ds_read_b64_tr_b16 v[144:145], v31 offset:50752
  ds_read_b64_tr_b16 v[146:147], v31 offset:51280
  v_mfma_f32_16x16x32_bf16 v[48:51], v[128:131], v[120:123], v[48:51]
  ds_read_b64_tr_b16 v[148:149], v30 offset:50720
  ds_read_b64_tr_b16 v[150:151], v30 offset:51248
  v_mfma_f32_16x16x32_bf16 v[52:55], v[128:131], v[124:127], v[52:55]
  s_waitcnt lgkmcnt(6)
  v_mfma_f32_16x16x32_bf16 v[32:35], v[132:135], v[136:139], v[32:35]
  ds_read_b64_tr_b16 v[152:153], v12 offset:20480
  ds_read_b64_tr_b16 v[154:155], v12 offset:21760
  s_waitcnt lgkmcnt(6)
  v_mfma_f32_16x16x32_bf16 v[36:39], v[132:135], v[140:143], v[36:39]
  ds_read_b64_tr_b16 v[156:157], v12 offset:20488
  ds_read_b64_tr_b16 v[158:159], v12 offset:21768
  s_waitcnt lgkmcnt(6)
  v_mfma_f32_16x16x32_bf16 v[40:43], v[132:135], v[144:147], v[40:43]
  ds_read_b64_tr_b16 v[160:161], v12 offset:20496
  ds_read_b64_tr_b16 v[162:163], v12 offset:21776
  s_waitcnt lgkmcnt(6)
  v_mfma_f32_16x16x32_bf16 v[44:47], v[148:151], v[136:139], v[44:47]
  ds_read_b64_tr_b16 v[164:165], v12 offset:20504
  ds_read_b64_tr_b16 v[166:167], v12 offset:21784
  v_mfma_f32_16x16x32_bf16 v[48:51], v[148:151], v[140:143], v[48:51]
  ds_read_b64_tr_b16 v[168:169], v12 offset:20512
  ds_read_b64_tr_b16 v[170:171], v12 offset:21792
  v_mfma_f32_16x16x32_bf16 v[52:55], v[148:151], v[144:147], v[52:55]
  s_waitcnt lgkmcnt(0)
  s_barrier
  v_mfma_f32_16x16x32_bf16 v[72:75], v[152:155], a[0:3], 0
  ds_read_b64_tr_b16 v[172:173], v12 offset:25600
  buffer_atomic_add_f32 v32, v18, s[52:55], 0 offen offset:0
  v_mfma_f32_16x16x32_bf16 v[92:95], v[152:155], a[4:7], 0
  ds_read_b64_tr_b16 v[174:175], v12 offset:26880
  buffer_atomic_add_f32 v33, v18, s[52:55], 0 offen offset:256
  v_mfma_f32_16x16x32_bf16 v[76:79], v[156:159], a[0:3], 0
  ds_read_b64_tr_b16 v[176:177], v12 offset:25608
  buffer_atomic_add_f32 v34, v18, s[52:55], 0 offen offset:512
  v_mfma_f32_16x16x32_bf16 v[96:99], v[156:159], a[4:7], 0
  ds_read_b64_tr_b16 v[178:179], v12 offset:26888
  buffer_atomic_add_f32 v35, v18, s[52:55], 0 offen offset:768
  v_mfma_f32_16x16x32_bf16 v[80:83], v[160:163], a[0:3], 0
  ds_read_b64_tr_b16 v[180:181], v12 offset:25616
  buffer_atomic_add_f32 v36, v18, s[52:55], 0 offen offset:1024
  v_mfma_f32_16x16x32_bf16 v[100:103], v[160:163], a[4:7], 0
  ds_read_b64_tr_b16 v[182:183], v12 offset:26896
  buffer_atomic_add_f32 v37, v18, s[52:55], 0 offen offset:1280
  v_mfma_f32_16x16x32_bf16 v[84:87], v[164:167], a[0:3], 0
  ds_read_b64_tr_b16 v[184:185], v12 offset:25624
  buffer_atomic_add_f32 v38, v18, s[52:55], 0 offen offset:1536
  v_mfma_f32_16x16x32_bf16 v[104:107], v[164:167], a[4:7], 0
  ds_read_b64_tr_b16 v[186:187], v12 offset:26904
  buffer_atomic_add_f32 v39, v18, s[52:55], 0 offen offset:1792
  v_mfma_f32_16x16x32_bf16 v[88:91], v[168:171], a[0:3], 0
  ds_read_b64_tr_b16 v[188:189], v12 offset:25632
  v_mov_b32_dpp v40, v41 row_ror:8 row_mask:0xf bank_mask:0xc
  buffer_atomic_add_f32 v40, v18, s[52:55], 0 offen offset:2048
  v_mfma_f32_16x16x32_bf16 v[108:111], v[168:171], a[4:7], 0
  ds_read_b64_tr_b16 v[190:191], v12 offset:26912
  s_waitcnt lgkmcnt(8)
  v_mfma_f32_16x16x32_bf16 v[72:75], v[172:175], a[8:11], v[72:75]
  ds_read_b64_tr_b16 v[152:153], v12 offset:30720
  v_mov_b32_dpp v42, v43 row_ror:8 row_mask:0xf bank_mask:0xc
  buffer_atomic_add_f32 v42, v18, s[52:55], 0 offen offset:2304
  v_mfma_f32_16x16x32_bf16 v[92:95], v[172:175], a[12:15], v[92:95]
  ds_read_b64_tr_b16 v[154:155], v12 offset:32000
  v_permlane16_swap_b32 v45, v46
  s_waitcnt lgkmcnt(8)
  v_mfma_f32_16x16x32_bf16 v[76:79], v[176:179], a[8:11], v[76:79]
  ds_read_b64_tr_b16 v[156:157], v12 offset:30728
  v_permlane32_swap_b32 v44, v45
  buffer_atomic_add_f32 v44, v18, s[52:55], 0 offen offset:2560
  v_mfma_f32_16x16x32_bf16 v[96:99], v[176:179], a[12:15], v[96:99]
  ds_read_b64_tr_b16 v[158:159], v12 offset:32008
  v_permlane16_swap_b32 v49, v50
  s_waitcnt lgkmcnt(8)
  v_mfma_f32_16x16x32_bf16 v[80:83], v[180:183], a[8:11], v[80:83]
  ds_read_b64_tr_b16 v[160:161], v12 offset:30736
  v_permlane32_swap_b32 v48, v49
  buffer_atomic_add_f32 v48, v18, s[52:55], 0 offen offset:2816
  v_mfma_f32_16x16x32_bf16 v[100:103], v[180:183], a[12:15], v[100:103]
  ds_read_b64_tr_b16 v[162:163], v12 offset:32016
  v_permlane16_swap_b32 v53, v54
  s_waitcnt lgkmcnt(8)
  v_mfma_f32_16x16x32_bf16 v[84:87], v[184:187], a[8:11], v[84:87]
  ds_read_b64_tr_b16 v[164:165], v12 offset:30744
  v_permlane32_swap_b32 v52, v53
  buffer_atomic_add_f32 v52, v18, s[52:55], 0 offen offset:3072
  v_mfma_f32_16x16x32_bf16 v[104:107], v[184:187], a[12:15], v[104:107]
  ds_read_b64_tr_b16 v[166:167], v12 offset:32024
  v_permlane16_swap_b32 v47, v51
  s_waitcnt lgkmcnt(8)
  v_mfma_f32_16x16x32_bf16 v[88:91], v[188:191], a[8:11], v[88:91]
  ds_read_b64_tr_b16 v[168:169], v12 offset:30752
  v_permlane32_swap_b32 v47, v55
  buffer_atomic_add_f32 v47, v18, s[52:55], 0 offen offset:3328
  v_mfma_f32_16x16x32_bf16 v[108:111], v[188:191], a[12:15], v[108:111]
  ds_read_b64_tr_b16 v[170:171], v12 offset:32032
  s_waitcnt lgkmcnt(8)
  v_mfma_f32_16x16x32_bf16 v[72:75], v[152:155], a[16:19], v[72:75]
  ds_read_b64_tr_b16 v[172:173], v12 offset:35840
  s_add_u32 m0, s3, 47104
  s_add_u32 s7, s63, 1966080
  v_mfma_f32_16x16x32_bf16 v[92:95], v[152:155], a[20:23], v[92:95]
  ds_read_b64_tr_b16 v[174:175], v12 offset:37120
  s_waitcnt lgkmcnt(8)
  v_mfma_f32_16x16x32_bf16 v[76:79], v[156:159], a[16:19], v[76:79]
  ds_read_b64_tr_b16 v[176:177], v12 offset:35848
  v_mfma_f32_16x16x32_bf16 v[96:99], v[156:159], a[20:23], v[96:99]
  ds_read_b64_tr_b16 v[178:179], v12 offset:37128
  s_waitcnt lgkmcnt(8)
  v_mfma_f32_16x16x32_bf16 v[80:83], v[160:163], a[16:19], v[80:83]
  ds_read_b64_tr_b16 v[180:181], v12 offset:35856
  v_mfma_f32_16x16x32_bf16 v[100:103], v[160:163], a[20:23], v[100:103]
  ds_read_b64_tr_b16 v[182:183], v12 offset:37136
  s_waitcnt lgkmcnt(8)
  v_mfma_f32_16x16x32_bf16 v[84:87], v[164:167], a[16:19], v[84:87]
  ds_read_b64_tr_b16 v[184:185], v12 offset:35864
  v_mfma_f32_16x16x32_bf16 v[104:107], v[164:167], a[20:23], v[104:107]
  ds_read_b64_tr_b16 v[186:187], v12 offset:37144
  s_waitcnt lgkmcnt(8)
  v_mfma_f32_16x16x32_bf16 v[88:91], v[168:171], a[16:19], v[88:91]
  ds_read_b64_tr_b16 v[188:189], v12 offset:35872
  buffer_load_dwordx4 v5, s[48:51], s7 offen offset:0 lds
  v_mfma_f32_16x16x32_bf16 v[108:111], v[168:171], a[20:23], v[108:111]
  ds_read_b64_tr_b16 v[190:191], v12 offset:37152
  s_waitcnt lgkmcnt(8)
  v_mfma_f32_16x16x32_bf16 v[72:75], v[172:175], a[24:27], v[72:75]
  ds_read_b64_tr_b16 v[152:153], v12 offset:40960
  v_mfma_f32_16x16x32_bf16 v[92:95], v[172:175], a[28:31], v[92:95]
  ds_read_b64_tr_b16 v[154:155], v12 offset:42240
  s_waitcnt lgkmcnt(8)
  v_mfma_f32_16x16x32_bf16 v[76:79], v[176:179], a[24:27], v[76:79]
  ds_read_b64_tr_b16 v[156:157], v12 offset:40968
  v_mfma_f32_16x16x32_bf16 v[96:99], v[176:179], a[28:31], v[96:99]
  ds_read_b64_tr_b16 v[158:159], v12 offset:42248
  s_waitcnt lgkmcnt(8)
  v_mfma_f32_16x16x32_bf16 v[80:83], v[180:183], a[24:27], v[80:83]
  ds_read_b64_tr_b16 v[160:161], v12 offset:40976
  v_mfma_f32_16x16x32_bf16 v[100:103], v[180:183], a[28:31], v[100:103]
  ds_read_b64_tr_b16 v[162:163], v12 offset:42256
  s_waitcnt lgkmcnt(8)
  v_mfma_f32_16x16x32_bf16 v[84:87], v[184:187], a[24:27], v[84:87]
  ds_read_b64_tr_b16 v[164:165], v12 offset:40984
  buffer_load_dwordx4 v6, s[48:51], s7 offen offset:1024 lds
  v_mfma_f32_16x16x32_bf16 v[104:107], v[184:187], a[28:31], v[104:107]
  ds_read_b64_tr_b16 v[166:167], v12 offset:42264
  s_waitcnt lgkmcnt(8)
  v_mfma_f32_16x16x32_bf16 v[88:91], v[188:191], a[24:27], v[88:91]
  ds_read_b64_tr_b16 v[168:169], v12 offset:40992
  v_mfma_f32_16x16x32_bf16 v[108:111], v[188:191], a[28:31], v[108:111]
  ds_read_b64_tr_b16 v[170:171], v12 offset:42272
  s_waitcnt lgkmcnt(8)
  v_mfma_f32_16x16x32_bf16 v[72:75], v[152:155], a[32:35], v[72:75]
  ds_read_b64_tr_b16 v[172:173], v12 offset:46080
  v_mfma_f32_16x16x32_bf16 v[92:95], v[152:155], a[36:39], v[92:95]
  ds_read_b64_tr_b16 v[174:175], v12 offset:47360
  s_waitcnt lgkmcnt(8)
  v_mfma_f32_16x16x32_bf16 v[76:79], v[156:159], a[32:35], v[76:79]
  ds_read_b64_tr_b16 v[176:177], v12 offset:46088
  v_mfma_f32_16x16x32_bf16 v[96:99], v[156:159], a[36:39], v[96:99]
  ds_read_b64_tr_b16 v[178:179], v12 offset:47368
  s_waitcnt lgkmcnt(8)
  v_mfma_f32_16x16x32_bf16 v[80:83], v[160:163], a[32:35], v[80:83]
  ds_read_b64_tr_b16 v[180:181], v12 offset:46096
  buffer_load_dwordx4 v7, s[48:51], s7 offen offset:2048 lds
  v_mfma_f32_16x16x32_bf16 v[100:103], v[160:163], a[36:39], v[100:103]
  ds_read_b64_tr_b16 v[182:183], v12 offset:47376
  s_waitcnt lgkmcnt(8)
  v_mfma_f32_16x16x32_bf16 v[84:87], v[164:167], a[32:35], v[84:87]
  ds_read_b64_tr_b16 v[184:185], v12 offset:46104
  v_mfma_f32_16x16x32_bf16 v[104:107], v[164:167], a[36:39], v[104:107]
  ds_read_b64_tr_b16 v[186:187], v12 offset:47384
  s_waitcnt lgkmcnt(8)
  v_mfma_f32_16x16x32_bf16 v[88:91], v[168:171], a[32:35], v[88:91]
  ds_read_b64_tr_b16 v[188:189], v12 offset:46112
  v_mfma_f32_16x16x32_bf16 v[108:111], v[168:171], a[36:39], v[108:111]
  ds_read_b64_tr_b16 v[190:191], v12 offset:47392
  s_waitcnt lgkmcnt(8)
  v_mfma_f32_16x16x32_bf16 v[72:75], v[172:175], a[40:43], v[72:75]
  ds_read_b64_tr_b16 v[152:153], v12 offset:51200
  v_mfma_f32_16x16x32_bf16 v[92:95], v[172:175], a[44:47], v[92:95]
  ds_read_b64_tr_b16 v[154:155], v12 offset:52480
  s_waitcnt lgkmcnt(8)
  v_mfma_f32_16x16x32_bf16 v[76:79], v[176:179], a[40:43], v[76:79]
  ds_read_b64_tr_b16 v[156:157], v12 offset:51208
  buffer_load_dwordx4 v8, s[48:51], s7 offen offset:3072 lds
  s_addk_i32 m0, 0x1000
  v_mfma_f32_16x16x32_bf16 v[96:99], v[176:179], a[44:47], v[96:99]
  ds_read_b64_tr_b16 v[158:159], v12 offset:52488
  s_waitcnt lgkmcnt(8)
  v_mfma_f32_16x16x32_bf16 v[80:83], v[180:183], a[40:43], v[80:83]
  ds_read_b64_tr_b16 v[160:161], v12 offset:51216
  v_mfma_f32_16x16x32_bf16 v[100:103], v[180:183], a[44:47], v[100:103]
  ds_read_b64_tr_b16 v[162:163], v12 offset:52496
  s_waitcnt lgkmcnt(8)
  v_mfma_f32_16x16x32_bf16 v[84:87], v[184:187], a[40:43], v[84:87]
  ds_read_b64_tr_b16 v[164:165], v12 offset:51224
  v_mfma_f32_16x16x32_bf16 v[104:107], v[184:187], a[44:47], v[104:107]
  ds_read_b64_tr_b16 v[166:167], v12 offset:52504
  s_waitcnt lgkmcnt(8)
  v_mfma_f32_16x16x32_bf16 v[88:91], v[188:191], a[40:43], v[88:91]
  ds_read_b64_tr_b16 v[168:169], v12 offset:51232
  v_mfma_f32_16x16x32_bf16 v[108:111], v[188:191], a[44:47], v[108:111]
  ds_read_b64_tr_b16 v[170:171], v12 offset:52512
  s_waitcnt lgkmcnt(8)
  v_mfma_f32_16x16x32_bf16 v[72:75], v[152:155], a[48:51], v[72:75]
  ds_read_b64_tr_b16 v[172:173], v12 offset:56320
  v_mfma_f32_16x16x32_bf16 v[92:95], v[152:155], a[52:55], v[92:95]
  ds_read_b64_tr_b16 v[174:175], v12 offset:57600
  buffer_load_dwordx4 v9, s[48:51], s7 offen offset:0 lds
  s_add_u32 m0, s3, 0
  s_add_u32 s7, s6, 0
  s_waitcnt lgkmcnt(8)
  v_mfma_f32_16x16x32_bf16 v[76:79], v[156:159], a[48:51], v[76:79]
  ds_read_b64_tr_b16 v[176:177], v12 offset:56328
  v_mfma_f32_16x16x32_bf16 v[96:99], v[156:159], a[52:55], v[96:99]
  ds_read_b64_tr_b16 v[178:179], v12 offset:57608
  s_waitcnt lgkmcnt(8)
  v_mfma_f32_16x16x32_bf16 v[80:83], v[160:163], a[48:51], v[80:83]
  ds_read_b64_tr_b16 v[180:181], v12 offset:56336
  v_mfma_f32_16x16x32_bf16 v[100:103], v[160:163], a[52:55], v[100:103]
  ds_read_b64_tr_b16 v[182:183], v12 offset:57616
  s_waitcnt lgkmcnt(8)
  v_mfma_f32_16x16x32_bf16 v[84:87], v[164:167], a[48:51], v[84:87]
  ds_read_b64_tr_b16 v[184:185], v12 offset:56344
  v_mfma_f32_16x16x32_bf16 v[104:107], v[164:167], a[52:55], v[104:107]
  ds_read_b64_tr_b16 v[186:187], v12 offset:57624
  s_waitcnt lgkmcnt(8)
  v_mfma_f32_16x16x32_bf16 v[88:91], v[168:171], a[48:51], v[88:91]
  ds_read_b64_tr_b16 v[188:189], v12 offset:56352
  v_mfma_f32_16x16x32_bf16 v[108:111], v[168:171], a[52:55], v[108:111]
  ds_read_b64_tr_b16 v[190:191], v12 offset:57632
  buffer_load_dwordx4 v252, s[64:67], s7 offen offset:0 lds
  s_waitcnt lgkmcnt(8)
  v_mfma_f32_16x16x32_bf16 v[72:75], v[172:175], a[56:59], v[72:75]
  ds_read_b64_tr_b16 v[152:153], v13 offset:0
  v_mfma_f32_16x16x32_bf16 v[92:95], v[172:175], a[60:63], v[92:95]
  ds_read_b64_tr_b16 v[154:155], v13 offset:1280
  s_waitcnt lgkmcnt(8)
  v_mfma_f32_16x16x32_bf16 v[76:79], v[176:179], a[56:59], v[76:79]
  ds_read_b64_tr_b16 v[156:157], v13 offset:8
  v_mfma_f32_16x16x32_bf16 v[96:99], v[176:179], a[60:63], v[96:99]
  ds_read_b64_tr_b16 v[158:159], v13 offset:1288
  s_waitcnt lgkmcnt(8)
  v_mfma_f32_16x16x32_bf16 v[80:83], v[180:183], a[56:59], v[80:83]
  ds_read_b64_tr_b16 v[160:161], v13 offset:16
  v_mfma_f32_16x16x32_bf16 v[100:103], v[180:183], a[60:63], v[100:103]
  ds_read_b64_tr_b16 v[162:163], v13 offset:1296
  s_waitcnt lgkmcnt(8)
  v_mfma_f32_16x16x32_bf16 v[84:87], v[184:187], a[56:59], v[84:87]
  ds_read_b64_tr_b16 v[164:165], v13 offset:24
  v_mfma_f32_16x16x32_bf16 v[104:107], v[184:187], a[60:63], v[104:107]
  ds_read_b64_tr_b16 v[166:167], v13 offset:1304
  buffer_load_dwordx4 v253, s[64:67], s7 offen offset:1024 lds
  s_waitcnt lgkmcnt(8)
  v_mfma_f32_16x16x32_bf16 v[88:91], v[188:191], a[56:59], v[88:91]
  ds_read_b64_tr_b16 v[168:169], v13 offset:32
  v_mfma_f32_16x16x32_bf16 v[108:111], v[188:191], a[60:63], v[108:111]
  ds_read_b64_tr_b16 v[170:171], v13 offset:1312
  s_waitcnt lgkmcnt(8)
  v_mfma_f32_16x16x32_bf16 v[72:75], v[152:155], a[64:67], v[72:75]
  ds_read_b64_tr_b16 v[172:173], v13 offset:5120
  v_mfma_f32_16x16x32_bf16 v[92:95], v[152:155], a[68:71], v[92:95]
  ds_read_b64_tr_b16 v[174:175], v13 offset:6400
  s_waitcnt lgkmcnt(8)
  v_mfma_f32_16x16x32_bf16 v[76:79], v[156:159], a[64:67], v[76:79]
  ds_read_b64_tr_b16 v[176:177], v13 offset:5128
  v_mfma_f32_16x16x32_bf16 v[96:99], v[156:159], a[68:71], v[96:99]
  ds_read_b64_tr_b16 v[178:179], v13 offset:6408
  s_waitcnt lgkmcnt(8)
  v_mfma_f32_16x16x32_bf16 v[80:83], v[160:163], a[64:67], v[80:83]
  ds_read_b64_tr_b16 v[180:181], v13 offset:5136
  v_mfma_f32_16x16x32_bf16 v[100:103], v[160:163], a[68:71], v[100:103]
  ds_read_b64_tr_b16 v[182:183], v13 offset:6416
  buffer_load_dwordx4 v254, s[64:67], s7 offen offset:2048 lds
  s_waitcnt lgkmcnt(8)
  v_mfma_f32_16x16x32_bf16 v[84:87], v[164:167], a[64:67], v[84:87]
  ds_read_b64_tr_b16 v[184:185], v13 offset:5144
  v_mfma_f32_16x16x32_bf16 v[104:107], v[164:167], a[68:71], v[104:107]
  ds_read_b64_tr_b16 v[186:187], v13 offset:6424
  s_waitcnt lgkmcnt(8)
  v_mfma_f32_16x16x32_bf16 v[88:91], v[168:171], a[64:67], v[88:91]
  ds_read_b64_tr_b16 v[188:189], v13 offset:5152
  v_mfma_f32_16x16x32_bf16 v[108:111], v[168:171], a[68:71], v[108:111]
  ds_read_b64_tr_b16 v[190:191], v13 offset:6432
  s_waitcnt lgkmcnt(8)
  v_mfma_f32_16x16x32_bf16 v[72:75], v[172:175], a[72:75], v[72:75]
  ds_read_b64_tr_b16 v[152:153], v13 offset:10240
  v_mfma_f32_16x16x32_bf16 v[92:95], v[172:175], a[76:79], v[92:95]
  ds_read_b64_tr_b16 v[154:155], v13 offset:11520
  s_waitcnt lgkmcnt(8)
  v_mfma_f32_16x16x32_bf16 v[76:79], v[176:179], a[72:75], v[76:79]
  ds_read_b64_tr_b16 v[156:157], v13 offset:10248
  v_mfma_f32_16x16x32_bf16 v[96:99], v[176:179], a[76:79], v[96:99]
  ds_read_b64_tr_b16 v[158:159], v13 offset:11528
  s_waitcnt lgkmcnt(8)
  v_mfma_f32_16x16x32_bf16 v[80:83], v[180:183], a[72:75], v[80:83]
  ds_read_b64_tr_b16 v[160:161], v13 offset:10256
  buffer_load_dwordx4 v255, s[64:67], s7 offen offset:3072 lds
  s_addk_i32 m0, 0x1000
  v_mfma_f32_16x16x32_bf16 v[100:103], v[180:183], a[76:79], v[100:103]
  ds_read_b64_tr_b16 v[162:163], v13 offset:11536
  s_waitcnt lgkmcnt(8)
  v_mfma_f32_16x16x32_bf16 v[84:87], v[184:187], a[72:75], v[84:87]
  ds_read_b64_tr_b16 v[164:165], v13 offset:10264
  v_mfma_f32_16x16x32_bf16 v[104:107], v[184:187], a[76:79], v[104:107]
  ds_read_b64_tr_b16 v[166:167], v13 offset:11544
  s_waitcnt lgkmcnt(8)
  v_mfma_f32_16x16x32_bf16 v[88:91], v[188:191], a[72:75], v[88:91]
  ds_read_b64_tr_b16 v[168:169], v13 offset:10272
  v_mfma_f32_16x16x32_bf16 v[108:111], v[188:191], a[76:79], v[108:111]
  ds_read_b64_tr_b16 v[170:171], v13 offset:11552
  s_waitcnt vmcnt(9)
  s_lshl_b32 s71, s10, 8
  s_add_u32 s71, s71, 8192
  s_lshl_b32 s11, s5, 2
  s_add_u32 s11, s11, s4
  s_lshl_b32 s11, s11, 2
  s_add_u32 s11, s71, s11
  v_mov_b32 v20, s14
  v_mov_b32 v21, 0
  s_mov_b64 exec, 1
  buffer_store_dword v20, v21, s[52:55], s11 offen sc1
  s_mov_b64 exec, -1
  s_waitcnt lgkmcnt(8)
  v_mfma_f32_16x16x32_bf16 v[72:75], v[152:155], a[80:83], v[72:75]
  ds_read_b64_tr_b16 v[172:173], v13 offset:15360
  v_mfma_f32_16x16x32_bf16 v[92:95], v[152:155], a[84:87], v[92:95]
  ds_read_b64_tr_b16 v[174:175], v13 offset:16640
  s_waitcnt lgkmcnt(8)
  v_mfma_f32_16x16x32_bf16 v[76:79], v[156:159], a[80:83], v[76:79]
  ds_read_b64_tr_b16 v[176:177], v13 offset:15368
  buffer_load_dwordx4 v26, s[64:67], s7 offen offset:0 lds
  s_add_u32 m0, s3, 20480
  s_add_u32 s7, s6, 163840
  v_mfma_f32_16x16x32_bf16 v[96:99], v[156:159], a[84:87], v[96:99]
  ds_read_b64_tr_b16 v[178:179], v13 offset:16648
  s_waitcnt lgkmcnt(8)
  v_mfma_f32_16x16x32_bf16 v[80:83], v[160:163], a[80:83], v[80:83]
  ds_read_b64_tr_b16 v[180:181], v13 offset:15376
  v_mfma_f32_16x16x32_bf16 v[100:103], v[160:163], a[84:87], v[100:103]
  ds_read_b64_tr_b16 v[182:183], v13 offset:16656
  s_waitcnt lgkmcnt(8)
  v_mfma_f32_16x16x32_bf16 v[84:87], v[164:167], a[80:83], v[84:87]
  ds_read_b64_tr_b16 v[184:185], v13 offset:15384
  v_mfma_f32_16x16x32_bf16 v[104:107], v[164:167], a[84:87], v[104:107]
  ds_read_b64_tr_b16 v[186:187], v13 offset:16664
  s_waitcnt lgkmcnt(8)
  v_mfma_f32_16x16x32_bf16 v[88:91], v[168:171], a[80:83], v[88:91]
  ds_read_b64_tr_b16 v[188:189], v13 offset:15392
  v_mfma_f32_16x16x32_bf16 v[108:111], v[168:171], a[84:87], v[108:111]
  ds_read_b64_tr_b16 v[190:191], v13 offset:16672
  s_waitcnt lgkmcnt(8)
  v_mfma_f32_16x16x32_bf16 v[72:75], v[172:175], a[88:91], v[72:75]
  ds_read_b64_tr_b16 v[152:153], v13 offset:20480
  buffer_load_dwordx4 v252, s[64:67], s7 offen offset:0 lds
  v_mfma_f32_16x16x32_bf16 v[92:95], v[172:175], a[92:95], v[92:95]
  ds_read_b64_tr_b16 v[154:155], v13 offset:21760
  s_waitcnt lgkmcnt(8)
  v_mfma_f32_16x16x32_bf16 v[76:79], v[176:179], a[88:91], v[76:79]
  ds_read_b64_tr_b16 v[156:157], v13 offset:20488
  v_mfma_f32_16x16x32_bf16 v[96:99], v[176:179], a[92:95], v[96:99]
  ds_read_b64_tr_b16 v[158:159], v13 offset:21768
  s_waitcnt lgkmcnt(8)
  v_mfma_f32_16x16x32_bf16 v[80:83], v[180:183], a[88:91], v[80:83]
  ds_read_b64_tr_b16 v[160:161], v13 offset:20496
  v_mfma_f32_16x16x32_bf16 v[100:103], v[180:183], a[92:95], v[100:103]
  ds_read_b64_tr_b16 v[162:163], v13 offset:21776
  s_waitcnt lgkmcnt(8)
  v_mfma_f32_16x16x32_bf16 v[84:87], v[184:187], a[88:91], v[84:87]
  ds_read_b64_tr_b16 v[164:165], v13 offset:20504
  v_mfma_f32_16x16x32_bf16 v[104:107], v[184:187], a[92:95], v[104:107]
  ds_read_b64_tr_b16 v[166:167], v13 offset:21784
  s_waitcnt lgkmcnt(8)
  v_mfma_f32_16x16x32_bf16 v[88:91], v[188:191], a[88:91], v[88:91]
  ds_read_b64_tr_b16 v[168:169], v13 offset:20512
  buffer_load_dwordx4 v253, s[64:67], s7 offen offset:1024 lds
  v_mfma_f32_16x16x32_bf16 v[108:111], v[188:191], a[92:95], v[108:111]
  ds_read_b64_tr_b16 v[170:171], v13 offset:21792
  s_waitcnt lgkmcnt(8)
  v_mfma_f32_16x16x32_bf16 v[72:75], v[152:155], a[96:99], v[72:75]
  ds_read_b64_tr_b16 v[172:173], v13 offset:25600
  v_mfma_f32_16x16x32_bf16 v[92:95], v[152:155], a[100:103], v[92:95]
  ds_read_b64_tr_b16 v[174:175], v13 offset:26880
  s_waitcnt lgkmcnt(8)
  v_mfma_f32_16x16x32_bf16 v[76:79], v[156:159], a[96:99], v[76:79]
  ds_read_b64_tr_b16 v[176:177], v13 offset:25608
  v_mfma_f32_16x16x32_bf16 v[96:99], v[156:159], a[100:103], v[96:99]
  ds_read_b64_tr_b16 v[178:179], v13 offset:26888
  s_waitcnt lgkmcnt(8)
  v_mfma_f32_16x16x32_bf16 v[80:83], v[160:163], a[96:99], v[80:83]
  ds_read_b64_tr_b16 v[180:181], v13 offset:25616
  v_mfma_f32_16x16x32_bf16 v[100:103], v[160:163], a[100:103], v[100:103]
  ds_read_b64_tr_b16 v[182:183], v13 offset:26896
  s_waitcnt lgkmcnt(8)
  v_mfma_f32_16x16x32_bf16 v[84:87], v[164:167], a[96:99], v[84:87]
  ds_read_b64_tr_b16 v[184:185], v13 offset:25624
  v_mfma_f32_16x16x32_bf16 v[104:107], v[164:167], a[100:103], v[104:107]
  ds_read_b64_tr_b16 v[186:187], v13 offset:26904
  buffer_load_dwordx4 v254, s[64:67], s7 offen offset:2048 lds
  s_waitcnt lgkmcnt(8)
  v_mfma_f32_16x16x32_bf16 v[88:91], v[168:171], a[96:99], v[88:91]
  ds_read_b64_tr_b16 v[188:189], v13 offset:25632
  v_mfma_f32_16x16x32_bf16 v[108:111], v[168:171], a[100:103], v[108:111]
  ds_read_b64_tr_b16 v[190:191], v13 offset:26912
  s_waitcnt lgkmcnt(8)
  v_mfma_f32_16x16x32_bf16 v[72:75], v[172:175], a[104:107], v[72:75]
  ds_read_b64_tr_b16 v[152:153], v13 offset:30720
  v_mfma_f32_16x16x32_bf16 v[92:95], v[172:175], a[108:111], v[92:95]
  ds_read_b64_tr_b16 v[154:155], v13 offset:32000
  s_waitcnt lgkmcnt(8)
  v_mfma_f32_16x16x32_bf16 v[76:79], v[176:179], a[104:107], v[76:79]
  ds_read_b64_tr_b16 v[156:157], v13 offset:30728
  v_mfma_f32_16x16x32_bf16 v[96:99], v[176:179], a[108:111], v[96:99]
  ds_read_b64_tr_b16 v[158:159], v13 offset:32008
  s_waitcnt lgkmcnt(8)
  v_mfma_f32_16x16x32_bf16 v[80:83], v[180:183], a[104:107], v[80:83]
  ds_read_b64_tr_b16 v[160:161], v13 offset:30736
  v_mfma_f32_16x16x32_bf16 v[100:103], v[180:183], a[108:111], v[100:103]
  ds_read_b64_tr_b16 v[162:163], v13 offset:32016
  buffer_load_dwordx4 v255, s[64:67], s7 offen offset:3072 lds
  s_addk_i32 m0, 0x1000
  s_waitcnt lgkmcnt(8)
  v_mfma_f32_16x16x32_bf16 v[84:87], v[184:187], a[104:107], v[84:87]
  ds_read_b64_tr_b16 v[164:165], v13 offset:30744
  v_mfma_f32_16x16x32_bf16 v[104:107], v[184:187], a[108:111], v[104:107]
  ds_read_b64_tr_b16 v[166:167], v13 offset:32024
  s_waitcnt lgkmcnt(8)
  v_mfma_f32_16x16x32_bf16 v[88:91], v[188:191], a[104:107], v[88:91]
  ds_read_b64_tr_b16 v[168:169], v13 offset:30752
  v_mfma_f32_16x16x32_bf16 v[108:111], v[188:191], a[108:111], v[108:111]
  ds_read_b64_tr_b16 v[170:171], v13 offset:32032
  s_waitcnt lgkmcnt(8)
  v_mfma_f32_16x16x32_bf16 v[72:75], v[152:155], a[112:115], v[72:75]
  ds_read_b64_tr_b16 v[172:173], v13 offset:35840
  v_mfma_f32_16x16x32_bf16 v[92:95], v[152:155], a[116:119], v[92:95]
  ds_read_b64_tr_b16 v[174:175], v13 offset:37120
  s_waitcnt lgkmcnt(8)
  v_mfma_f32_16x16x32_bf16 v[76:79], v[156:159], a[112:115], v[76:79]
  ds_read_b64_tr_b16 v[176:177], v13 offset:35848
  v_mfma_f32_16x16x32_bf16 v[96:99], v[156:159], a[116:119], v[96:99]
  ds_read_b64_tr_b16 v[178:179], v13 offset:37128
  buffer_load_dwordx4 v26, s[64:67], s7 offen offset:0 lds
  s_waitcnt lgkmcnt(8)
  v_mfma_f32_16x16x32_bf16 v[80:83], v[160:163], a[112:115], v[80:83]
  ds_read_b64_tr_b16 v[180:181], v13 offset:35856
  v_mfma_f32_16x16x32_bf16 v[100:103], v[160:163], a[116:119], v[100:103]
  ds_read_b64_tr_b16 v[182:183], v13 offset:37136
  s_waitcnt lgkmcnt(8)
  v_mfma_f32_16x16x32_bf16 v[84:87], v[164:167], a[112:115], v[84:87]
  ds_read_b64_tr_b16 v[184:185], v13 offset:35864
  v_mfma_f32_16x16x32_bf16 v[104:107], v[164:167], a[116:119], v[104:107]
  ds_read_b64_tr_b16 v[186:187], v13 offset:37144
  s_waitcnt lgkmcnt(8)
  v_mfma_f32_16x16x32_bf16 v[88:91], v[168:171], a[112:115], v[88:91]
  ds_read_b64_tr_b16 v[188:189], v13 offset:35872
  v_mfma_f32_16x16x32_bf16 v[108:111], v[168:171], a[116:119], v[108:111]
  ds_read_b64_tr_b16 v[190:191], v13 offset:37152
  s_waitcnt vmcnt(11)
  s_waitcnt lgkmcnt(0)
  s_barrier
  v_mfma_f32_16x16x32_bf16 v[72:75], v[172:175], a[120:123], v[72:75]
  ds_read_b64_tr_b16 v[152:153], v12 offset:0
  v_accvgpr_write_b32 a0, 0
  v_mfma_f32_16x16x32_bf16 v[92:95], v[172:175], a[124:127], v[92:95]
  ds_read_b64_tr_b16 v[154:155], v12 offset:1280
  v_accvgpr_write_b32 a1, 0
  v_mfma_f32_16x16x32_bf16 v[76:79], v[176:179], a[120:123], v[76:79]
  ds_read_b64_tr_b16 v[156:157], v12 offset:8
  v_accvgpr_write_b32 a2, 0
  v_mfma_f32_16x16x32_bf16 v[96:99], v[176:179], a[124:127], v[96:99]
  ds_read_b64_tr_b16 v[158:159], v12 offset:1288
  v_accvgpr_write_b32 a3, 0
  v_mfma_f32_16x16x32_bf16 v[80:83], v[180:183], a[120:123], v[80:83]
  ds_read_b64_tr_b16 v[160:161], v12 offset:16
  v_accvgpr_write_b32 a4, 0
  v_mfma_f32_16x16x32_bf16 v[100:103], v[180:183], a[124:127], v[100:103]
  ds_read_b64_tr_b16 v[162:163], v12 offset:1296
  v_mfma_f32_16x16x32_bf16 v[84:87], v[184:187], a[120:123], v[84:87]
  ds_read_b64_tr_b16 v[164:165], v12 offset:24
  v_accvgpr_write_b32 a5, 0
  v_mfma_f32_16x16x32_bf16 v[104:107], v[184:187], a[124:127], v[104:107]
  ds_read_b64_tr_b16 v[166:167], v12 offset:1304
  v_accvgpr_write_b32 a6, 0
  v_mfma_f32_16x16x32_bf16 v[88:91], v[188:191], a[120:123], v[88:91]
  ds_read_b64_tr_b16 v[168:169], v12 offset:32
  v_accvgpr_write_b32 a7, 0
  v_mfma_f32_16x16x32_bf16 v[108:111], v[188:191], a[124:127], v[108:111]
  ds_read_b64_tr_b16 v[170:171], v12 offset:1312
  v_accvgpr_write_b32 a8, 0
  s_waitcnt lgkmcnt(8)
  v_mfma_f32_16x16x32_bf16 v[72:75], v[152:155], a[128:131], v[72:75]
  ds_read_b64_tr_b16 v[172:173], v12 offset:5120
  v_accvgpr_write_b32 a9, 0
  v_mfma_f32_16x16x32_bf16 v[92:95], v[152:155], a[132:135], v[92:95]
  ds_read_b64_tr_b16 v[174:175], v12 offset:6400
  s_waitcnt lgkmcnt(8)
  v_mfma_f32_16x16x32_bf16 v[76:79], v[156:159], a[128:131], v[76:79]
  ds_read_b64_tr_b16 v[176:177], v12 offset:5128
  v_accvgpr_write_b32 a10, 0
  v_mfma_f32_16x16x32_bf16 v[96:99], v[156:159], a[132:135], v[96:99]
  ds_read_b64_tr_b16 v[178:179], v12 offset:6408
  v_accvgpr_write_b32 a11, 0
  s_waitcnt lgkmcnt(8)
  v_mfma_f32_16x16x32_bf16 v[80:83], v[160:163], a[128:131], v[80:83]
  ds_read_b64_tr_b16 v[180:181], v12 offset:5136
  v_accvgpr_write_b32 a12, 0
  v_mfma_f32_16x16x32_bf16 v[100:103], v[160:163], a[132:135], v[100:103]
  ds_read_b64_tr_b16 v[182:183], v12 offset:6416
  v_accvgpr_write_b32 a13, 0
  s_waitcnt lgkmcnt(8)
  v_mfma_f32_16x16x32_bf16 v[84:87], v[164:167], a[128:131], v[84:87]
  ds_read_b64_tr_b16 v[184:185], v12 offset:5144
  v_mfma_f32_16x16x32_bf16 v[104:107], v[164:167], a[132:135], v[104:107]
  ds_read_b64_tr_b16 v[186:187], v12 offset:6424
  v_accvgpr_write_b32 a14, 0
  s_waitcnt lgkmcnt(8)
  v_mfma_f32_16x16x32_bf16 v[88:91], v[168:171], a[128:131], v[88:91]
  ds_read_b64_tr_b16 v[188:189], v12 offset:5152
  v_accvgpr_write_b32 a15, 0
  v_mfma_f32_16x16x32_bf16 v[108:111], v[168:171], a[132:135], v[108:111]
  ds_read_b64_tr_b16 v[190:191], v12 offset:6432
  v_accvgpr_write_b32 a16, 0
  s_waitcnt lgkmcnt(8)
  v_mfma_f32_16x16x32_bf16 v[72:75], v[172:175], a[136:139], v[72:75]
  ds_read_b64_tr_b16 v[152:153], v12 offset:10240
  v_accvgpr_write_b32 a17, 0
  v_mfma_f32_16x16x32_bf16 v[92:95], v[172:175], a[140:143], v[92:95]
  ds_read_b64_tr_b16 v[154:155], v12 offset:11520
  v_accvgpr_write_b32 a18, 0
  s_waitcnt lgkmcnt(8)
  v_mfma_f32_16x16x32_bf16 v[76:79], v[176:179], a[136:139], v[76:79]
  ds_read_b64_tr_b16 v[156:157], v12 offset:10248
  v_mfma_f32_16x16x32_bf16 v[96:99], v[176:179], a[140:143], v[96:99]
  ds_read_b64_tr_b16 v[158:159], v12 offset:11528
  v_accvgpr_write_b32 a19, 0
  s_waitcnt lgkmcnt(8)
  v_mfma_f32_16x16x32_bf16 v[80:83], v[180:183], a[136:139], v[80:83]
  ds_read_b64_tr_b16 v[160:161], v12 offset:10256
  v_accvgpr_write_b32 a20, 0
  v_mfma_f32_16x16x32_bf16 v[100:103], v[180:183], a[140:143], v[100:103]
  ds_read_b64_tr_b16 v[162:163], v12 offset:11536
  v_accvgpr_write_b32 a21, 0
  s_waitcnt lgkmcnt(8)
  v_mfma_f32_16x16x32_bf16 v[84:87], v[184:187], a[136:139], v[84:87]
  ds_read_b64_tr_b16 v[164:165], v12 offset:10264
  v_accvgpr_write_b32 a22, 0
  v_mfma_f32_16x16x32_bf16 v[104:107], v[184:187], a[140:143], v[104:107]
  ds_read_b64_tr_b16 v[166:167], v12 offset:11544
  s_waitcnt lgkmcnt(8)
  v_mfma_f32_16x16x32_bf16 v[88:91], v[188:191], a[136:139], v[88:91]
  ds_read_b64_tr_b16 v[168:169], v12 offset:10272
  v_accvgpr_write_b32 a23, 0
  v_mfma_f32_16x16x32_bf16 v[108:111], v[188:191], a[140:143], v[108:111]
  ds_read_b64_tr_b16 v[170:171], v12 offset:11552
  v_accvgpr_write_b32 a24, 0
  s_waitcnt lgkmcnt(8)
  v_mfma_f32_16x16x32_bf16 v[72:75], v[152:155], a[144:147], v[72:75]
  ds_read_b64_tr_b16 v[172:173], v12 offset:15360
  v_accvgpr_write_b32 a25, 0
  v_mfma_f32_16x16x32_bf16 v[92:95], v[152:155], a[148:151], v[92:95]
  ds_read_b64_tr_b16 v[174:175], v12 offset:16640
  v_accvgpr_write_b32 a26, 0
  s_waitcnt lgkmcnt(8)
  v_mfma_f32_16x16x32_bf16 v[76:79], v[156:159], a[144:147], v[76:79]
  ds_read_b64_tr_b16 v[176:177], v12 offset:15368
  v_accvgpr_write_b32 a27, 0
  v_mfma_f32_16x16x32_bf16 v[96:99], v[156:159], a[148:151], v[96:99]
  ds_read_b64_tr_b16 v[178:179], v12 offset:16648
  s_waitcnt lgkmcnt(8)
  v_mfma_f32_16x16x32_bf16 v[80:83], v[160:163], a[144:147], v[80:83]
  ds_read_b64_tr_b16 v[180:181], v12 offset:15376
  v_accvgpr_write_b32 a28, 0
  v_mfma_f32_16x16x32_bf16 v[100:103], v[160:163], a[148:151], v[100:103]
  ds_read_b64_tr_b16 v[182:183], v12 offset:16656
  v_accvgpr_write_b32 a29, 0
  s_waitcnt lgkmcnt(8)
  v_mfma_f32_16x16x32_bf16 v[84:87], v[164:167], a[144:147], v[84:87]
  ds_read_b64_tr_b16 v[184:185], v12 offset:15384
  v_accvgpr_write_b32 a30, 0
  v_mfma_f32_16x16x32_bf16 v[104:107], v[164:167], a[148:151], v[104:107]
  ds_read_b64_tr_b16 v[186:187], v12 offset:16664
  v_accvgpr_write_b32 a31, 0
  s_waitcnt lgkmcnt(8)
  v_mfma_f32_16x16x32_bf16 v[88:91], v[168:171], a[144:147], v[88:91]
  ds_read_b64_tr_b16 v[188:189], v12 offset:15392
  v_accvgpr_write_b32 a32, 0
  v_mfma_f32_16x16x32_bf16 v[108:111], v[168:171], a[148:151], v[108:111]
  ds_read_b64_tr_b16 v[190:191], v12 offset:16672
  s_waitcnt lgkmcnt(8)
  v_mfma_f32_16x16x32_bf16 v[72:75], v[172:175], a[152:155], v[72:75]
  v_accvgpr_write_b32 a33, 0
  v_mfma_f32_16x16x32_bf16 v[92:95], v[172:175], a[156:159], v[92:95]
  v_accvgpr_write_b32 a34, 0
  s_waitcnt lgkmcnt(6)
  v_mfma_f32_16x16x32_bf16 v[76:79], v[176:179], a[152:155], v[76:79]
  v_accvgpr_write_b32 a35, 0
  v_mfma_f32_16x16x32_bf16 v[96:99], v[176:179], a[156:159], v[96:99]
  v_accvgpr_write_b32 a36, 0
  s_waitcnt lgkmcnt(4)
  v_mfma_f32_16x16x32_bf16 v[80:83], v[180:183], a[152:155], v[80:83]
  v_mfma_f32_16x16x32_bf16 v[100:103], v[180:183], a[156:159], v[100:103]
  v_accvgpr_write_b32 a37, 0
  s_waitcnt lgkmcnt(2)
  v_mfma_f32_16x16x32_bf16 v[84:87], v[184:187], a[152:155], v[84:87]
  v_accvgpr_write_b32 a38, 0
  v_mfma_f32_16x16x32_bf16 v[104:107], v[184:187], a[156:159], v[104:107]
  v_accvgpr_write_b32 a39, 0
  s_waitcnt lgkmcnt(0)
  v_mfma_f32_16x16x32_bf16 v[88:91], v[188:191], a[152:155], v[88:91]
  v_mfma_f32_16x16x32_bf16 v[108:111], v[188:191], a[156:159], v[108:111]
  s_barrier
  v_lshlrev_b32 v19, 2, v0
  v_cvt_pk_bf16_f32 v72, v72, v73
  v_cvt_pk_bf16_f32 v73, v74, v75
  v_cvt_pk_bf16_f32 v74, v76, v77
  v_cvt_pk_bf16_f32 v75, v78, v79
  v_cvt_pk_bf16_f32 v76, v80, v81
  v_cvt_pk_bf16_f32 v77, v82, v83
  v_cvt_pk_bf16_f32 v78, v84, v85
  v_cvt_pk_bf16_f32 v79, v86, v87
  v_cvt_pk_bf16_f32 v80, v88, v89
  v_cvt_pk_bf16_f32 v81, v90, v91
  v_mfma_f32_16x16x32_bf16 v[204:207], a[160:163], v[72:75], 0
  v_cvt_pk_bf16_f32 v92, v92, v93
  v_mfma_f32_16x16x32_bf16 v[208:211], a[172:175], v[72:75], 0
  v_cvt_pk_bf16_f32 v93, v94, v95
  v_mfma_f32_16x16x32_bf16 v[212:215], a[184:187], v[72:75], 0
  v_cvt_pk_bf16_f32 v94, v96, v97
  v_mfma_f32_16x16x32_bf16 v[216:219], a[196:199], v[72:75], 0
  v_cvt_pk_bf16_f32 v95, v98, v99
  v_mfma_f32_16x16x32_bf16 v[220:223], a[208:211], v[72:75], 0
  v_cvt_pk_bf16_f32 v96, v100, v101
  v_mfma_f32_16x16x32_bf16 v[204:207], a[164:167], v[76:79], v[204:207]
  v_cvt_pk_bf16_f32 v97, v102, v103
  v_mfma_f32_16x16x32_bf16 v[208:211], a[176:179], v[76:79], v[208:211]
  v_cvt_pk_bf16_f32 v98, v104, v105
  v_mfma_f32_16x16x32_bf16 v[212:215], a[188:191], v[76:79], v[212:215]
  v_cvt_pk_bf16_f32 v99, v106, v107
  v_mfma_f32_16x16x32_bf16 v[216:219], a[200:203], v[76:79], v[216:219]
  v_cvt_pk_bf16_f32 v100, v108, v109
  v_mfma_f32_16x16x32_bf16 v[220:223], a[212:215], v[76:79], v[220:223]
  v_cvt_pk_bf16_f32 v101, v110, v111
  v_mfma_f32_16x16x32_bf16 v[204:207], a[168:171], v[78:81], v[204:207]
  v_mfma_f32_16x16x32_bf16 v[208:211], a[180:183], v[78:81], v[208:211]
  v_mfma_f32_16x16x32_bf16 v[212:215], a[192:195], v[78:81], v[212:215]
  v_mfma_f32_16x16x32_bf16 v[216:219], a[204:207], v[78:81], v[216:219]
  v_mfma_f32_16x16x32_bf16 v[220:223], a[216:219], v[78:81], v[220:223]
  s_nop 3
  v_max3_f32 v244, v204, v205, v206
  v_max3_f32 v244, v244, v207, v208
  v_max3_f32 v244, v244, v209, v210
  v_max3_f32 v244, v244, v211, v212
  v_max3_f32 v244, v244, v213, v214
  v_max3_f32 v244, v244, v215, v216
  v_max3_f32 v244, v244, v217, v218
  v_max3_f32 v244, v244, v219, v220
  v_max3_f32 v244, v244, v221, v222
  v_max_f32 v244, v244, v223
  v_min3_f32 v245, v204, v205, v206
  v_min3_f32 v245, v245, v207, v208
  v_min3_f32 v245, v245, v209, v210
  v_min3_f32 v245, v245, v211, v212
  v_min3_f32 v245, v245, v213, v214
  v_min3_f32 v245, v245, v215, v216
  v_min3_f32 v245, v245, v217, v218
  v_min3_f32 v245, v245, v219, v220
  v_min3_f32 v245, v245, v221, v222
  v_min_f32 v245, v245, v223
  v_mul_f32 v246, s12, v244
  v_mul_f32 v247, s12, v245
  v_pk_fma_f32 v[112:113], v[204:205], s[12:13], v[246:247] op_sel_hi:[1,1,0] neg_lo:[0,0,1] neg_hi:[0,0,1]
  v_pk_fma_f32 v[114:115], v[206:207], s[12:13], v[246:247] op_sel_hi:[1,1,0] neg_lo:[0,0,1] neg_hi:[0,0,1]
  v_pk_fma_f32 v[116:117], v[208:209], s[12:13], v[246:247] op_sel_hi:[1,1,0] neg_lo:[0,0,1] neg_hi:[0,0,1]
  v_pk_fma_f32 v[118:119], v[210:211], s[12:13], v[246:247] op_sel_hi:[1,1,0] neg_lo:[0,0,1] neg_hi:[0,0,1]
  v_pk_fma_f32 v[120:121], v[212:213], s[12:13], v[246:247] op_sel_hi:[1,1,0] neg_lo:[0,0,1] neg_hi:[0,0,1]
  v_pk_fma_f32 v[122:123], v[214:215], s[12:13], v[246:247] op_sel_hi:[1,1,0] neg_lo:[0,0,1] neg_hi:[0,0,1]
  v_pk_fma_f32 v[124:125], v[216:217], s[12:13], v[246:247] op_sel_hi:[1,1,0] neg_lo:[0,0,1] neg_hi:[0,0,1]
  v_pk_fma_f32 v[126:127], v[218:219], s[12:13], v[246:247] op_sel_hi:[1,1,0] neg_lo:[0,0,1] neg_hi:[0,0,1]
  v_pk_fma_f32 v[128:129], v[220:221], s[12:13], v[246:247] op_sel_hi:[1,1,0] neg_lo:[0,0,1] neg_hi:[0,0,1]
  v_pk_fma_f32 v[130:131], v[222:223], s[12:13], v[246:247] op_sel_hi:[1,1,0] neg_lo:[0,0,1] neg_hi:[0,0,1]
  v_pk_fma_f32 v[132:133], v[204:205], s[12:13], v[246:247] op_sel:[0,0,1] op_sel_hi:[1,1,1] neg_lo:[1,0,0] neg_hi:[1,0,0]
  v_pk_fma_f32 v[134:135], v[206:207], s[12:13], v[246:247] op_sel:[0,0,1] op_sel_hi:[1,1,1] neg_lo:[1,0,0] neg_hi:[1,0,0]
  v_pk_fma_f32 v[136:137], v[208:209], s[12:13], v[246:247] op_sel:[0,0,1] op_sel_hi:[1,1,1] neg_lo:[1,0,0] neg_hi:[1,0,0]
  v_pk_fma_f32 v[138:139], v[210:211], s[12:13], v[246:247] op_sel:[0,0,1] op_sel_hi:[1,1,1] neg_lo:[1,0,0] neg_hi:[1,0,0]
  v_pk_fma_f32 v[140:141], v[212:213], s[12:13], v[246:247] op_sel:[0,0,1] op_sel_hi:[1,1,1] neg_lo:[1,0,0] neg_hi:[1,0,0]
  v_pk_fma_f32 v[142:143], v[214:215], s[12:13], v[246:247] op_sel:[0,0,1] op_sel_hi:[1,1,1] neg_lo:[1,0,0] neg_hi:[1,0,0]
  v_pk_fma_f32 v[144:145], v[216:217], s[12:13], v[246:247] op_sel:[0,0,1] op_sel_hi:[1,1,1] neg_lo:[1,0,0] neg_hi:[1,0,0]
  v_pk_fma_f32 v[146:147], v[218:219], s[12:13], v[246:247] op_sel:[0,0,1] op_sel_hi:[1,1,1] neg_lo:[1,0,0] neg_hi:[1,0,0]
  v_pk_fma_f32 v[148:149], v[220:221], s[12:13], v[246:247] op_sel:[0,0,1] op_sel_hi:[1,1,1] neg_lo:[1,0,0] neg_hi:[1,0,0]
  v_pk_fma_f32 v[150:151], v[222:223], s[12:13], v[246:247] op_sel:[0,0,1] op_sel_hi:[1,1,1] neg_lo:[1,0,0] neg_hi:[1,0,0]
  v_mfma_f32_16x16x32_bf16 v[152:155], a[160:163], v[92:95], 0
  v_exp_f32 v112, v112
  v_exp_f32 v113, v113
  v_mfma_f32_16x16x32_bf16 v[156:159], a[172:175], v[92:95], 0
  v_exp_f32 v114, v114
  v_exp_f32 v115, v115
  v_mfma_f32_16x16x32_bf16 v[160:163], a[184:187], v[92:95], 0
  v_exp_f32 v116, v116
  v_exp_f32 v117, v117
  v_exp_f32 v118, v118
  v_mfma_f32_16x16x32_bf16 v[164:167], a[196:199], v[92:95], 0
  v_exp_f32 v119, v119
  v_exp_f32 v120, v120
  v_mfma_f32_16x16x32_bf16 v[168:171], a[208:211], v[92:95], 0
  v_exp_f32 v121, v121
  v_exp_f32 v122, v122
  v_exp_f32 v123, v123
  v_mfma_f32_16x16x32_bf16 v[152:155], a[164:167], v[96:99], v[152:155]
  v_exp_f32 v124, v124
  v_exp_f32 v125, v125
  v_mfma_f32_16x16x32_bf16 v[156:159], a[176:179], v[96:99], v[156:159]
  v_exp_f32 v126, v126
  v_exp_f32 v127, v127
  v_mfma_f32_16x16x32_bf16 v[160:163], a[188:191], v[96:99], v[160:163]
  v_exp_f32 v128, v128
  v_exp_f32 v129, v129
  v_exp_f32 v130, v130
  v_mfma_f32_16x16x32_bf16 v[164:167], a[200:203], v[96:99], v[164:167]
  v_exp_f32 v131, v131
  v_exp_f32 v132, v132
  v_mfma_f32_16x16x32_bf16 v[168:171], a[212:215], v[96:99], v[168:171]
  v_exp_f32 v133, v133
  v_exp_f32 v134, v134
  v_exp_f32 v135, v135
  v_mfma_f32_16x16x32_bf16 v[152:155], a[168:171], v[98:101], v[152:155]
  v_exp_f32 v136, v136
  v_exp_f32 v137, v137
  v_mfma_f32_16x16x32_bf16 v[156:159], a[180:183], v[98:101], v[156:159]
  v_exp_f32 v138, v138
  v_exp_f32 v139, v139
  v_mfma_f32_16x16x32_bf16 v[160:163], a[192:195], v[98:101], v[160:163]
  v_exp_f32 v140, v140
  v_exp_f32 v141, v141
  v_exp_f32 v142, v142
  v_mfma_f32_16x16x32_bf16 v[164:167], a[204:207], v[98:101], v[164:167]
  v_exp_f32 v143, v143
  v_exp_f32 v144, v144
  v_mfma_f32_16x16x32_bf16 v[168:171], a[216:219], v[98:101], v[168:171]
  v_exp_f32 v145, v145
  v_exp_f32 v146, v146
  v_exp_f32 v147, v147
  v_exp_f32 v148, v148
  v_exp_f32 v149, v149
  v_exp_f32 v150, v150
  v_exp_f32 v151, v151
  v_pk_add_f32 v[248:249], v[112:113], v[114:115]
  v_pk_add_f32 v[248:249], v[248:249], v[116:117]
  v_pk_add_f32 v[248:249], v[248:249], v[118:119]
  v_pk_add_f32 v[248:249], v[248:249], v[120:121]
  v_pk_add_f32 v[248:249], v[248:249], v[122:123]
  v_pk_add_f32 v[248:249], v[248:249], v[124:125]
  v_pk_add_f32 v[248:249], v[248:249], v[126:127]
  v_pk_add_f32 v[248:249], v[248:249], v[128:129]
  v_pk_add_f32 v[248:249], v[248:249], v[130:131]
  v_add_f32 v248, v248, v249
  v_pk_add_f32 v[250:251], v[132:133], v[134:135]
  v_pk_add_f32 v[250:251], v[250:251], v[136:137]
  v_pk_add_f32 v[250:251], v[250:251], v[138:139]
  v_pk_add_f32 v[250:251], v[250:251], v[140:141]
  v_pk_add_f32 v[250:251], v[250:251], v[142:143]
  v_pk_add_f32 v[250:251], v[250:251], v[144:145]
  v_pk_add_f32 v[250:251], v[250:251], v[146:147]
  v_pk_add_f32 v[250:251], v[250:251], v[148:149]
  v_pk_add_f32 v[250:251], v[250:251], v[150:151]
  v_add_f32 v250, v250, v251
  v_rcp_f32 v250, v250
  v_mul_f32 v23, 0x358637bd, v248
  v_mul_f32 v250, v250, v248
  buffer_load_dword v22, v19, s[52:55], s71 offen sc1
  v_pk_mul_f32 v[132:133], v[132:133], v[250:251] op_sel_hi:[1,0]
  v_pk_mul_f32 v[134:135], v[134:135], v[250:251] op_sel_hi:[1,0]
  v_pk_mul_f32 v[136:137], v[136:137], v[250:251] op_sel_hi:[1,0]
  v_pk_mul_f32 v[138:139], v[138:139], v[250:251] op_sel_hi:[1,0]
  v_pk_mul_f32 v[140:141], v[140:141], v[250:251] op_sel_hi:[1,0]
  v_pk_mul_f32 v[142:143], v[142:143], v[250:251] op_sel_hi:[1,0]
  v_pk_mul_f32 v[144:145], v[144:145], v[250:251] op_sel_hi:[1,0]
  v_pk_mul_f32 v[146:147], v[146:147], v[250:251] op_sel_hi:[1,0]
  v_pk_mul_f32 v[148:149], v[148:149], v[250:251] op_sel_hi:[1,0]
  v_pk_mul_f32 v[150:151], v[150:151], v[250:251] op_sel_hi:[1,0]
  v_cvt_pk_bf16_f32 v32, v112, v113
  v_cvt_pk_bf16_f32 v33, v114, v115
  v_cvt_pk_bf16_f32 v34, v116, v117
  v_cvt_pk_bf16_f32 v35, v118, v119
  v_cvt_pk_bf16_f32 v36, v120, v121
  v_cvt_pk_bf16_f32 v37, v122, v123
  v_cvt_pk_bf16_f32 v38, v124, v125
  v_cvt_pk_bf16_f32 v39, v126, v127
  v_cvt_pk_bf16_f32 v40, v128, v129
  v_cvt_pk_bf16_f32 v41, v130, v131
  v_cvt_pk_bf16_f32 v42, v132, v133
  v_cvt_pk_bf16_f32 v43, v134, v135
  v_cvt_pk_bf16_f32 v44, v136, v137
  v_cvt_pk_bf16_f32 v45, v138, v139
  v_cvt_pk_bf16_f32 v46, v140, v141
  v_cvt_pk_bf16_f32 v47, v142, v143
  v_cvt_pk_bf16_f32 v48, v144, v145
  v_cvt_pk_bf16_f32 v49, v146, v147
  v_cvt_pk_bf16_f32 v50, v148, v149
  v_cvt_pk_bf16_f32 v51, v150, v151
  s_mov_b64 s[100:101], -1
  s_waitcnt vmcnt(0)
  v_cmp_ne_u32 vcc, s14, v22
  s_mov_b32 s9, 0
  s_and_b64 vcc, vcc, s[100:101]
  s_cbranch_scc0 A_p1_ok
A_p1:
  buffer_load_dword v22, v19, s[52:55], s71 offen sc1
  s_waitcnt vmcnt(0)
  v_cmp_ne_u32 vcc, s14, v22
  s_add_u32 s9, s9, 1
  s_and_b64 vcc, vcc, s[100:101]
  s_cbranch_scc0 A_p1_ok
  s_sleep 1
  s_cmp_lt_u32 s9, 0x40000
  s_cbranch_scc1 A_p1
A_p1_ok:
  s_lshl_b32 s70, s10, 2
  s_add_u32 s70, s70, s4
  s_mul_i32 s70, s70, 4096
  s_add_u32 s70, s70, 65536
  v_lshlrev_b32 v19, 4, v0
  buffer_load_dwordx4 v[204:207], v19, s[52:55], s70 offen offset:0 sc1
  buffer_load_dwordx4 v[208:211], v19, s[52:55], s70 offen offset:1024 sc1
  buffer_load_dwordx4 v[212:215], v19, s[52:55], s70 offen offset:2048 sc1
  buffer_load_dwordx4 v[216:219], v19, s[52:55], s70 offen offset:3072 sc1
  s_mul_i32 s70, s4, 2304
  v_add_u32 v1, s70, v1
  v_add_u32 v2, s70, v2
  v_add_u32 v3, s70, v3
  v_add_u32 v4, s70, v4
  v_max3_f32 v244, v152, v153, v154
  v_max3_f32 v244, v244, v155, v156
  v_max3_f32 v244, v244, v157, v158
  v_max3_f32 v244, v244, v159, v160
  v_max3_f32 v244, v244, v161, v162
  v_max3_f32 v244, v244, v163, v164
  v_max3_f32 v244, v244, v165, v166
  v_max3_f32 v244, v244, v167, v168
  v_max3_f32 v244, v244, v169, v170
  v_max_f32 v244, v244, v171
  v_min3_f32 v245, v152, v153, v154
  v_min3_f32 v245, v245, v155, v156
  v_min3_f32 v245, v245, v157, v158
  v_min3_f32 v245, v245, v159, v160
  v_min3_f32 v245, v245, v161, v162
  v_min3_f32 v245, v245, v163, v164
  v_min3_f32 v245, v245, v165, v166
  v_min3_f32 v245, v245, v167, v168
  v_min3_f32 v245, v245, v169, v170
  v_min_f32 v245, v245, v171
  v_mul_f32 v246, s12, v244
  v_mul_f32 v247, s12, v245
  v_pk_fma_f32 v[112:113], v[152:153], s[12:13], v[246:247] op_sel_hi:[1,1,0] neg_lo:[0,0,1] neg_hi:[0,0,1]
  v_pk_fma_f32 v[114:115], v[154:155], s[12:13], v[246:247] op_sel_hi:[1,1,0] neg_lo:[0,0,1] neg_hi:[0,0,1]
  v_pk_fma_f32 v[116:117], v[156:157], s[12:13], v[246:247] op_sel_hi:[1,1,0] neg_lo:[0,0,1] neg_hi:[0,0,1]
  v_pk_fma_f32 v[118:119], v[158:159], s[12:13], v[246:247] op_sel_hi:[1,1,0] neg_lo:[0,0,1] neg_hi:[0,0,1]
  v_pk_fma_f32 v[120:121], v[160:161], s[12:13], v[246:247] op_sel_hi:[1,1,0] neg_lo:[0,0,1] neg_hi:[0,0,1]
  v_pk_fma_f32 v[122:123], v[162:163], s[12:13], v[246:247] op_sel_hi:[1,1,0] neg_lo:[0,0,1] neg_hi:[0,0,1]
  v_pk_fma_f32 v[124:125], v[164:165], s[12:13], v[246:247] op_sel_hi:[1,1,0] neg_lo:[0,0,1] neg_hi:[0,0,1]
  v_pk_fma_f32 v[126:127], v[166:167], s[12:13], v[246:247] op_sel_hi:[1,1,0] neg_lo:[0,0,1] neg_hi:[0,0,1]
  v_pk_fma_f32 v[128:129], v[168:169], s[12:13], v[246:247] op_sel_hi:[1,1,0] neg_lo:[0,0,1] neg_hi:[0,0,1]
  v_pk_fma_f32 v[130:131], v[170:171], s[12:13], v[246:247] op_sel_hi:[1,1,0] neg_lo:[0,0,1] neg_hi:[0,0,1]
  v_pk_fma_f32 v[132:133], v[152:153], s[12:13], v[246:247] op_sel:[0,0,1] op_sel_hi:[1,1,1] neg_lo:[1,0,0] neg_hi:[1,0,0]
  v_pk_fma_f32 v[134:135], v[154:155], s[12:13], v[246:247] op_sel:[0,0,1] op_sel_hi:[1,1,1] neg_lo:[1,0,0] neg_hi:[1,0,0]
  v_pk_fma_f32 v[136:137], v[156:157], s[12:13], v[246:247] op_sel:[0,0,1] op_sel_hi:[1,1,1] neg_lo:[1,0,0] neg_hi:[1,0,0]
  v_pk_fma_f32 v[138:139], v[158:159], s[12:13], v[246:247] op_sel:[0,0,1] op_sel_hi:[1,1,1] neg_lo:[1,0,0] neg_hi:[1,0,0]
  v_pk_fma_f32 v[140:141], v[160:161], s[12:13], v[246:247] op_sel:[0,0,1] op_sel_hi:[1,1,1] neg_lo:[1,0,0] neg_hi:[1,0,0]
  v_pk_fma_f32 v[142:143], v[162:163], s[12:13], v[246:247] op_sel:[0,0,1] op_sel_hi:[1,1,1] neg_lo:[1,0,0] neg_hi:[1,0,0]
  v_pk_fma_f32 v[144:145], v[164:165], s[12:13], v[246:247] op_sel:[0,0,1] op_sel_hi:[1,1,1] neg_lo:[1,0,0] neg_hi:[1,0,0]
  v_pk_fma_f32 v[146:147], v[166:167], s[12:13], v[246:247] op_sel:[0,0,1] op_sel_hi:[1,1,1] neg_lo:[1,0,0] neg_hi:[1,0,0]
  v_pk_fma_f32 v[148:149], v[168:169], s[12:13], v[246:247] op_sel:[0,0,1] op_sel_hi:[1,1,1] neg_lo:[1,0,0] neg_hi:[1,0,0]
  v_pk_fma_f32 v[150:151], v[170:171], s[12:13], v[246:247] op_sel:[0,0,1] op_sel_hi:[1,1,1] neg_lo:[1,0,0] neg_hi:[1,0,0]
  v_exp_f32 v112, v112
  v_exp_f32 v113, v113
  v_exp_f32 v114, v114
  v_exp_f32 v115, v115
  v_exp_f32 v116, v116
  v_exp_f32 v117, v117
  v_exp_f32 v118, v118
  v_exp_f32 v119, v119
  v_exp_f32 v120, v120
  v_exp_f32 v121, v121
  v_exp_f32 v122, v122
  v_exp_f32 v123, v123
  v_exp_f32 v124, v124
  v_exp_f32 v125, v125
  v_exp_f32 v126, v126
  v_exp_f32 v127, v127
  v_exp_f32 v128, v128
  v_exp_f32 v129, v129
  v_exp_f32 v130, v130
  v_exp_f32 v131, v131
  v_exp_f32 v132, v132
  v_exp_f32 v133, v133
  v_exp_f32 v134, v134
  v_exp_f32 v135, v135
  v_exp_f32 v136, v136
  v_exp_f32 v137, v137
  v_exp_f32 v138, v138
  v_exp_f32 v139, v139
  v_exp_f32 v140, v140
  v_exp_f32 v141, v141
  v_exp_f32 v142, v142
  v_exp_f32 v143, v143
  v_exp_f32 v144, v144
  v_exp_f32 v145, v145
  v_exp_f32 v146, v146
  v_exp_f32 v147, v147
  v_exp_f32 v148, v148
  v_exp_f32 v149, v149
  v_exp_f32 v150, v150
  v_exp_f32 v151, v151
  v_pk_add_f32 v[248:249], v[112:113], v[114:115]
  v_pk_add_f32 v[248:249], v[248:249], v[116:117]
  v_pk_add_f32 v[248:249], v[248:249], v[118:119]
  v_pk_add_f32 v[248:249], v[248:249], v[120:121]
  v_pk_add_f32 v[248:249], v[248:249], v[122:123]
  v_pk_add_f32 v[248:249], v[248:249], v[124:125]
  v_pk_add_f32 v[248:249], v[248:249], v[126:127]
  v_pk_add_f32 v[248:249], v[248:249], v[128:129]
  v_pk_add_f32 v[248:249], v[248:249], v[130:131]
  v_add_f32 v248, v248, v249
  v_pk_add_f32 v[250:251], v[132:133], v[134:135]
  v_pk_add_f32 v[250:251], v[250:251], v[136:137]
  v_pk_add_f32 v[250:251], v[250:251], v[138:139]
  v_pk_add_f32 v[250:251], v[250:251], v[140:141]
  v_pk_add_f32 v[250:251], v[250:251], v[142:143]
  v_pk_add_f32 v[250:251], v[250:251], v[144:145]
  v_pk_add_f32 v[250:251], v[250:251], v[146:147]
  v_pk_add_f32 v[250:251], v[250:251], v[148:149]
  v_pk_add_f32 v[250:251], v[250:251], v[150:151]
  v_add_f32 v250, v250, v251
  v_rcp_f32 v250, v250
  v_mul_f32 v24, 0x358637bd, v248
  v_mul_f32 v250, v250, v248
  v_pk_mul_f32 v[132:133], v[132:133], v[250:251] op_sel_hi:[1,0]
  v_pk_mul_f32 v[134:135], v[134:135], v[250:251] op_sel_hi:[1,0]
  v_pk_mul_f32 v[136:137], v[136:137], v[250:251] op_sel_hi:[1,0]
  v_pk_mul_f32 v[138:139], v[138:139], v[250:251] op_sel_hi:[1,0]
  v_pk_mul_f32 v[140:141], v[140:141], v[250:251] op_sel_hi:[1,0]
  v_pk_mul_f32 v[142:143], v[142:143], v[250:251] op_sel_hi:[1,0]
  v_pk_mul_f32 v[144:145], v[144:145], v[250:251] op_sel_hi:[1,0]
  v_pk_mul_f32 v[146:147], v[146:147], v[250:251] op_sel_hi:[1,0]
  v_pk_mul_f32 v[148:149], v[148:149], v[250:251] op_sel_hi:[1,0]
  v_pk_mul_f32 v[150:151], v[150:151], v[250:251] op_sel_hi:[1,0]
  v_cvt_pk_bf16_f32 v52, v112, v113
  v_cvt_pk_bf16_f32 v53, v114, v115
  v_cvt_pk_bf16_f32 v54, v116, v117
  v_cvt_pk_bf16_f32 v55, v118, v119
  v_cvt_pk_bf16_f32 v56, v120, v121
  v_cvt_pk_bf16_f32 v57, v122, v123
  v_cvt_pk_bf16_f32 v58, v124, v125
  v_cvt_pk_bf16_f32 v59, v126, v127
  v_cvt_pk_bf16_f32 v60, v128, v129
  v_cvt_pk_bf16_f32 v61, v130, v131
  v_cvt_pk_bf16_f32 v62, v132, v133
  v_cvt_pk_bf16_f32 v63, v134, v135
  v_cvt_pk_bf16_f32 v64, v136, v137
  v_cvt_pk_bf16_f32 v65, v138, v139
  v_cvt_pk_bf16_f32 v66, v140, v141
  v_cvt_pk_bf16_f32 v67, v142, v143
  v_cvt_pk_bf16_f32 v68, v144, v145
  v_cvt_pk_bf16_f32 v69, v146, v147
  v_cvt_pk_bf16_f32 v70, v148, v149
  v_cvt_pk_bf16_f32 v71, v150, v151
  s_waitcnt vmcnt(3)
  v_cvt_pk_bf16_f32 v192, v204, v205
  v_cvt_pk_bf16_f32 v193, v206, v207
  s_waitcnt vmcnt(2)
  v_cvt_pk_bf16_f32 v194, v208, v209
  v_cvt_pk_bf16_f32 v195, v210, v211
  s_waitcnt vmcnt(1)
  v_cvt_pk_bf16_f32 v196, v212, v213
  v_cvt_pk_bf16_f32 v197, v214, v215
  s_waitcnt vmcnt(0)
  v_cvt_pk_bf16_f32 v198, v216, v217
  v_cvt_pk_bf16_f32 v199, v218, v219
  ds_write_b64 v1, v[192:193]
  ds_write_b64 v2, v[194:195]
  ds_write_b64 v3, v[196:197]
  ds_write_b64 v4, v[198:199]
  v_cmp_ne_u32 s[100:101], -1, v25
  s_waitcnt lgkmcnt(0)
  s_barrier
  s_mov_b64 exec, s[100:101]
  ds_read_b128 a[0:3], v25 offset:1920
  ds_read_b128 a[4:7], v25 offset:1936
  ds_read_b128 a[8:11], v25 offset:1952
  ds_read_b128 a[12:15], v25 offset:1968
  ds_read_b128 a[16:19], v25 offset:1984
  s_mov_b64 exec, -1
  s_lshl_b32 s70, s5, 2
  s_add_u32 s70, s70, s4
  s_lshl_b32 s70, s70, 4
  s_add_u32 s70, s70, s10
  s_mul_i32 s70, s70, 2560
  s_add_u32 s70, s70, 1048576
  s_add_u32 s71, s70, 20480
  v_lshlrev_b32 v19, 4, v0
  v_lshlrev_b32 v20, 3, v0
  v_add_u32 v20, 0x800, v20
  s_waitcnt lgkmcnt(4)
  v_mfma_f32_16x16x32_bf16 v[212:215], a[0:3], v[32:35], 0
  s_add_u32 m0, s3, 40960
  s_add_u32 s7, s6, 327680
  v_mfma_f32_16x16x32_bf16 v[236:239], a[0:3], v[52:55], 0
  s_mov_b64 exec, s[100:101]
  ds_read_b128 a[20:23], v25 offset:0
  ds_read_b128 a[24:27], v25 offset:16
  ds_read_b128 a[28:31], v25 offset:32
  ds_read_b128 a[32:35], v25 offset:48
  ds_read_b128 a[36:39], v25 offset:64
  s_mov_b64 exec, -1
  s_waitcnt lgkmcnt(8)
  v_mfma_f32_16x16x32_bf16 v[212:215], a[4:7], v[36:39], v[212:215]
  buffer_load_dwordx4 v252, s[64:67], s7 offen offset:0 lds
  v_mfma_f32_16x16x32_bf16 v[236:239], a[4:7], v[56:59], v[236:239]
  s_waitcnt lgkmcnt(7)
  v_mfma_f32_16x16x32_bf16 v[212:215], a[8:11], v[40:43], v[212:215]
  buffer_load_dwordx4 v253, s[64:67], s7 offen offset:1024 lds
  v_mfma_f32_16x16x32_bf16 v[236:239], a[8:11], v[60:63], v[236:239]
  s_waitcnt lgkmcnt(6)
  v_mfma_f32_16x16x32_bf16 v[212:215], a[12:15], v[44:47], v[212:215]
  v_mfma_f32_16x16x32_bf16 v[236:239], a[12:15], v[64:67], v[236:239]
  buffer_load_dwordx4 v254, s[64:67], s7 offen offset:2048 lds
  s_waitcnt lgkmcnt(5)
  v_mfma_f32_16x16x32_bf16 v[212:215], a[16:19], v[48:51], v[212:215]
  v_mfma_f32_16x16x32_bf16 v[236:239], a[16:19], v[68:71], v[236:239]
  buffer_load_dwordx4 v255, s[64:67], s7 offen offset:3072 lds
  s_addk_i32 m0, 0x1000
  s_waitcnt lgkmcnt(4)
  v_mfma_f32_16x16x32_bf16 v[192:195], a[20:23], v[32:35], 0
  v_mfma_f32_16x16x32_bf16 v[216:219], a[20:23], v[52:55], 0
  buffer_load_dwordx4 v26, s[64:67], s7 offen offset:0 lds
  s_add_u32 m0, s3, 61440
  s_add_u32 s7, s6, 491520
  s_mov_b64 exec, s[100:101]
  ds_read_b128 a[0:3], v25 offset:384
  ds_read_b128 a[4:7], v25 offset:400
  ds_read_b128 a[8:11], v25 offset:416
  ds_read_b128 a[12:15], v25 offset:432
  ds_read_b128 a[16:19], v25 offset:448
  s_mov_b64 exec, -1
  s_waitcnt lgkmcnt(8)
  v_mfma_f32_16x16x32_bf16 v[192:195], a[24:27], v[36:39], v[192:195]
  v_mfma_f32_16x16x32_bf16 v[216:219], a[24:27], v[56:59], v[216:219]
  s_waitcnt lgkmcnt(7)
  v_mfma_f32_16x16x32_bf16 v[192:195], a[28:31], v[40:43], v[192:195]
  buffer_load_dwordx4 v252, s[64:67], s7 offen offset:0 lds
  v_mfma_f32_16x16x32_bf16 v[216:219], a[28:31], v[60:63], v[216:219]
  v_add_f32 v212, v212, v23
  v_rcp_f32 v212, v212
  v_add_f32 v236, v236, v24
  v_rcp_f32 v236, v236
  s_waitcnt lgkmcnt(6)
  v_mfma_f32_16x16x32_bf16 v[192:195], a[32:35], v[44:47], v[192:195]
  buffer_load_dwordx4 v253, s[64:67], s7 offen offset:1024 lds
  v_mfma_f32_16x16x32_bf16 v[216:219], a[32:35], v[64:67], v[216:219]
  s_waitcnt lgkmcnt(5)
  v_mfma_f32_16x16x32_bf16 v[192:195], a[36:39], v[48:51], v[192:195]
  v_mfma_f32_16x16x32_bf16 v[216:219], a[36:39], v[68:71], v[216:219]
  buffer_load_dwordx4 v254, s[64:67], s7 offen offset:2048 lds
  s_waitcnt lgkmcnt(4)
  v_mfma_f32_16x16x32_bf16 v[196:199], a[0:3], v[32:35], 0
  v_mfma_f32_16x16x32_bf16 v[220:223], a[0:3], v[52:55], 0
  buffer_load_dwordx4 v255, s[64:67], s7 offen offset:3072 lds
  s_addk_i32 m0, 0x1000
  s_mov_b64 exec, s[100:101]
  ds_read_b128 a[20:23], v25 offset:768
  ds_read_b128 a[24:27], v25 offset:784
  ds_read_b128 a[28:31], v25 offset:800
  ds_read_b128 a[32:35], v25 offset:816
  ds_read_b128 a[36:39], v25 offset:832
  s_mov_b64 exec, -1
  s_waitcnt lgkmcnt(8)
  v_mfma_f32_16x16x32_bf16 v[196:199], a[4:7], v[36:39], v[196:199]
  v_mfma_f32_16x16x32_bf16 v[220:223], a[4:7], v[56:59], v[220:223]
  buffer_load_dwordx4 v26, s[64:67], s7 offen offset:0 lds
  s_add_u32 m0, s3, 81920
  s_add_u32 s7, s6, 655360
  s_waitcnt lgkmcnt(7)
  v_mfma_f32_16x16x32_bf16 v[196:199], a[8:11], v[40:43], v[196:199]
  v_mfma_f32_16x16x32_bf16 v[220:223], a[8:11], v[60:63], v[220:223]
  s_waitcnt lgkmcnt(6)
  v_mfma_f32_16x16x32_bf16 v[196:199], a[12:15], v[44:47], v[196:199]
  buffer_load_dwordx4 v252, s[64:67], s7 offen offset:0 lds
  v_mfma_f32_16x16x32_bf16 v[220:223], a[12:15], v[64:67], v[220:223]
  s_waitcnt lgkmcnt(5)
  v_mfma_f32_16x16x32_bf16 v[196:199], a[16:19], v[48:51], v[196:199]
  buffer_load_dwordx4 v253, s[64:67], s7 offen offset:1024 lds
  v_mfma_f32_16x16x32_bf16 v[220:223], a[16:19], v[68:71], v[220:223]
  s_waitcnt lgkmcnt(4)
  v_mfma_f32_16x16x32_bf16 v[200:203], a[20:23], v[32:35], 0
  v_mfma_f32_16x16x32_bf16 v[224:227], a[20:23], v[52:55], 0
  buffer_load_dwordx4 v254, s[64:67], s7 offen offset:2048 lds
  s_mov_b64 exec, s[100:101]
  ds_read_b128 a[0:3], v25 offset:1152
  ds_read_b128 a[4:7], v25 offset:1168
  ds_read_b128 a[8:11], v25 offset:1184
  ds_read_b128 a[12:15], v25 offset:1200
  ds_read_b128 a[16:19], v25 offset:1216
  s_mov_b64 exec, -1
  s_waitcnt lgkmcnt(8)
  v_mfma_f32_16x16x32_bf16 v[200:203], a[24:27], v[36:39], v[200:203]
  v_mfma_f32_16x16x32_bf16 v[224:227], a[24:27], v[56:59], v[224:227]
  buffer_load_dwordx4 v255, s[64:67], s7 offen offset:3072 lds
  s_addk_i32 m0, 0x1000
  s_waitcnt lgkmcnt(7)
  v_mfma_f32_16x16x32_bf16 v[200:203], a[28:31], v[40:43], v[200:203]
  v_mfma_f32_16x16x32_bf16 v[224:227], a[28:31], v[60:63], v[224:227]
  buffer_load_dwordx4 v26, s[64:67], s7 offen offset:0 lds
  s_waitcnt lgkmcnt(6)
  v_mfma_f32_16x16x32_bf16 v[200:203], a[32:35], v[44:47], v[200:203]
  v_mfma_f32_16x16x32_bf16 v[224:227], a[32:35], v[64:67], v[224:227]
  s_waitcnt lgkmcnt(5)
  v_mfma_f32_16x16x32_bf16 v[200:203], a[36:39], v[48:51], v[200:203]
  v_mfma_f32_16x16x32_bf16 v[224:227], a[36:39], v[68:71], v[224:227]
  s_waitcnt lgkmcnt(4)
  v_mfma_f32_16x16x32_bf16 v[204:207], a[0:3], v[32:35], 0
  v_mfma_f32_16x16x32_bf16 v[228:231], a[0:3], v[52:55], 0
  s_mov_b64 exec, s[100:101]
  ds_read_b128 a[20:23], v25 offset:1536
  ds_read_b128 a[24:27], v25 offset:1552
  ds_read_b128 a[28:31], v25 offset:1568
  ds_read_b128 a[32:35], v25 offset:1584
  ds_read_b128 a[36:39], v25 offset:1600
  s_mov_b64 exec, -1
  s_waitcnt lgkmcnt(8)
  v_mfma_f32_16x16x32_bf16 v[204:207], a[4:7], v[36:39], v[204:207]
  v_mfma_f32_16x16x32_bf16 v[228:231], a[4:7], v[56:59], v[228:231]
  s_waitcnt lgkmcnt(7)
  v_mfma_f32_16x16x32_bf16 v[204:207], a[8:11], v[40:43], v[204:207]
  v_mfma_f32_16x16x32_bf16 v[228:231], a[8:11], v[60:63], v[228:231]
  s_waitcnt lgkmcnt(6)
  v_mfma_f32_16x16x32_bf16 v[204:207], a[12:15], v[44:47], v[204:207]
  v_mfma_f32_16x16x32_bf16 v[228:231], a[12:15], v[64:67], v[228:231]
  s_waitcnt lgkmcnt(5)
  v_mfma_f32_16x16x32_bf16 v[204:207], a[16:19], v[48:51], v[204:207]
  v_mfma_f32_16x16x32_bf16 v[228:231], a[16:19], v[68:71], v[228:231]
  s_waitcnt lgkmcnt(4)
  v_mfma_f32_16x16x32_bf16 v[208:211], a[20:23], v[32:35], 0
  v_mfma_f32_16x16x32_bf16 v[232:235], a[20:23], v[52:55], 0
  s_waitcnt lgkmcnt(3)
  v_mfma_f32_16x16x32_bf16 v[208:211], a[24:27], v[36:39], v[208:211]
  v_mfma_f32_16x16x32_bf16 v[232:235], a[24:27], v[56:59], v[232:235]
  s_waitcnt lgkmcnt(2)
  v_mfma_f32_16x16x32_bf16 v[208:211], a[28:31], v[40:43], v[208:211]
  v_mfma_f32_16x16x32_bf16 v[232:235], a[28:31], v[60:63], v[232:235]
  s_waitcnt lgkmcnt(1)
  v_mfma_f32_16x16x32_bf16 v[208:211], a[32:35], v[44:47], v[208:211]
  v_mfma_f32_16x16x32_bf16 v[232:235], a[32:35], v[64:67], v[232:235]
  s_waitcnt lgkmcnt(0)
  v_mfma_f32_16x16x32_bf16 v[208:211], a[36:39], v[48:51], v[208:211]
  v_mfma_f32_16x16x32_bf16 v[232:235], a[36:39], v[68:71], v[232:235]
  v_pk_mul_f32 v[192:193], v[192:193], v[212:213] op_sel_hi:[1,0]
  v_pk_mul_f32 v[194:195], v[194:195], v[212:213] op_sel_hi:[1,0]
  v_pk_mul_f32 v[196:197], v[196:197], v[212:213] op_sel_hi:[1,0]
  v_pk_mul_f32 v[198:199], v[198:199], v[212:213] op_sel_hi:[1,0]
  v_pk_mul_f32 v[200:201], v[200:201], v[212:213] op_sel_hi:[1,0]
  v_pk_mul_f32 v[202:203], v[202:203], v[212:213] op_sel_hi:[1,0]
  v_pk_mul_f32 v[204:205], v[204:205], v[212:213] op_sel_hi:[1,0]
  v_pk_mul_f32 v[206:207], v[206:207], v[212:213] op_sel_hi:[1,0]
  v_pk_mul_f32 v[208:209], v[208:209], v[212:213] op_sel_hi:[1,0]
  v_pk_mul_f32 v[210:211], v[210:211], v[212:213] op_sel_hi:[1,0]
  v_cvt_pk_bf16_f32 v72, v192, v193
  v_cvt_pk_bf16_f32 v73, v194, v195
  v_cvt_pk_bf16_f32 v74, v196, v197
  v_cvt_pk_bf16_f32 v75, v198, v199
  v_cvt_pk_bf16_f32 v76, v200, v201
  v_cvt_pk_bf16_f32 v77, v202, v203
  v_cvt_pk_bf16_f32 v78, v204, v205
  v_cvt_pk_bf16_f32 v79, v206, v207
  v_cvt_pk_bf16_f32 v80, v208, v209
  v_cvt_pk_bf16_f32 v81, v210, v211
  buffer_store_dwordx4 v[72:75], v19, s[52:55], s70 offen sc1
  buffer_store_dwordx4 v[76:79], v19, s[52:55], s70 offen offset:1024 sc1
  buffer_store_dwordx2 v[80:81], v20, s[52:55], s70 offen sc1
  v_pk_mul_f32 v[216:217], v[216:217], v[236:237] op_sel_hi:[1,0]
  v_pk_mul_f32 v[218:219], v[218:219], v[236:237] op_sel_hi:[1,0]
  v_pk_mul_f32 v[220:221], v[220:221], v[236:237] op_sel_hi:[1,0]
  v_pk_mul_f32 v[222:223], v[222:223], v[236:237] op_sel_hi:[1,0]
  v_pk_mul_f32 v[224:225], v[224:225], v[236:237] op_sel_hi:[1,0]
  v_pk_mul_f32 v[226:227], v[226:227], v[236:237] op_sel_hi:[1,0]
  v_pk_mul_f32 v[228:229], v[228:229], v[236:237] op_sel_hi:[1,0]
  v_pk_mul_f32 v[230:231], v[230:231], v[236:237] op_sel_hi:[1,0]
  v_pk_mul_f32 v[232:233], v[232:233], v[236:237] op_sel_hi:[1,0]
  v_pk_mul_f32 v[234:235], v[234:235], v[236:237] op_sel_hi:[1,0]
  v_cvt_pk_bf16_f32 v84, v216, v217
  v_cvt_pk_bf16_f32 v85, v218, v219
  v_cvt_pk_bf16_f32 v86, v220, v221
  v_cvt_pk_bf16_f32 v87, v222, v223
  v_cvt_pk_bf16_f32 v88, v224, v225
  v_cvt_pk_bf16_f32 v89, v226, v227
  v_cvt_pk_bf16_f32 v90, v228, v229
  v_cvt_pk_bf16_f32 v91, v230, v231
  v_cvt_pk_bf16_f32 v92, v232, v233
  v_cvt_pk_bf16_f32 v93, v234, v235
  buffer_store_dwordx4 v[84:87], v19, s[52:55], s71 offen sc1
  buffer_store_dwordx4 v[88:91], v19, s[52:55], s71 offen offset:1024 sc1
  buffer_store_dwordx2 v[92:93], v20, s[52:55], s71 offen sc1
  s_waitcnt vmcnt(6)
  s_barrier
  s_mov_b32 s15, 0
  s_and_b32 s11, s2, 6
  s_cmp_lt_u32 s2, 64
  s_cselect_b32 s13, 4, 6
  s_and_b32 s11, s11, s13
  s_cmp_lg_u32 s11, 4
  s_cselect_b32 s13, 1, 0
A3_entry:
  s_lshl_b32 s70, s5, 1
  s_add_u32 s70, s70, s15
  s_lshl_b32 s70, s70, 2
  s_add_u32 s60, s70, s4
  s_lshr_b32 s71, s60, 1
  s_lshl_b32 s71, s71, 7
  s_add_u32 s71, s71, 16384
  v_and_b32 v20, 7, v0
  v_and_b32 v21, 8, v0
  v_lshlrev_b32 v16, 5, v21
  v_lshl_add_u32 v16, v20, 2, v16
  buffer_load_dword v22, v16, s[52:55], s71 offen sc1
  v_mul_u32_u24 v73, 2560, v20
  v_mul_u32_u24 v21, 10240, v21
  v_add3_u32 v73, v73, v21, v21
  v_sub_u32 v73, v73, v21
  v_add_u32 v73, 2556, v73
  v_lshrrev_b32 v20, 4, v0
  v_bfe_u32 v21, v0, 2, 2
  v_mul_u32_u24 v25, 20, v20
  v_add_u32 v25, v25, v21
  v_and_b32 v21, 3, v0
  v_mul_u32_u24 v25, 160, v25
  v_mul_u32_u24 v21, 40, v21
  v_add_u32 v25, v25, v21
  s_and_b32 s6, s10, 3
  s_mul_i32 s7, s6, 25600
  v_add_u32 v12, s7, v25
  ds_read_b64_tr_b16 a[0:1], v12 offset:0
  ds_read_b64_tr_b16 a[2:3], v12 offset:640
  ds_read_b64_tr_b16 a[4:5], v12 offset:8
  ds_read_b64_tr_b16 a[6:7], v12 offset:648
  ds_read_b64_tr_b16 a[8:9], v12 offset:16
  ds_read_b64_tr_b16 a[10:11], v12 offset:656
  ds_read_b64_tr_b16 a[12:13], v12 offset:24
  ds_read_b64_tr_b16 a[14:15], v12 offset:664
  ds_read_b64_tr_b16 a[16:17], v12 offset:32
  ds_read_b64_tr_b16 a[18:19], v12 offset:672
  ds_read_b64_tr_b16 a[20:21], v12 offset:1280
  ds_read_b64_tr_b16 a[22:23], v12 offset:1920
  ds_read_b64_tr_b16 a[24:25], v12 offset:1288
  ds_read_b64_tr_b16 a[26:27], v12 offset:1928
  ds_read_b64_tr_b16 a[28:29], v12 offset:1296
  ds_read_b64_tr_b16 a[30:31], v12 offset:1936
  ds_read_b64_tr_b16 a[32:33], v12 offset:1304
  ds_read_b64_tr_b16 a[34:35], v12 offset:1944
  ds_read_b64_tr_b16 a[36:37], v12 offset:1312
  ds_read_b64_tr_b16 a[38:39], v12 offset:1952
  ds_read_b64_tr_b16 a[40:41], v12 offset:12800
  ds_read_b64_tr_b16 a[42:43], v12 offset:13440
  ds_read_b64_tr_b16 a[44:45], v12 offset:12808
  ds_read_b64_tr_b16 a[46:47], v12 offset:13448
  ds_read_b64_tr_b16 a[48:49], v12 offset:12816
  ds_read_b64_tr_b16 a[50:51], v12 offset:13456
  ds_read_b64_tr_b16 a[52:53], v12 offset:12824
  ds_read_b64_tr_b16 a[54:55], v12 offset:13464
  ds_read_b64_tr_b16 a[56:57], v12 offset:12832
  ds_read_b64_tr_b16 a[58:59], v12 offset:13472
  ds_read_b64_tr_b16 a[60:61], v12 offset:14080
  ds_read_b64_tr_b16 a[62:63], v12 offset:14720
  ds_read_b64_tr_b16 a[64:65], v12 offset:14088
  ds_read_b64_tr_b16 a[66:67], v12 offset:14728
  ds_read_b64_tr_b16 a[68:69], v12 offset:14096
  ds_read_b64_tr_b16 a[70:71], v12 offset:14736
  ds_read_b64_tr_b16 a[72:73], v12 offset:14104
  ds_read_b64_tr_b16 a[74:75], v12 offset:14744
  ds_read_b64_tr_b16 a[76:77], v12 offset:14112
  ds_read_b64_tr_b16 a[78:79], v12 offset:14752
  ds_read_b64_tr_b16 a[80:81], v12 offset:2560
  ds_read_b64_tr_b16 a[82:83], v12 offset:15360
  ds_read_b64_tr_b16 a[84:85], v12 offset:2568
  ds_read_b64_tr_b16 a[86:87], v12 offset:15368
  ds_read_b64_tr_b16 a[88:89], v12 offset:2576
  ds_read_b64_tr_b16 a[90:91], v12 offset:15376
  ds_read_b64_tr_b16 a[92:93], v12 offset:2584
  ds_read_b64_tr_b16 a[94:95], v12 offset:15384
  ds_read_b64_tr_b16 a[96:97], v12 offset:2592
  ds_read_b64_tr_b16 a[98:99], v12 offset:15392
  s_add_u32 s6, s6, 1
  s_and_b32 s6, s6, 3
  s_mul_i32 s7, s6, 25600
  v_add_u32 v13, s7, v25
  ds_read_b64_tr_b16 a[100:101], v13 offset:0
  ds_read_b64_tr_b16 a[102:103], v13 offset:640
  ds_read_b64_tr_b16 a[104:105], v13 offset:8
  ds_read_b64_tr_b16 a[106:107], v13 offset:648
  ds_read_b64_tr_b16 a[108:109], v13 offset:16
  ds_read_b64_tr_b16 a[110:111], v13 offset:656
  ds_read_b64_tr_b16 a[112:113], v13 offset:24
  ds_read_b64_tr_b16 a[114:115], v13 offset:664
  ds_read_b64_tr_b16 a[116:117], v13 offset:32
  ds_read_b64_tr_b16 a[118:119], v13 offset:672
  ds_read_b64_tr_b16 a[120:121], v13 offset:1280
  ds_read_b64_tr_b16 a[122:123], v13 offset:1920
  ds_read_b64_tr_b16 a[124:125], v13 offset:1288
  ds_read_b64_tr_b16 a[126:127], v13 offset:1928
  ds_read_b64_tr_b16 a[128:129], v13 offset:1296
  ds_read_b64_tr_b16 a[130:131], v13 offset:1936
  ds_read_b64_tr_b16 a[132:133], v13 offset:1304
  ds_read_b64_tr_b16 a[134:135], v13 offset:1944
  ds_read_b64_tr_b16 a[136:137], v13 offset:1312
  ds_read_b64_tr_b16 a[138:139], v13 offset:1952
  ds_read_b64_tr_b16 a[140:141], v13 offset:12800
  ds_read_b64_tr_b16 a[142:143], v13 offset:13440
  ds_read_b64_tr_b16 a[144:145], v13 offset:12808
  ds_read_b64_tr_b16 a[146:147], v13 offset:13448
  ds_read_b64_tr_b16 a[148:149], v13 offset:12816
  ds_read_b64_tr_b16 a[150:151], v13 offset:13456
  ds_read_b64_tr_b16 a[152:153], v13 offset:12824
  ds_read_b64_tr_b16 a[154:155], v13 offset:13464
  ds_read_b64_tr_b16 a[156:157], v13 offset:12832
  ds_read_b64_tr_b16 a[158:159], v13 offset:13472
  ds_read_b64_tr_b16 a[160:161], v13 offset:14080
  ds_read_b64_tr_b16 a[162:163], v13 offset:14720
  ds_read_b64_tr_b16 a[164:165], v13 offset:14088
  ds_read_b64_tr_b16 a[166:167], v13 offset:14728
  ds_read_b64_tr_b16 a[168:169], v13 offset:14096
  ds_read_b64_tr_b16 a[170:171], v13 offset:14736
  ds_read_b64_tr_b16 a[172:173], v13 offset:14104
  ds_read_b64_tr_b16 a[174:175], v13 offset:14744
  ds_read_b64_tr_b16 a[176:177], v13 offset:14112
  ds_read_b64_tr_b16 a[178:179], v13 offset:14752
  ds_read_b64_tr_b16 a[180:181], v13 offset:2560
  ds_read_b64_tr_b16 a[182:183], v13 offset:15360
  ds_read_b64_tr_b16 a[184:185], v13 offset:2568
  ds_read_b64_tr_b16 a[186:187], v13 offset:15368
  ds_read_b64_tr_b16 a[188:189], v13 offset:2576
  ds_read_b64_tr_b16 a[190:191], v13 offset:15376
  ds_read_b64_tr_b16 a[192:193], v13 offset:2584
  ds_read_b64_tr_b16 a[194:195], v13 offset:15384
  ds_read_b64_tr_b16 a[196:197], v13 offset:2592
  ds_read_b64_tr_b16 a[198:199], v13 offset:15392
  s_add_u32 s6, s6, 1
  s_and_b32 s6, s6, 3
  s_mul_i32 s7, s6, 25600
  v_add_u32 v12, s7, v25
  ds_read_b64_tr_b16 a[200:201], v12 offset:0
  ds_read_b64_tr_b16 a[202:203], v12 offset:640
  ds_read_b64_tr_b16 a[204:205], v12 offset:8
  ds_read_b64_tr_b16 a[206:207], v12 offset:648
  ds_read_b64_tr_b16 a[208:209], v12 offset:16
  ds_read_b64_tr_b16 a[210:211], v12 offset:656
  ds_read_b64_tr_b16 a[212:213], v12 offset:24
  ds_read_b64_tr_b16 a[214:215], v12 offset:664
  ds_read_b64_tr_b16 a[216:217], v12 offset:32
  ds_read_b64_tr_b16 a[218:219], v12 offset:672
  ds_read_b64_tr_b16 a[220:221], v12 offset:1280
  ds_read_b64_tr_b16 a[222:223], v12 offset:1920
  ds_read_b64_tr_b16 a[224:225], v12 offset:1288
  ds_read_b64_tr_b16 a[226:227], v12 offset:1928
  ds_read_b64_tr_b16 a[228:229], v12 offset:1296
  ds_read_b64_tr_b16 a[230:231], v12 offset:1936
  ds_read_b64_tr_b16 a[232:233], v12 offset:1304
  ds_read_b64_tr_b16 a[234:235], v12 offset:1944
  ds_read_b64_tr_b16 a[236:237], v12 offset:1312
  ds_read_b64_tr_b16 a[238:239], v12 offset:1952
  ds_read_b64_tr_b16 a[240:241], v12 offset:12800
  ds_read_b64_tr_b16 a[242:243], v12 offset:13440
  ds_read_b64_tr_b16 a[244:245], v12 offset:12808
  ds_read_b64_tr_b16 a[246:247], v12 offset:13448
  ds_read_b64_tr_b16 a[248:249], v12 offset:12816
  ds_read_b64_tr_b16 a[250:251], v12 offset:13456
  ds_read_b64_tr_b16 a[252:253], v12 offset:12824
  ds_read_b64_tr_b16 a[254:255], v12 offset:13464
  ds_read_b64_tr_b16 v[112:113], v12 offset:12832
  ds_read_b64_tr_b16 v[114:115], v12 offset:13472
  ds_read_b64_tr_b16 v[116:117], v12 offset:14080
  ds_read_b64_tr_b16 v[118:119], v12 offset:14720
  ds_read_b64_tr_b16 v[120:121], v12 offset:14088
  ds_read_b64_tr_b16 v[122:123], v12 offset:14728
  ds_read_b64_tr_b16 v[124:125], v12 offset:14096
  ds_read_b64_tr_b16 v[126:127], v12 offset:14736
  ds_read_b64_tr_b16 v[128:129], v12 offset:14104
  ds_read_b64_tr_b16 v[130:131], v12 offset:14744
  ds_read_b64_tr_b16 v[132:133], v12 offset:14112
  ds_read_b64_tr_b16 v[134:135], v12 offset:14752
  ds_read_b64_tr_b16 v[136:137], v12 offset:2560
  ds_read_b64_tr_b16 v[138:139], v12 offset:15360
  ds_read_b64_tr_b16 v[140:141], v12 offset:2568
  ds_read_b64_tr_b16 v[142:143], v12 offset:15368
  ds_read_b64_tr_b16 v[144:145], v12 offset:2576
  ds_read_b64_tr_b16 v[146:147], v12 offset:15376
  ds_read_b64_tr_b16 v[148:149], v12 offset:2584
  ds_read_b64_tr_b16 v[150:151], v12 offset:15384
  ds_read_b64_tr_b16 v[152:153], v12 offset:2592
  ds_read_b64_tr_b16 v[154:155], v12 offset:15392
  s_mul_i32 s8, s60, 20480
  s_add_u32 s8, s8, 1048576
  s_and_b32 s11, s10, 3
  s_mul_i32 s68, s11, 5120
  s_add_u32 s68, s68, s8
  s_add_u32 s11, s11, 1
  s_and_b32 s11, s11, 3
  s_mul_i32 s69, s11, 5120
  s_add_u32 s69, s69, s8
  s_add_u32 s11, s11, 1
  s_and_b32 s11, s11, 3
  s_mul_i32 s62, s11, 5120
  s_add_u32 s62, s62, s8
  s_add_u32 s11, s11, 1
  s_and_b32 s11, s11, 3
  s_mul_i32 s63, s11, 5120
  s_add_u32 s63, s63, s8
  s_mul_i32 s70, s60, 40960
  s_mul_i32 s11, s10, 160
  s_add_u32 s70, s70, s11
  v_lshlrev_b32 v19, 4, v0
  v_lshlrev_b32 v18, 3, v0
  v_add_u32 v18, 0x800, v18
  s_cmp_lg_u32 s13, 0
  s_mov_b32 s11, 0xffff
  s_cselect_b32 s100, s11, 0xff
  s_mov_b32 s101, 0
  s_waitcnt vmcnt(0)
  v_cmp_ne_u32 vcc, s14, v22
  s_mov_b32 s9, 0
  s_and_b64 vcc, vcc, s[100:101]
  s_cbranch_scc0 A_pg_ok
A_pg:
  buffer_load_dword v22, v16, s[52:55], s71 offen sc1
  s_waitcnt vmcnt(0)
  v_cmp_ne_u32 vcc, s14, v22
  s_add_u32 s9, s9, 1
  s_and_b64 vcc, vcc, s[100:101]
  s_cbranch_scc0 A_pg_ok
  s_sleep 48
  s_cmp_lt_u32 s9, 0x40000
  s_cbranch_scc1 A_pg
A_pg_ok:
  v_mov_b32 v72, -1
  s_cmp_lg_u32 s15, 0
  s_cbranch_scc1 A3_nofirst
  buffer_load_dword v72, v73, s[52:55], s8 offen sc1
  buffer_load_dwordx4 v[32:35], v19, s[52:55], s68 offen offset:0 sc1
  buffer_load_dwordx4 v[36:39], v19, s[52:55], s68 offen offset:1024 sc1
  buffer_load_dwordx4 v[40:43], v19, s[52:55], s68 offen offset:2560 sc1
  buffer_load_dwordx4 v[44:47], v19, s[52:55], s68 offen offset:3584 sc1
  buffer_load_dwordx2 v[48:49], v18, s[52:55], s68 offen offset:0 sc1
  buffer_load_dwordx2 v[50:51], v18, s[52:55], s68 offen offset:2560 sc1
  buffer_load_dwordx4 v[52:55], v19, s[52:55], s69 offen offset:0 sc1
  buffer_load_dwordx4 v[56:59], v19, s[52:55], s69 offen offset:1024 sc1
  buffer_load_dwordx4 v[60:63], v19, s[52:55], s69 offen offset:2560 sc1
  buffer_load_dwordx4 v[64:67], v19, s[52:55], s69 offen offset:3584 sc1
  buffer_load_dwordx2 v[68:69], v18, s[52:55], s69 offen offset:0 sc1
  buffer_load_dwordx2 v[70:71], v18, s[52:55], s69 offen offset:2560 sc1
A3_nofirst:
  s_add_u32 s6, s6, 1
  s_and_b32 s6, s6, 3
  s_mul_i32 s7, s6, 25600
  v_add_u32 v13, s7, v25
  ds_read_b64_tr_b16 v[156:157], v13 offset:0
  ds_read_b64_tr_b16 v[158:159], v13 offset:640
  ds_read_b64_tr_b16 v[160:161], v13 offset:8
  ds_read_b64_tr_b16 v[162:163], v13 offset:648
  ds_read_b64_tr_b16 v[164:165], v13 offset:16
  ds_read_b64_tr_b16 v[166:167], v13 offset:656
  ds_read_b64_tr_b16 v[168:169], v13 offset:24
  ds_read_b64_tr_b16 v[170:171], v13 offset:664
  ds_read_b64_tr_b16 v[172:173], v13 offset:32
  ds_read_b64_tr_b16 v[174:175], v13 offset:672
  ds_read_b64_tr_b16 v[176:177], v13 offset:1280
  ds_read_b64_tr_b16 v[178:179], v13 offset:1920
  ds_read_b64_tr_b16 v[180:181], v13 offset:1288
  ds_read_b64_tr_b16 v[182:183], v13 offset:1928
  ds_read_b64_tr_b16 v[184:185], v13 offset:1296
  ds_read_b64_tr_b16 v[186:187], v13 offset:1936
  ds_read_b64_tr_b16 v[188:189], v13 offset:1304
  ds_read_b64_tr_b16 v[190:191], v13 offset:1944
  ds_read_b64_tr_b16 v[192:193], v13 offset:1312
  ds_read_b64_tr_b16 v[194:195], v13 offset:1952
  ds_read_b64_tr_b16 v[196:197], v13 offset:12800
  ds_read_b64_tr_b16 v[198:199], v13 offset:13440
  ds_read_b64_tr_b16 v[200:201], v13 offset:12808
  ds_read_b64_tr_b16 v[202:203], v13 offset:13448
  ds_read_b64_tr_b16 v[204:205], v13 offset:12816
  ds_read_b64_tr_b16 v[206:207], v13 offset:13456
  ds_read_b64_tr_b16 v[208:209], v13 offset:12824
  ds_read_b64_tr_b16 v[210:211], v13 offset:13464
  ds_read_b64_tr_b16 v[212:213], v13 offset:12832
  ds_read_b64_tr_b16 v[214:215], v13 offset:13472
  ds_read_b64_tr_b16 v[216:217], v13 offset:14080
  ds_read_b64_tr_b16 v[218:219], v13 offset:14720
  ds_read_b64_tr_b16 v[220:221], v13 offset:14088
  ds_read_b64_tr_b16 v[222:223], v13 offset:14728
  ds_read_b64_tr_b16 v[224:225], v13 offset:14096
  ds_read_b64_tr_b16 v[226:227], v13 offset:14736
  ds_read_b64_tr_b16 v[228:229], v13 offset:14104
  ds_read_b64_tr_b16 v[230:231], v13 offset:14744
  ds_read_b64_tr_b16 v[232:233], v13 offset:14112
  ds_read_b64_tr_b16 v[234:235], v13 offset:14752
  ds_read_b64_tr_b16 v[236:237], v13 offset:2560
  ds_read_b64_tr_b16 v[238:239], v13 offset:15360
  ds_read_b64_tr_b16 v[240:241], v13 offset:2568
  ds_read_b64_tr_b16 v[242:243], v13 offset:15368
  ds_read_b64_tr_b16 v[244:245], v13 offset:2576
  ds_read_b64_tr_b16 v[246:247], v13 offset:15376
  ds_read_b64_tr_b16 v[248:249], v13 offset:2584
  ds_read_b64_tr_b16 v[250:251], v13 offset:15384
  ds_read_b64_tr_b16 v[252:253], v13 offset:2592
  ds_read_b64_tr_b16 v[254:255], v13 offset:15392
  v_and_b32 v17, 15, v0
  v_lshrrev_b32 v20, 4, v0
  v_mul_u32_u24 v17, 2560, v17
  v_mul_u32_u24 v20, 40, v20
  v_add_u32 v17, v17, v20
  s_mov_b32 s9, 0
  s_waitcnt lgkmcnt(0)
  s_waitcnt vmcnt(12)
  v_cmp_eq_u32 vcc, -1, v72
  v_mov_b32 v74, 0
  s_and_b64 vcc, vcc, s[100:101]
  s_cbranch_scc0 A3_go
A3_redo:
  s_waitcnt vmcnt(0)
  s_mul_i32 s8, s60, 20480
  s_add_u32 s8, s8, 1048576
  s_and_b32 s11, s10, 3
  s_mul_i32 s68, s11, 5120
  s_add_u32 s68, s68, s8
  s_add_u32 s11, s11, 1
  s_and_b32 s11, s11, 3
  s_mul_i32 s69, s11, 5120
  s_add_u32 s69, s69, s8
  s_add_u32 s11, s11, 1
  s_and_b32 s11, s11, 3
  s_mul_i32 s62, s11, 5120
  s_add_u32 s62, s62, s8
  s_add_u32 s11, s11, 1
  s_and_b32 s11, s11, 3
  s_mul_i32 s63, s11, 5120
  s_add_u32 s63, s63, s8
  s_mul_i32 s70, s60, 40960
  s_mul_i32 s11, s10, 160
  s_add_u32 s70, s70, s11
  s_cmp_eq_u32 s15, 0
  s_cbranch_scc1 A3_hint
  s_lshl_b64 exec, 1, s10
A3_h1:
  s_sleep 6
  buffer_load_dword v72, v73, s[52:55], s8 offen sc1
  s_add_u32 s9, s9, 1
  s_cmp_ge_u32 s9, 0x40000
  s_cbranch_scc1 A3_h1_ok
  s_waitcnt vmcnt(0)
  v_cmp_eq_u32 vcc, -1, v72
  s_nop 0
  s_cmp_lg_u64 vcc, 0
  s_cbranch_scc1 A3_h1
A3_h1_ok:
  s_waitcnt vmcnt(0)
  s_mov_b64 exec, -1
A3_hint:
  s_waitcnt vmcnt(0)
  buffer_load_dword v72, v73, s[52:55], s8 offen sc1
  buffer_load_dwordx4 v[32:35], v19, s[52:55], s68 offen offset:0 sc1
  buffer_load_dwordx4 v[36:39], v19, s[52:55], s68 offen offset:1024 sc1
  buffer_load_dwordx4 v[40:43], v19, s[52:55], s68 offen offset:2560 sc1
  buffer_load_dwordx4 v[44:47], v19, s[52:55], s68 offen offset:3584 sc1
  buffer_load_dwordx2 v[48:49], v18, s[52:55], s68 offen offset:0 sc1
  buffer_load_dwordx2 v[50:51], v18, s[52:55], s68 offen offset:2560 sc1
  buffer_load_dwordx4 v[52:55], v19, s[52:55], s69 offen offset:0 sc1
  buffer_load_dwordx4 v[56:59], v19, s[52:55], s69 offen offset:1024 sc1
  buffer_load_dwordx4 v[60:63], v19, s[52:55], s69 offen offset:2560 sc1
  buffer_load_dwordx4 v[64:67], v19, s[52:55], s69 offen offset:3584 sc1
  buffer_load_dwordx2 v[68:69], v18, s[52:55], s69 offen offset:0 sc1
  buffer_load_dwordx2 v[70:71], v18, s[52:55], s69 offen offset:2560 sc1
  s_add_u32 s9, s9, 1
  s_cmp_ge_u32 s9, 0x40000
  s_cbranch_scc1 A3_hint_ok
  s_waitcnt vmcnt(12)
  v_cmp_eq_u32 vcc, -1, v72
  s_nop 0
  s_and_b64 vcc, vcc, s[100:101]
  s_cbranch_scc1 A3_hint
A3_hint_ok:
  v_mov_b32 v74, 0
A3_go:
  s_waitcnt vmcnt(11)
  v_mfma_f32_16x16x32_bf16 v[92:95], a[0:3], v[32:35], 0
  v_max3_u32 v74, v74, v32, v33
  v_mfma_f32_16x16x32_bf16 v[96:99], a[4:7], v[32:35], 0
  v_max3_u32 v74, v74, v34, v35
  v_mfma_f32_16x16x32_bf16 v[100:103], a[8:11], v[32:35], 0
  v_mfma_f32_16x16x32_bf16 v[104:107], a[12:15], v[32:35], 0
  v_mfma_f32_16x16x32_bf16 v[108:111], a[16:19], v[32:35], 0
  buffer_load_dwordx4 v[32:35], v19, s[52:55], s62 offen offset:0 sc1
  s_waitcnt vmcnt(11)
  v_mfma_f32_16x16x32_bf16 v[92:95], a[20:23], v[36:39], v[92:95]
  v_max3_u32 v74, v74, v36, v37
  v_mfma_f32_16x16x32_bf16 v[96:99], a[24:27], v[36:39], v[96:99]
  v_max3_u32 v74, v74, v38, v39
  v_mfma_f32_16x16x32_bf16 v[100:103], a[28:31], v[36:39], v[100:103]
  v_mfma_f32_16x16x32_bf16 v[104:107], a[32:35], v[36:39], v[104:107]
  v_mfma_f32_16x16x32_bf16 v[108:111], a[36:39], v[36:39], v[108:111]
  buffer_load_dwordx4 v[36:39], v19, s[52:55], s62 offen offset:1024 sc1
  s_waitcnt vmcnt(11)
  v_mfma_f32_16x16x32_bf16 v[92:95], a[40:43], v[40:43], v[92:95]
  v_max3_u32 v74, v74, v40, v41
  v_mfma_f32_16x16x32_bf16 v[96:99], a[44:47], v[40:43], v[96:99]
  v_max3_u32 v74, v74, v42, v43
  v_mfma_f32_16x16x32_bf16 v[100:103], a[48:51], v[40:43], v[100:103]
  v_mfma_f32_16x16x32_bf16 v[104:107], a[52:55], v[40:43], v[104:107]
  v_mfma_f32_16x16x32_bf16 v[108:111], a[56:59], v[40:43], v[108:111]
  buffer_load_dwordx4 v[40:43], v19, s[52:55], s62 offen offset:2560 sc1
  s_waitcnt vmcnt(11)
  v_mfma_f32_16x16x32_bf16 v[92:95], a[60:63], v[44:47], v[92:95]
  v_max3_u32 v74, v74, v44, v45
  v_mfma_f32_16x16x32_bf16 v[96:99], a[64:67], v[44:47], v[96:99]
  v_max3_u32 v74, v74, v46, v47
  v_mfma_f32_16x16x32_bf16 v[100:103], a[68:71], v[44:47], v[100:103]
  v_mfma_f32_16x16x32_bf16 v[104:107], a[72:75], v[44:47], v[104:107]
  v_mfma_f32_16x16x32_bf16 v[108:111], a[76:79], v[44:47], v[108:111]
  buffer_load_dwordx4 v[44:47], v19, s[52:55], s62 offen offset:3584 sc1
  s_waitcnt vmcnt(10)
  v_mfma_f32_16x16x32_bf16 v[92:95], a[80:83], v[48:51], v[92:95]
  v_max3_u32 v74, v74, v48, v49
  v_mfma_f32_16x16x32_bf16 v[96:99], a[84:87], v[48:51], v[96:99]
  v_max3_u32 v74, v74, v50, v51
  v_mfma_f32_16x16x32_bf16 v[100:103], a[88:91], v[48:51], v[100:103]
  v_mfma_f32_16x16x32_bf16 v[104:107], a[92:95], v[48:51], v[104:107]
  v_mfma_f32_16x16x32_bf16 v[108:111], a[96:99], v[48:51], v[108:111]
  buffer_load_dwordx2 v[48:49], v18, s[52:55], s62 offen offset:0 sc1
  buffer_load_dwordx2 v[50:51], v18, s[52:55], s62 offen offset:2560 sc1
  s_cmp_lg_u32 s13, 0
  s_cbranch_scc0 A3_single
  s_waitcnt vmcnt(11)
  v_mfma_f32_16x16x32_bf16 v[92:95], a[100:103], v[52:55], v[92:95]
  v_max3_u32 v74, v74, v52, v53
  v_mfma_f32_16x16x32_bf16 v[96:99], a[104:107], v[52:55], v[96:99]
  v_max3_u32 v74, v74, v54, v55
  v_mfma_f32_16x16x32_bf16 v[100:103], a[108:111], v[52:55], v[100:103]
  v_mfma_f32_16x16x32_bf16 v[104:107], a[112:115], v[52:55], v[104:107]
  v_mfma_f32_16x16x32_bf16 v[108:111], a[116:119], v[52:55], v[108:111]
  buffer_load_dwordx4 v[52:55], v19, s[52:55], s63 offen offset:0 sc1
  s_waitcnt vmcnt(11)
  v_mfma_f32_16x16x32_bf16 v[92:95], a[120:123], v[56:59], v[92:95]
  v_max3_u32 v74, v74, v56, v57
  v_mfma_f32_16x16x32_bf16 v[96:99], a[124:127], v[56:59], v[96:99]
  v_max3_u32 v74, v74, v58, v59
  v_mfma_f32_16x16x32_bf16 v[100:103], a[128:131], v[56:59], v[100:103]
  v_mfma_f32_16x16x32_bf16 v[104:107], a[132:135], v[56:59], v[104:107]
  v_mfma_f32_16x16x32_bf16 v[108:111], a[136:139], v[56:59], v[108:111]
  buffer_load_dwordx4 v[56:59], v19, s[52:55], s63 offen offset:1024 sc1
  s_waitcnt vmcnt(11)
  v_mfma_f32_16x16x32_bf16 v[92:95], a[140:143], v[60:63], v[92:95]
  v_max3_u32 v74, v74, v60, v61
  v_mfma_f32_16x16x32_bf16 v[96:99], a[144:147], v[60:63], v[96:99]
  v_max3_u32 v74, v74, v62, v63
  v_mfma_f32_16x16x32_bf16 v[100:103], a[148:151], v[60:63], v[100:103]
  v_mfma_f32_16x16x32_bf16 v[104:107], a[152:155], v[60:63], v[104:107]
  v_mfma_f32_16x16x32_bf16 v[108:111], a[156:159], v[60:63], v[108:111]
  buffer_load_dwordx4 v[60:63], v19, s[52:55], s63 offen offset:2560 sc1
  s_waitcnt vmcnt(11)
  v_mfma_f32_16x16x32_bf16 v[92:95], a[160:163], v[64:67], v[92:95]
  v_max3_u32 v74, v74, v64, v65
  v_mfma_f32_16x16x32_bf16 v[96:99], a[164:167], v[64:67], v[96:99]
  v_max3_u32 v74, v74, v66, v67
  v_mfma_f32_16x16x32_bf16 v[100:103], a[168:171], v[64:67], v[100:103]
  v_mfma_f32_16x16x32_bf16 v[104:107], a[172:175], v[64:67], v[104:107]
  v_mfma_f32_16x16x32_bf16 v[108:111], a[176:179], v[64:67], v[108:111]
  buffer_load_dwordx4 v[64:67], v19, s[52:55], s63 offen offset:3584 sc1
  s_waitcnt vmcnt(10)
  v_mfma_f32_16x16x32_bf16 v[92:95], a[180:183], v[68:71], v[92:95]
  v_max3_u32 v74, v74, v68, v69
  v_mfma_f32_16x16x32_bf16 v[96:99], a[184:187], v[68:71], v[96:99]
  v_max3_u32 v74, v74, v70, v71
  v_mfma_f32_16x16x32_bf16 v[100:103], a[188:191], v[68:71], v[100:103]
  v_mfma_f32_16x16x32_bf16 v[104:107], a[192:195], v[68:71], v[104:107]
  v_mfma_f32_16x16x32_bf16 v[108:111], a[196:199], v[68:71], v[108:111]
  buffer_load_dwordx2 v[68:69], v18, s[52:55], s63 offen offset:0 sc1
  buffer_load_dwordx2 v[70:71], v18, s[52:55], s63 offen offset:2560 sc1
  s_waitcnt vmcnt(11)
  v_mfma_f32_16x16x32_bf16 v[92:95], a[200:203], v[32:35], v[92:95]
  v_max3_u32 v74, v74, v32, v33
  v_mfma_f32_16x16x32_bf16 v[96:99], a[204:207], v[32:35], v[96:99]
  v_max3_u32 v74, v74, v34, v35
  v_mfma_f32_16x16x32_bf16 v[100:103], a[208:211], v[32:35], v[100:103]
  v_mfma_f32_16x16x32_bf16 v[104:107], a[212:215], v[32:35], v[104:107]
  v_mfma_f32_16x16x32_bf16 v[108:111], a[216:219], v[32:35], v[108:111]
  s_add_u32 s68, s68, 81920
  buffer_load_dwordx4 v[32:35], v19, s[52:55], s68 offen offset:0 sc1
  s_waitcnt vmcnt(11)
  v_mfma_f32_16x16x32_bf16 v[92:95], a[220:223], v[36:39], v[92:95]
  v_max3_u32 v74, v74, v36, v37
  v_mfma_f32_16x16x32_bf16 v[96:99], a[224:227], v[36:39], v[96:99]
  v_max3_u32 v74, v74, v38, v39
  v_mfma_f32_16x16x32_bf16 v[100:103], a[228:231], v[36:39], v[100:103]
  v_mfma_f32_16x16x32_bf16 v[104:107], a[232:235], v[36:39], v[104:107]
  v_mfma_f32_16x16x32_bf16 v[108:111], a[236:239], v[36:39], v[108:111]
  buffer_load_dwordx4 v[36:39], v19, s[52:55], s68 offen offset:1024 sc1
  s_waitcnt vmcnt(11)
  v_mfma_f32_16x16x32_bf16 v[92:95], a[240:243], v[40:43], v[92:95]
  v_max3_u32 v74, v74, v40, v41
  v_mfma_f32_16x16x32_bf16 v[96:99], a[244:247], v[40:43], v[96:99]
  v_max3_u32 v74, v74, v42, v43
  v_mfma_f32_16x16x32_bf16 v[100:103], a[248:251], v[40:43], v[100:103]
  v_mfma_f32_16x16x32_bf16 v[104:107], a[252:255], v[40:43], v[104:107]
  v_mfma_f32_16x16x32_bf16 v[108:111], v[112:115], v[40:43], v[108:111]
  buffer_load_dwordx4 v[40:43], v19, s[52:55], s68 offen offset:2560 sc1
  s_waitcnt vmcnt(11)
  v_mfma_f32_16x16x32_bf16 v[92:95], v[116:119], v[44:47], v[92:95]
  v_max3_u32 v74, v74, v44, v45
  v_mfma_f32_16x16x32_bf16 v[96:99], v[120:123], v[44:47], v[96:99]
  v_max3_u32 v74, v74, v46, v47
  v_mfma_f32_16x16x32_bf16 v[100:103], v[124:127], v[44:47], v[100:103]
  v_mfma_f32_16x16x32_bf16 v[104:107], v[128:131], v[44:47], v[104:107]
  v_mfma_f32_16x16x32_bf16 v[108:111], v[132:135], v[44:47], v[108:111]
  buffer_load_dwordx4 v[44:47], v19, s[52:55], s68 offen offset:3584 sc1
  s_waitcnt vmcnt(10)
  v_mfma_f32_16x16x32_bf16 v[92:95], v[136:139], v[48:51], v[92:95]
  v_max3_u32 v74, v74, v48, v49
  v_mfma_f32_16x16x32_bf16 v[96:99], v[140:143], v[48:51], v[96:99]
  v_max3_u32 v74, v74, v50, v51
  v_mfma_f32_16x16x32_bf16 v[100:103], v[144:147], v[48:51], v[100:103]
  v_mfma_f32_16x16x32_bf16 v[104:107], v[148:151], v[48:51], v[104:107]
  v_mfma_f32_16x16x32_bf16 v[108:111], v[152:155], v[48:51], v[108:111]
  buffer_load_dwordx2 v[48:49], v18, s[52:55], s68 offen offset:0 sc1
  buffer_load_dwordx2 v[50:51], v18, s[52:55], s68 offen offset:2560 sc1
  s_waitcnt vmcnt(11)
  v_mfma_f32_16x16x32_bf16 v[92:95], v[156:159], v[52:55], v[92:95]
  v_max3_u32 v74, v74, v52, v53
  v_mfma_f32_16x16x32_bf16 v[96:99], v[160:163], v[52:55], v[96:99]
  v_max3_u32 v74, v74, v54, v55
  v_mfma_f32_16x16x32_bf16 v[100:103], v[164:167], v[52:55], v[100:103]
  v_mfma_f32_16x16x32_bf16 v[104:107], v[168:171], v[52:55], v[104:107]
  v_mfma_f32_16x16x32_bf16 v[108:111], v[172:175], v[52:55], v[108:111]
  s_add_u32 s69, s69, 81920
  buffer_load_dwordx4 v[52:55], v19, s[52:55], s69 offen offset:0 sc1
  s_waitcnt vmcnt(11)
  v_mfma_f32_16x16x32_bf16 v[92:95], v[176:179], v[56:59], v[92:95]
  v_max3_u32 v74, v74, v56, v57
  v_mfma_f32_16x16x32_bf16 v[96:99], v[180:183], v[56:59], v[96:99]
  v_max3_u32 v74, v74, v58, v59
  v_mfma_f32_16x16x32_bf16 v[100:103], v[184:187], v[56:59], v[100:103]
  v_mfma_f32_16x16x32_bf16 v[104:107], v[188:191], v[56:59], v[104:107]
  v_mfma_f32_16x16x32_bf16 v[108:111], v[192:195], v[56:59], v[108:111]
  buffer_load_dwordx4 v[56:59], v19, s[52:55], s69 offen offset:1024 sc1
  s_waitcnt vmcnt(11)
  v_mfma_f32_16x16x32_bf16 v[92:95], v[196:199], v[60:63], v[92:95]
  v_max3_u32 v74, v74, v60, v61
  v_mfma_f32_16x16x32_bf16 v[96:99], v[200:203], v[60:63], v[96:99]
  v_max3_u32 v74, v74, v62, v63
  v_mfma_f32_16x16x32_bf16 v[100:103], v[204:207], v[60:63], v[100:103]
  v_mfma_f32_16x16x32_bf16 v[104:107], v[208:211], v[60:63], v[104:107]
  v_mfma_f32_16x16x32_bf16 v[108:111], v[212:215], v[60:63], v[108:111]
  buffer_load_dwordx4 v[60:63], v19, s[52:55], s69 offen offset:2560 sc1
  s_waitcnt vmcnt(11)
  v_mfma_f32_16x16x32_bf16 v[92:95], v[216:219], v[64:67], v[92:95]
  v_max3_u32 v74, v74, v64, v65
  v_mfma_f32_16x16x32_bf16 v[96:99], v[220:223], v[64:67], v[96:99]
  v_max3_u32 v74, v74, v66, v67
  v_mfma_f32_16x16x32_bf16 v[100:103], v[224:227], v[64:67], v[100:103]
  v_mfma_f32_16x16x32_bf16 v[104:107], v[228:231], v[64:67], v[104:107]
  v_mfma_f32_16x16x32_bf16 v[108:111], v[232:235], v[64:67], v[108:111]
  buffer_load_dwordx4 v[64:67], v19, s[52:55], s69 offen offset:3584 sc1
  s_waitcnt vmcnt(10)
  v_mfma_f32_16x16x32_bf16 v[92:95], v[236:239], v[68:71], v[92:95]
  v_max3_u32 v74, v74, v68, v69
  v_mfma_f32_16x16x32_bf16 v[96:99], v[240:243], v[68:71], v[96:99]
  v_max3_u32 v74, v74, v70, v71
  v_mfma_f32_16x16x32_bf16 v[100:103], v[244:247], v[68:71], v[100:103]
  v_mfma_f32_16x16x32_bf16 v[104:107], v[248:251], v[68:71], v[104:107]
  v_mfma_f32_16x16x32_bf16 v[108:111], v[252:255], v[68:71], v[108:111]
  buffer_load_dwordx2 v[68:69], v18, s[52:55], s69 offen offset:0 sc1
  buffer_load_dwordx2 v[70:71], v18, s[52:55], s69 offen offset:2560 sc1
  v_cmp_eq_u32 vcc, -1, v74
  v_cvt_pk_bf16_f32 v2, v92, v93
  v_cvt_pk_bf16_f32 v3, v94, v95
  v_cvt_pk_bf16_f32 v4, v96, v97
  v_cvt_pk_bf16_f32 v5, v98, v99
  v_cvt_pk_bf16_f32 v6, v100, v101
  v_cvt_pk_bf16_f32 v7, v102, v103
  v_cvt_pk_bf16_f32 v8, v104, v105
  v_cvt_pk_bf16_f32 v9, v106, v107
  v_cvt_pk_bf16_f32 v10, v108, v109
  v_cvt_pk_bf16_f32 v11, v110, v111
  s_cmp_lt_u32 s9, 0x40000
  s_cselect_b64 vcc, vcc, 0
  s_cmp_lg_u64 vcc, 0
  s_cbranch_scc1 A3_redo
  buffer_store_dwordx4 v[2:5], v17, s[56:59], s70 offen
  buffer_store_dwordx4 v[6:9], v17, s[56:59], s70 offen offset:16
  buffer_store_dwordx2 v[10:11], v17, s[56:59], s70 offen offset:32
  s_add_u32 s70, s70, 163840
  s_waitcnt vmcnt(14)
  v_mfma_f32_16x16x32_bf16 v[92:95], a[0:3], v[32:35], 0
  v_max3_u32 v74, v74, v32, v33
  v_mfma_f32_16x16x32_bf16 v[96:99], a[4:7], v[32:35], 0
  v_max3_u32 v74, v74, v34, v35
  v_mfma_f32_16x16x32_bf16 v[100:103], a[8:11], v[32:35], 0
  v_mfma_f32_16x16x32_bf16 v[104:107], a[12:15], v[32:35], 0
  v_mfma_f32_16x16x32_bf16 v[108:111], a[16:19], v[32:35], 0
  s_add_u32 s62, s62, 81920
  buffer_load_dwordx4 v[32:35], v19, s[52:55], s62 offen offset:0 sc1
  s_waitcnt vmcnt(14)
  v_mfma_f32_16x16x32_bf16 v[92:95], a[20:23], v[36:39], v[92:95]
  v_max3_u32 v74, v74, v36, v37
  v_mfma_f32_16x16x32_bf16 v[96:99], a[24:27], v[36:39], v[96:99]
  v_max3_u32 v74, v74, v38, v39
  v_mfma_f32_16x16x32_bf16 v[100:103], a[28:31], v[36:39], v[100:103]
  v_mfma_f32_16x16x32_bf16 v[104:107], a[32:35], v[36:39], v[104:107]
  v_mfma_f32_16x16x32_bf16 v[108:111], a[36:39], v[36:39], v[108:111]
  buffer_load_dwordx4 v[36:39], v19, s[52:55], s62 offen offset:1024 sc1
  s_waitcnt vmcnt(14)
  v_mfma_f32_16x16x32_bf16 v[92:95], a[40:43], v[40:43], v[92:95]
  v_max3_u32 v74, v74, v40, v41
  v_mfma_f32_16x16x32_bf16 v[96:99], a[44:47], v[40:43], v[96:99]
  v_max3_u32 v74, v74, v42, v43
  v_mfma_f32_16x16x32_bf16 v[100:103], a[48:51], v[40:43], v[100:103]
  v_mfma_f32_16x16x32_bf16 v[104:107], a[52:55], v[40:43], v[104:107]
  v_mfma_f32_16x16x32_bf16 v[108:111], a[56:59], v[40:43], v[108:111]
  buffer_load_dwordx4 v[40:43], v19, s[52:55], s62 offen offset:2560 sc1
  s_waitcnt vmcnt(14)
  v_mfma_f32_16x16x32_bf16 v[92:95], a[60:63], v[44:47], v[92:95]
  v_max3_u32 v74, v74, v44, v45
  v_mfma_f32_16x16x32_bf16 v[96:99], a[64:67], v[44:47], v[96:99]
  v_max3_u32 v74, v74, v46, v47
  v_mfma_f32_16x16x32_bf16 v[100:103], a[68:71], v[44:47], v[100:103]
  v_mfma_f32_16x16x32_bf16 v[104:107], a[72:75], v[44:47], v[104:107]
  v_mfma_f32_16x16x32_bf16 v[108:111], a[76:79], v[44:47], v[108:111]
  buffer_load_dwordx4 v[44:47], v19, s[52:55], s62 offen offset:3584 sc1
  s_waitcnt vmcnt(13)
  v_mfma_f32_16x16x32_bf16 v[92:95], a[80:83], v[48:51], v[92:95]
  v_max3_u32 v74, v74, v48, v49
  v_mfma_f32_16x16x32_bf16 v[96:99], a[84:87], v[48:51], v[96:99]
  v_max3_u32 v74, v74, v50, v51
  v_mfma_f32_16x16x32_bf16 v[100:103], a[88:91], v[48:51], v[100:103]
  v_mfma_f32_16x16x32_bf16 v[104:107], a[92:95], v[48:51], v[104:107]
  v_mfma_f32_16x16x32_bf16 v[108:111], a[96:99], v[48:51], v[108:111]
  buffer_load_dwordx2 v[48:49], v18, s[52:55], s62 offen offset:0 sc1
  buffer_load_dwordx2 v[50:51], v18, s[52:55], s62 offen offset:2560 sc1
  s_add_u32 s63, s63, 81920
A3_single:
  s_waitcnt vmcnt(11)
  v_mfma_f32_16x16x32_bf16 v[92:95], a[100:103], v[52:55], v[92:95]
  v_max3_u32 v74, v74, v52, v53
  v_mfma_f32_16x16x32_bf16 v[96:99], a[104:107], v[52:55], v[96:99]
  v_max3_u32 v74, v74, v54, v55
  v_mfma_f32_16x16x32_bf16 v[100:103], a[108:111], v[52:55], v[100:103]
  v_mfma_f32_16x16x32_bf16 v[104:107], a[112:115], v[52:55], v[104:107]
  v_mfma_f32_16x16x32_bf16 v[108:111], a[116:119], v[52:55], v[108:111]
  buffer_load_dwordx4 v[52:55], v19, s[52:55], s63 offen offset:0 sc1
  s_waitcnt vmcnt(11)
  v_mfma_f32_16x16x32_bf16 v[92:95], a[120:123], v[56:59], v[92:95]
  v_max3_u32 v74, v74, v56, v57
  v_mfma_f32_16x16x32_bf16 v[96:99], a[124:127], v[56:59], v[96:99]
  v_max3_u32 v74, v74, v58, v59
  v_mfma_f32_16x16x32_bf16 v[100:103], a[128:131], v[56:59], v[100:103]
  v_mfma_f32_16x16x32_bf16 v[104:107], a[132:135], v[56:59], v[104:107]
  v_mfma_f32_16x16x32_bf16 v[108:111], a[136:139], v[56:59], v[108:111]
  buffer_load_dwordx4 v[56:59], v19, s[52:55], s63 offen offset:1024 sc1
  s_waitcnt vmcnt(11)
  v_mfma_f32_16x16x32_bf16 v[92:95], a[140:143], v[60:63], v[92:95]
  v_max3_u32 v74, v74, v60, v61
  v_mfma_f32_16x16x32_bf16 v[96:99], a[144:147], v[60:63], v[96:99]
  v_max3_u32 v74, v74, v62, v63
  v_mfma_f32_16x16x32_bf16 v[100:103], a[148:151], v[60:63], v[100:103]
  v_mfma_f32_16x16x32_bf16 v[104:107], a[152:155], v[60:63], v[104:107]
  v_mfma_f32_16x16x32_bf16 v[108:111], a[156:159], v[60:63], v[108:111]
  buffer_load_dwordx4 v[60:63], v19, s[52:55], s63 offen offset:2560 sc1
  s_waitcnt vmcnt(11)
  v_mfma_f32_16x16x32_bf16 v[92:95], a[160:163], v[64:67], v[92:95]
  v_max3_u32 v74, v74, v64, v65
  v_mfma_f32_16x16x32_bf16 v[96:99], a[164:167], v[64:67], v[96:99]
  v_max3_u32 v74, v74, v66, v67
  v_mfma_f32_16x16x32_bf16 v[100:103], a[168:171], v[64:67], v[100:103]
  v_mfma_f32_16x16x32_bf16 v[104:107], a[172:175], v[64:67], v[104:107]
  v_mfma_f32_16x16x32_bf16 v[108:111], a[176:179], v[64:67], v[108:111]
  buffer_load_dwordx4 v[64:67], v19, s[52:55], s63 offen offset:3584 sc1
  s_waitcnt vmcnt(10)
  v_mfma_f32_16x16x32_bf16 v[92:95], a[180:183], v[68:71], v[92:95]
  v_max3_u32 v74, v74, v68, v69
  v_mfma_f32_16x16x32_bf16 v[96:99], a[184:187], v[68:71], v[96:99]
  v_max3_u32 v74, v74, v70, v71
  v_mfma_f32_16x16x32_bf16 v[100:103], a[188:191], v[68:71], v[100:103]
  v_mfma_f32_16x16x32_bf16 v[104:107], a[192:195], v[68:71], v[104:107]
  v_mfma_f32_16x16x32_bf16 v[108:111], a[196:199], v[68:71], v[108:111]
  buffer_load_dwordx2 v[68:69], v18, s[52:55], s63 offen offset:0 sc1
  buffer_load_dwordx2 v[70:71], v18, s[52:55], s63 offen offset:2560 sc1
  s_waitcnt vmcnt(11)
  v_mfma_f32_16x16x32_bf16 v[92:95], a[200:203], v[32:35], v[92:95]
  v_max3_u32 v74, v74, v32, v33
  v_mfma_f32_16x16x32_bf16 v[96:99], a[204:207], v[32:35], v[96:99]
  v_max3_u32 v74, v74, v34, v35
  v_mfma_f32_16x16x32_bf16 v[100:103], a[208:211], v[32:35], v[100:103]
  v_mfma_f32_16x16x32_bf16 v[104:107], a[212:215], v[32:35], v[104:107]
  v_mfma_f32_16x16x32_bf16 v[108:111], a[216:219], v[32:35], v[108:111]
  s_waitcnt vmcnt(10)
  v_mfma_f32_16x16x32_bf16 v[92:95], a[220:223], v[36:39], v[92:95]
  v_max3_u32 v74, v74, v36, v37
  v_mfma_f32_16x16x32_bf16 v[96:99], a[224:227], v[36:39], v[96:99]
  v_max3_u32 v74, v74, v38, v39
  v_mfma_f32_16x16x32_bf16 v[100:103], a[228:231], v[36:39], v[100:103]
  v_mfma_f32_16x16x32_bf16 v[104:107], a[232:235], v[36:39], v[104:107]
  v_mfma_f32_16x16x32_bf16 v[108:111], a[236:239], v[36:39], v[108:111]
  s_waitcnt vmcnt(9)
  v_mfma_f32_16x16x32_bf16 v[92:95], a[240:243], v[40:43], v[92:95]
  v_max3_u32 v74, v74, v40, v41
  v_mfma_f32_16x16x32_bf16 v[96:99], a[244:247], v[40:43], v[96:99]
  v_max3_u32 v74, v74, v42, v43
  v_mfma_f32_16x16x32_bf16 v[100:103], a[248:251], v[40:43], v[100:103]
  v_mfma_f32_16x16x32_bf16 v[104:107], a[252:255], v[40:43], v[104:107]
  v_mfma_f32_16x16x32_bf16 v[108:111], v[112:115], v[40:43], v[108:111]
  s_waitcnt vmcnt(8)
  v_mfma_f32_16x16x32_bf16 v[92:95], v[116:119], v[44:47], v[92:95]
  v_max3_u32 v74, v74, v44, v45
  v_mfma_f32_16x16x32_bf16 v[96:99], v[120:123], v[44:47], v[96:99]
  v_max3_u32 v74, v74, v46, v47
  v_mfma_f32_16x16x32_bf16 v[100:103], v[124:127], v[44:47], v[100:103]
  v_mfma_f32_16x16x32_bf16 v[104:107], v[128:131], v[44:47], v[104:107]
  v_mfma_f32_16x16x32_bf16 v[108:111], v[132:135], v[44:47], v[108:111]
  s_waitcnt vmcnt(6)
  v_mfma_f32_16x16x32_bf16 v[92:95], v[136:139], v[48:51], v[92:95]
  v_max3_u32 v74, v74, v48, v49
  v_mfma_f32_16x16x32_bf16 v[96:99], v[140:143], v[48:51], v[96:99]
  v_max3_u32 v74, v74, v50, v51
  v_mfma_f32_16x16x32_bf16 v[100:103], v[144:147], v[48:51], v[100:103]
  v_mfma_f32_16x16x32_bf16 v[104:107], v[148:151], v[48:51], v[104:107]
  v_mfma_f32_16x16x32_bf16 v[108:111], v[152:155], v[48:51], v[108:111]
  s_waitcnt vmcnt(5)
  v_mfma_f32_16x16x32_bf16 v[92:95], v[156:159], v[52:55], v[92:95]
  v_max3_u32 v74, v74, v52, v53
  v_mfma_f32_16x16x32_bf16 v[96:99], v[160:163], v[52:55], v[96:99]
  v_max3_u32 v74, v74, v54, v55
  v_mfma_f32_16x16x32_bf16 v[100:103], v[164:167], v[52:55], v[100:103]
  v_mfma_f32_16x16x32_bf16 v[104:107], v[168:171], v[52:55], v[104:107]
  v_mfma_f32_16x16x32_bf16 v[108:111], v[172:175], v[52:55], v[108:111]
  s_waitcnt vmcnt(4)
  v_mfma_f32_16x16x32_bf16 v[92:95], v[176:179], v[56:59], v[92:95]
  v_max3_u32 v74, v74, v56, v57
  v_mfma_f32_16x16x32_bf16 v[96:99], v[180:183], v[56:59], v[96:99]
  v_max3_u32 v74, v74, v58, v59
  v_mfma_f32_16x16x32_bf16 v[100:103], v[184:187], v[56:59], v[100:103]
  v_mfma_f32_16x16x32_bf16 v[104:107], v[188:191], v[56:59], v[104:107]
  v_mfma_f32_16x16x32_bf16 v[108:111], v[192:195], v[56:59], v[108:111]
  s_waitcnt vmcnt(3)
  v_mfma_f32_16x16x32_bf16 v[92:95], v[196:199], v[60:63], v[92:95]
  v_max3_u32 v74, v74, v60, v61
  v_mfma_f32_16x16x32_bf16 v[96:99], v[200:203], v[60:63], v[96:99]
  v_max3_u32 v74, v74, v62, v63
  v_mfma_f32_16x16x32_bf16 v[100:103], v[204:207], v[60:63], v[100:103]
  v_mfma_f32_16x16x32_bf16 v[104:107], v[208:211], v[60:63], v[104:107]
  v_mfma_f32_16x16x32_bf16 v[108:111], v[212:215], v[60:63], v[108:111]
  s_waitcnt vmcnt(2)
  v_mfma_f32_16x16x32_bf16 v[92:95], v[216:219], v[64:67], v[92:95]
  v_max3_u32 v74, v74, v64, v65
  v_mfma_f32_16x16x32_bf16 v[96:99], v[220:223], v[64:67], v[96:99]
  v_max3_u32 v74, v74, v66, v67
  v_mfma_f32_16x16x32_bf16 v[100:103], v[224:227], v[64:67], v[100:103]
  v_mfma_f32_16x16x32_bf16 v[104:107], v[228:231], v[64:67], v[104:107]
  v_mfma_f32_16x16x32_bf16 v[108:111], v[232:235], v[64:67], v[108:111]
  s_waitcnt vmcnt(0)
  v_mfma_f32_16x16x32_bf16 v[92:95], v[236:239], v[68:71], v[92:95]
  v_max3_u32 v74, v74, v68, v69
  v_mfma_f32_16x16x32_bf16 v[96:99], v[240:243], v[68:71], v[96:99]
  v_max3_u32 v74, v74, v70, v71
  v_mfma_f32_16x16x32_bf16 v[100:103], v[244:247], v[68:71], v[100:103]
  v_mfma_f32_16x16x32_bf16 v[104:107], v[248:251], v[68:71], v[104:107]
  v_mfma_f32_16x16x32_bf16 v[108:111], v[252:255], v[68:71], v[108:111]
  v_cmp_eq_u32 vcc, -1, v74
  s_nop 0
  v_cvt_pk_bf16_f32 v2, v92, v93
  v_cvt_pk_bf16_f32 v3, v94, v95
  v_cvt_pk_bf16_f32 v4, v96, v97
  v_cvt_pk_bf16_f32 v5, v98, v99
  v_cvt_pk_bf16_f32 v6, v100, v101
  v_cvt_pk_bf16_f32 v7, v102, v103
  v_cvt_pk_bf16_f32 v8, v104, v105
  v_cvt_pk_bf16_f32 v9, v106, v107
  v_cvt_pk_bf16_f32 v10, v108, v109
  v_cvt_pk_bf16_f32 v11, v110, v111
  s_cmp_lt_u32 s9, 0x40000
  s_cselect_b64 vcc, vcc, 0
  s_cmp_lg_u64 vcc, 0
  s_cbranch_scc1 A3_redo
  buffer_store_dwordx4 v[2:5], v17, s[56:59], s70 offen
  buffer_store_dwordx4 v[6:9], v17, s[56:59], s70 offen offset:16
  buffer_store_dwordx2 v[10:11], v17, s[56:59], s70 offen offset:32
  s_cmp_lg_u32 s4, 0
  s_cbranch_scc1 A3_end
  v_readfirstlane_b32 s11, v14
  s_nop 0
  s_cmp_lg_u32 s11, 255
  s_cbranch_scc1 A3_end
  s_mov_b32 s11, 0
  v_mov_b32 v20, s14
  v_mov_b32 v21, 0
  s_mov_b64 exec, 1
  buffer_store_dword v20, v21, s[52:55], s11 offen sc1
  s_mov_b64 exec, -1
A3_end:
  s_endpgm
L_notA:
  s_sub_u32 s9, s9, 16
  s_add_u32 s6, s6, TABLES-L_pc
  s_addc_u32 s7, s7, 0
  s_waitcnt lgkmcnt(0)
  s_mov_b32 s12, s9
  s_mov_b32 s71, 0
  s_mov_b32 s70, 0
  s_lshl_b32 s5, s8, 4
  s_cmp_lt_u32 s8, 4
  s_cbranch_scc1 L_B
  s_sub_u32 s13, s5, 64
  s_cmp_lt_u32 s8, 6
  s_cbranch_scc1 L_H
  s_lshl_b32 s5, s8, 3
  s_add_u32 s5, s5, 16
  s_cmp_lt_u32 s9, 8
  s_cbranch_scc1 L_B
  s_sub_u32 s13, s5, 40
L_H:
  s_add_u32 s13, s13, s9
  s_cmp_ge_u32 s13, 40
  s_cselect_b32 s70, 1, 0
  s_min_u32 s5, s13, 39
  s_lshl_b32 s5, s5, 1
  s_mov_b32 s9, 0
  s_mov_b32 s71, 1
L_B:
  s_add_u32 s5, s5, s9
  v_lshlrev_b32 v1, 2, v0
  s_lshl_b32 s52, s5, 3
  s_add_u32 s52, s52, s4
  s_lshl_b32 s53, s71, 2
  s_add_u32 s52, s52, s53
  s_lshl_b32 s53, s52, 8
  s_min_u32 s53, s53, 161536
  s_lshl_b32 s54, s52, 8
  v_add_u32 v30, s54, v1
  v_add_u32 v28, s53, v1
  global_load_dword v16, v30, s[26:27] offset:0
  global_load_dword v17, v30, s[28:29] offset:0
  global_load_dword v18, v30, s[30:31] offset:0
  global_load_dword v19, v30, s[32:33] offset:0
  global_load_dword v20, v28, s[26:27] offset:2048
  global_load_dword v21, v28, s[28:29] offset:2048
  global_load_dword v22, v28, s[30:31] offset:2048
  global_load_dword v23, v28, s[32:33] offset:2048
  s_lshl_b32 s53, s52, 1
  s_and_b32 s53, s53, 0xfffffffc
  s_add_u32 s54, s53, 16
  s_min_u32 s54, s54, 1276
  s_load_dword s56, s[34:35], s53
  s_load_dword s57, s[34:35], s54
  s_load_dword s58, s[36:37], s53
  s_load_dword s59, s[36:37], s54
  v_mov_b32 v204, 0
  global_load_dword v207, v204, s[42:43] sc1
  global_load_dword v2, v1, s[6:7] offset:0
  global_load_dword v3, v1, s[6:7] offset:256
  global_load_dword v4, v1, s[6:7] offset:512
  global_load_dword v5, v1, s[6:7] offset:768
  global_load_dword v6, v1, s[6:7] offset:1024
  global_load_dword v7, v1, s[6:7] offset:1280
  global_load_dword v8, v1, s[6:7] offset:1536
  global_load_dword v9, v1, s[6:7] offset:1792
  global_load_dword v10, v1, s[6:7] offset:2048
  global_load_dword v11, v1, s[6:7] offset:2304
  global_load_dword v12, v1, s[6:7] offset:2560
  s_cmp_eq_u32 s71, 0
  s_cbranch_scc1 B_nozero
  s_mov_b32 s64, s42
  s_mov_b32 s65, s43
  s_mov_b32 s66, 268435456
  s_mov_b32 s67, 0x20000
  v_mov_b32 v212, 0
  v_mov_b32 v213, 0
  v_mov_b32 v214, 0
  v_mov_b32 v215, 0
  v_lshlrev_b32 v216, 4, v0
  s_lshl_b32 s3, s13, 2
  s_add_u32 s3, s3, s4
  s_lshl_b32 s3, s3, 10
  s_add_u32 s3, s3, 65536
  buffer_store_dwordx4 v[212:215], v216, s[64:67], s3 offen sc1
B_nozero:
  s_lshl_b32 s60, s12, 2
  s_add_u32 s60, s60, s4
  s_min_u32 s60, s60, 49
  s_mul_i32 s53, s60, 13108
  s_lshr_b32 s53, s53, 16
  s_mul_i32 s54, s53, 5
  s_sub_u32 s54, s60, s54
  s_lshl_b32 s54, s54, 7
  s_and_b32 s55, s8, 1
  s_mul_i32 s55, s55, 640
  s_add_u32 s54, s54, s55
  s_lshl_b32 s53, s53, 6
  v_add_u32 v220, s53, v0
  v_mul_u32_u24 v225, 3840, v220
  v_mul_u32_u24 v220, 1280, v220
  v_add_u32 v225, s54, v225
  v_add_u32 v220, s54, v220
  v_mov_b32 v228, v220
  v_mul_u32_u24 v218, 1280, v0
  v_mul_u32_u24 v219, 3840, v0
  s_lshl_b32 s60, s12, 2
  s_add_u32 s60, s60, s4
  s_mul_i32 s53, s60, 3641
  s_lshr_b32 s53, s53, 16
  s_mul_i32 s54, s53, 18
  s_sub_u32 s54, s60, s54
  s_min_u32 s53, s53, 9
  s_cmp_ge_u32 s54, 8
  s_cbranch_scc1 B_pfw0
  s_lshr_b32 s55, s8, 1
  s_lshl_b32 s55, s55, 3
  s_add_u32 s55, s55, s54
  s_mul_i32 s55, s55, 81920
  s_lshl_b32 s53, s53, 7
  s_add_u32 s55, s55, s53
  v_add_u32 v220, s55, v218
  global_load_dword v221, v220, s[16:17]
  s_branch B_pfe0
B_pfw0:
  s_sub_u32 s54, s54, 8
  s_lshl_b32 s55, s54, 7
  s_cmp_ge_u32 s54, 5
  s_cselect_b32 s54, 640, 0
  s_add_u32 s55, s55, s54
  s_and_b32 s54, s8, 1
  s_mul_i32 s54, s54, 640
  s_add_u32 s55, s55, s54
  s_mul_i32 s53, s53, 245760
  s_add_u32 s55, s55, s53
  s_add_u32 s55, s55, 1280
  v_add_u32 v220, s55, v219
  global_load_dword v221, v220, s[18:19]
B_pfe0:
  s_add_u32 s60, s60, 64
  s_mul_i32 s53, s60, 3641
  s_lshr_b32 s53, s53, 16
  s_mul_i32 s54, s53, 18
  s_sub_u32 s54, s60, s54
  s_min_u32 s53, s53, 9
  s_cmp_ge_u32 s54, 8
  s_cbranch_scc1 B_pfw1
  s_lshr_b32 s55, s8, 1
  s_lshl_b32 s55, s55, 3
  s_add_u32 s55, s55, s54
  s_mul_i32 s55, s55, 81920
  s_lshl_b32 s53, s53, 7
  s_add_u32 s55, s55, s53
  v_add_u32 v220, s55, v218
  global_load_dword v222, v220, s[16:17]
  s_branch B_pfe1
B_pfw1:
  s_sub_u32 s54, s54, 8
  s_lshl_b32 s55, s54, 7
  s_cmp_ge_u32 s54, 5
  s_cselect_b32 s54, 640, 0
  s_add_u32 s55, s55, s54
  s_and_b32 s54, s8, 1
  s_mul_i32 s54, s54, 640
  s_add_u32 s55, s55, s54
  s_mul_i32 s53, s53, 245760
  s_add_u32 s55, s55, s53
  s_add_u32 s55, s55, 1280
  v_add_u32 v220, s55, v219
  global_load_dword v222, v220, s[18:19]
B_pfe1:
  s_add_u32 s60, s60, 64
  s_mul_i32 s53, s60, 3641
  s_lshr_b32 s53, s53, 16
  s_mul_i32 s54, s53, 18
  s_sub_u32 s54, s60, s54
  s_min_u32 s53, s53, 9
  s_cmp_ge_u32 s54, 8
  s_cbranch_scc1 B_pfw2
  s_lshr_b32 s55, s8, 1
  s_lshl_b32 s55, s55, 3
  s_add_u32 s55, s55, s54
  s_mul_i32 s55, s55, 81920
  s_lshl_b32 s53, s53, 7
  s_add_u32 s55, s55, s53
  v_add_u32 v220, s55, v218
  global_load_dword v223, v220, s[16:17]
  s_branch B_pfe2
B_pfw2:
  s_sub_u32 s54, s54, 8
  s_lshl_b32 s55, s54, 7
  s_cmp_ge_u32 s54, 5
  s_cselect_b32 s54, 640, 0
  s_add_u32 s55, s55, s54
  s_and_b32 s54, s8, 1
  s_mul_i32 s54, s54, 640
  s_add_u32 s55, s55, s54
  s_mul_i32 s53, s53, 245760
  s_add_u32 s55, s55, s53
  s_add_u32 s55, s55, 1280
  v_add_u32 v220, s55, v219
  global_load_dword v223, v220, s[18:19]
B_pfe2:
  s_add_u32 s60, s60, 64
  s_mov_b32 s44, s24
  s_mov_b32 s45, s25
  s_mov_b32 s46, 2621440
  s_mov_b32 s47, 0x20000
  s_mov_b32 s48, s38
  s_mov_b32 s49, s39
  s_mov_b32 s50, 5242880
  s_mov_b32 s51, 0x20000
  s_mov_b32 s53, 1280
  v_mul_lo_u32 v31, v0, s53
  s_mul_i32 s69, s4, 655360
  s_lshl_b32 s55, s5, 4
  s_add_u32 s69, s69, s55
  s_lshl_b32 s55, s4, 13
  s_add_u32 s15, s55, 16
  s_and_b32 s3, s5, 7
  s_cmp_lg_u32 s71, 0
  s_cbranch_scc1 B_noraw
  s_waitcnt vmcnt(3)
  s_branch B_rawdone
B_noraw:
  s_waitcnt vmcnt(3)
B_rawdone:
  s_mov_b32 s64, 0
  s_mov_b32 s65, -1
  s_mov_b32 s62, 0x55555555
  s_mov_b32 s63, 0
  s_mov_b32 s66, 0x55555555
  s_mov_b32 s67, 0x55555555
  v_mov_b32 v200, 0
  v_mov_b32 v201, 0
  v_mov_b32 v202, 0
  v_mov_b32 v203, 0
  ds_write_b128 v200, v[200:203]
  s_mul_i32 s68, s4, 8448
  s_add_u32 s68, s68, 32784
  s_add_u32 s53, s68, 33792
  v_lshl_add_u32 v24, v0, 3, s53
  v_cmp_eq_u32 vcc, 0, v0
  v_mov_b32 v204, 0x3f80
  v_mov_b32 v205, 0x3f80
  v_cndmask_b32 v27, 0, 1.0, vcc
  v_add_u32 v2, s53, v2
  v_add_u32 v3, s53, v3
  v_add_u32 v4, s68, v4
  v_add_u32 v5, s68, v5
  v_add_u32 v12, s68, v12
  s_and_b32 s53, s4, 1
  s_lshl_b32 s53, s53, 4
  s_waitcnt lgkmcnt(0)
  s_lshr_b32 s56, s56, s53
  s_lshl_b32 s56, s56, 16
  s_lshr_b32 s57, s57, s53
  s_lshl_b32 s57, s57, 16
  s_lshr_b32 s58, s58, s53
  s_lshl_b32 s58, s58, 16
  s_lshr_b32 s59, s59, s53
  s_lshl_b32 s59, s59, 16
  s_mov_b32 s60, 0
  v_add_u32 v207, 1, v207
  s_nop 0
  v_readfirstlane_b32 s53, v207
  s_nop 0
  s_mov_b32 s14, s53
  s_cmp_eq_u32 s71, 0
  s_cbranch_scc1 B_nozf
  s_barrier
  s_cmp_lg_u32 s4, 0
  s_cbranch_scc1 S_done
  s_lshl_b32 s3, s13, 2
  s_add_u32 s3, s3, 4096
  v_mov_b32 v216, s3
  v_mov_b32 v217, s14
  s_mov_b64 exec, 1
  global_store_dword v216, v217, s[42:43] sc1
  v_mov_b32 v14, 1
  v_mov_b32 v216, 0
  global_atomic_add v14, v216, v14, s[40:41] sc0
  s_mov_b64 exec, -1
S_done:
  s_cmp_eq_u32 s70, 1
  s_cbranch_scc1 L_join
B_nozf:
B_kgen_ch:
  s_cmp_lg_u32 s71, 0
  v_mov_b32 v25, s56
  v_mul_f32 v25, 0x3fb8aa3b, v25
  v_exp_f32 v25, v25
  v_mov_b32 v26, s58
  v_cvt_pk_bf16_f32 v25, v25, v25
  v_lshlrev_b32 v25, 16, v25
  v_lshlrev_b32 v58, 16, v16
  v_and_b32 v90, 0xffff0000, v16
  v_mul_f32 v58, 0x3fb8aa3b, v58
  global_load_dword v226, v225, s[18:19]
  v_mul_f32 v90, 0x3fb8aa3b, v90
  v_exp_f32 v58, v58
  v_exp_f32 v90, v90
  v_lshlrev_b32 v33, 16, v17
  v_and_b32 v65, 0xffff0000, v17
  v_lshlrev_b32 v34, 16, v18
  v_and_b32 v66, 0xffff0000, v18
  v_lshlrev_b32 v35, 16, v19
  v_and_b32 v67, 0xffff0000, v19
  v_cvt_pk_bf16_f32 v58, v58, v58
  v_cvt_pk_bf16_f32 v90, v90, v90
  v_lshlrev_b32 v58, 16, v58
  v_lshlrev_b32 v90, 16, v90
  v_mul_f32 v32, v58, v25
  v_mul_f32 v64, v90, v25
  v_mul_f32 v33, v33, v25
  v_mul_f32 v65, v65, v25
  v_mul_f32 v32, 0xbfb8aa3b, v32
  v_mul_f32 v64, 0xbfb8aa3b, v64
  v_mul_f32 v33, 0x3e22f983, v33
  v_mul_f32 v65, 0x3e22f983, v65
  v_mul_f32 v34, v34, v25
  v_mul_f32 v66, v66, v25
  v_mul_f32 v35, v35, v25
  v_mul_f32 v67, v67, v25
  v_add_f32 v34, v34, v34
  v_add_f32 v66, v66, v66
  v_add_f32 v35, v35, v35
  v_add_f32 v67, v67, v67
  v_mul_f32 v58, 0x41000000, v32
  v_mul_f32 v90, 0x41000000, v64
  v_mul_f32 v59, 0x41000000, v33
  v_mul_f32 v91, 0x41000000, v65
  v_exp_f32 v58, v58
  v_exp_f32 v90, v90
  v_fract_f32 v59, v59
  v_fract_f32 v91, v91
  v_cos_f32 v38, v59
  v_cos_f32 v70, v91
  v_sin_f32 v39, v59
  v_sin_f32 v71, v91
  v_mul_f32 v38, v38, v58
  v_mul_f32 v70, v70, v90
  v_mul_f32 v39, v39, v58
  v_mul_f32 v71, v71, v90
  v_exp_f32 v58, v32
  v_exp_f32 v90, v64
  v_fract_f32 v59, v33
  v_fract_f32 v91, v65
  v_cos_f32 v36, v59
  v_cos_f32 v68, v91
  v_sin_f32 v37, v59
  v_sin_f32 v69, v91
  v_mul_f32 v36, v36, v58
  v_mul_f32 v68, v68, v90
  v_mul_f32 v37, v37, v58
  v_mul_f32 v69, v69, v90
  v_mul_f32 v58, 0x43800000, v32
  v_mul_f32 v90, 0x43800000, v64
  v_mul_f32 v59, 0x43800000, v33
  v_mul_f32 v91, 0x43800000, v65
  v_exp_f32 v58, v58
  v_exp_f32 v90, v90
  v_fract_f32 v59, v59
  v_fract_f32 v91, v91
  v_cos_f32 v40, v59
  v_cos_f32 v72, v91
  v_sin_f32 v41, v59
  v_sin_f32 v73, v91
  v_mul_f32 v40, v40, v58
  v_mul_f32 v72, v72, v90
  v_mul_f32 v41, v41, v58
  v_mul_f32 v73, v73, v90
  ds_write_b64 v24, v[204:205]
  v_cvt_pk_bf16_f32 v96, v38, v39
  v_cvt_pk_bf16_f32 v97, v70, v71
  v_pk_mul_f32 v[52:53], v[38:39], v[38:39] op_sel:[0,0] op_sel_hi:[1,0]
  v_pk_mul_f32 v[84:85], v[70:71], v[70:71] op_sel:[0,0] op_sel_hi:[1,0]
  v_pk_fma_f32 v[48:49], v[38:39], v[38:39], v[52:53] op_sel:[1,1,0] op_sel_hi:[0,1,1] neg_lo:[1,0,0]
  v_pk_fma_f32 v[80:81], v[70:71], v[70:71], v[84:85] op_sel:[1,1,0] op_sel_hi:[0,1,1] neg_lo:[1,0,0]
  v_cvt_pk_bf16_f32 v98, v48, v49
  v_cvt_pk_bf16_f32 v99, v80, v81
  v_pk_mul_f32 v[52:53], v[48:49], v[38:39] op_sel:[0,0] op_sel_hi:[1,0]
  v_pk_mul_f32 v[84:85], v[80:81], v[70:71] op_sel:[0,0] op_sel_hi:[1,0]
  v_pk_fma_f32 v[50:51], v[48:49], v[38:39], v[52:53] op_sel:[1,1,0] op_sel_hi:[0,1,1] neg_lo:[1,0,0]
  v_pk_fma_f32 v[82:83], v[80:81], v[70:71], v[84:85] op_sel:[1,1,0] op_sel_hi:[0,1,1] neg_lo:[1,0,0]
  v_cvt_pk_bf16_f32 v100, v50, v51
  v_cvt_pk_bf16_f32 v101, v82, v83
  v_pk_mul_f32 v[52:53], v[50:51], v[38:39] op_sel:[0,0] op_sel_hi:[1,0]
  v_pk_mul_f32 v[84:85], v[82:83], v[70:71] op_sel:[0,0] op_sel_hi:[1,0]
  v_pk_fma_f32 v[48:49], v[50:51], v[38:39], v[52:53] op_sel:[1,1,0] op_sel_hi:[0,1,1] neg_lo:[1,0,0]
  v_pk_fma_f32 v[80:81], v[82:83], v[70:71], v[84:85] op_sel:[1,1,0] op_sel_hi:[0,1,1] neg_lo:[1,0,0]
  v_cvt_pk_bf16_f32 v102, v48, v49
  v_cvt_pk_bf16_f32 v103, v80, v81
  s_cbranch_scc1 B_nr0
  s_lshl_b32 s11, s3, 10
  s_add_u32 m0, s11, s15
  s_mul_i32 s11, s3, 81920
  s_add_u32 s11, s11, s69
  buffer_load_dwordx4 v31, s[44:47], s11 offen lds
  s_add_u32 s3, s3, 1
  s_and_b32 s3, s3, 7
B_nr0:
  s_cmp_lg_u32 s71, 0
  ds_write_b64 v24, v[96:97] offset:528
  ds_write_b64 v24, v[98:99] offset:1056
  ds_write_b64 v24, v[100:101] offset:1584
  ds_write_b64 v24, v[102:103] offset:2112
  v_pk_mul_f32 v[52:53], v[48:49], v[38:39] op_sel:[0,0] op_sel_hi:[1,0]
  v_pk_mul_f32 v[84:85], v[80:81], v[70:71] op_sel:[0,0] op_sel_hi:[1,0]
  v_pk_fma_f32 v[50:51], v[48:49], v[38:39], v[52:53] op_sel:[1,1,0] op_sel_hi:[0,1,1] neg_lo:[1,0,0]
  v_pk_fma_f32 v[82:83], v[80:81], v[70:71], v[84:85] op_sel:[1,1,0] op_sel_hi:[0,1,1] neg_lo:[1,0,0]
  v_cvt_pk_bf16_f32 v96, v50, v51
  v_cvt_pk_bf16_f32 v97, v82, v83
  v_pk_mul_f32 v[52:53], v[50:51], v[38:39] op_sel:[0,0] op_sel_hi:[1,0]
  v_pk_mul_f32 v[84:85], v[82:83], v[70:71] op_sel:[0,0] op_sel_hi:[1,0]
  v_pk_fma_f32 v[48:49], v[50:51], v[38:39], v[52:53] op_sel:[1,1,0] op_sel_hi:[0,1,1] neg_lo:[1,0,0]
  v_pk_fma_f32 v[80:81], v[82:83], v[70:71], v[84:85] op_sel:[1,1,0] op_sel_hi:[0,1,1] neg_lo:[1,0,0]
  v_cvt_pk_bf16_f32 v98, v48, v49
  v_cvt_pk_bf16_f32 v99, v80, v81
  v_pk_mul_f32 v[52:53], v[48:49], v[38:39] op_sel:[0,0] op_sel_hi:[1,0]
  v_pk_mul_f32 v[84:85], v[80:81], v[70:71] op_sel:[0,0] op_sel_hi:[1,0]
  v_pk_fma_f32 v[50:51], v[48:49], v[38:39], v[52:53] op_sel:[1,1,0] op_sel_hi:[0,1,1] neg_lo:[1,0,0]
  v_pk_fma_f32 v[82:83], v[80:81], v[70:71], v[84:85] op_sel:[1,1,0] op_sel_hi:[0,1,1] neg_lo:[1,0,0]
  v_cvt_pk_bf16_f32 v100, v50, v51
  v_cvt_pk_bf16_f32 v101, v82, v83
  v_pk_mul_f32 v[52:53], v[50:51], v[38:39] op_sel:[0,0] op_sel_hi:[1,0]
  v_pk_mul_f32 v[84:85], v[82:83], v[70:71] op_sel:[0,0] op_sel_hi:[1,0]
  v_pk_fma_f32 v[48:49], v[50:51], v[38:39], v[52:53] op_sel:[1,1,0] op_sel_hi:[0,1,1] neg_lo:[1,0,0]
  v_pk_fma_f32 v[80:81], v[82:83], v[70:71], v[84:85] op_sel:[1,1,0] op_sel_hi:[0,1,1] neg_lo:[1,0,0]
  v_cvt_pk_bf16_f32 v102, v48, v49
  v_cvt_pk_bf16_f32 v103, v80, v81
  ds_write_b64 v24, v[96:97] offset:2640
  ds_write_b64 v24, v[98:99] offset:3168
  ds_write_b64 v24, v[100:101] offset:3696
  ds_write_b64 v24, v[102:103] offset:4224
  v_pk_mul_f32 v[52:53], v[48:49], v[38:39] op_sel:[0,0] op_sel_hi:[1,0]
  v_pk_mul_f32 v[84:85], v[80:81], v[70:71] op_sel:[0,0] op_sel_hi:[1,0]
  v_pk_fma_f32 v[50:51], v[48:49], v[38:39], v[52:53] op_sel:[1,1,0] op_sel_hi:[0,1,1] neg_lo:[1,0,0]
  v_pk_fma_f32 v[82:83], v[80:81], v[70:71], v[84:85] op_sel:[1,1,0] op_sel_hi:[0,1,1] neg_lo:[1,0,0]
  v_cvt_pk_bf16_f32 v96, v50, v51
  v_cvt_pk_bf16_f32 v97, v82, v83
  v_pk_mul_f32 v[52:53], v[50:51], v[38:39] op_sel:[0,0] op_sel_hi:[1,0]
  global_load_dword v227, v228, s[22:23]
  v_pk_mul_f32 v[84:85], v[82:83], v[70:71] op_sel:[0,0] op_sel_hi:[1,0]
  v_pk_fma_f32 v[48:49], v[50:51], v[38:39], v[52:53] op_sel:[1,1,0] op_sel_hi:[0,1,1] neg_lo:[1,0,0]
  v_pk_fma_f32 v[80:81], v[82:83], v[70:71], v[84:85] op_sel:[1,1,0] op_sel_hi:[0,1,1] neg_lo:[1,0,0]
  v_cvt_pk_bf16_f32 v98, v48, v49
  v_cvt_pk_bf16_f32 v99, v80, v81
  v_pk_mul_f32 v[52:53], v[48:49], v[38:39] op_sel:[0,0] op_sel_hi:[1,0]
  v_pk_mul_f32 v[84:85], v[80:81], v[70:71] op_sel:[0,0] op_sel_hi:[1,0]
  v_pk_fma_f32 v[50:51], v[48:49], v[38:39], v[52:53] op_sel:[1,1,0] op_sel_hi:[0,1,1] neg_lo:[1,0,0]
  v_pk_fma_f32 v[82:83], v[80:81], v[70:71], v[84:85] op_sel:[1,1,0] op_sel_hi:[0,1,1] neg_lo:[1,0,0]
  v_cvt_pk_bf16_f32 v100, v50, v51
  v_cvt_pk_bf16_f32 v101, v82, v83
  v_pk_mul_f32 v[52:53], v[50:51], v[38:39] op_sel:[0,0] op_sel_hi:[1,0]
  v_pk_mul_f32 v[84:85], v[82:83], v[70:71] op_sel:[0,0] op_sel_hi:[1,0]
  v_pk_fma_f32 v[48:49], v[50:51], v[38:39], v[52:53] op_sel:[1,1,0] op_sel_hi:[0,1,1] neg_lo:[1,0,0]
  s_cbranch_scc1 B_nr1
  s_lshl_b32 s11, s3, 10
  s_add_u32 m0, s11, s15
  s_mul_i32 s11, s3, 81920
  s_add_u32 s11, s11, s69
  buffer_load_dwordx4 v31, s[44:47], s11 offen lds
  s_add_u32 s3, s3, 1
  s_and_b32 s3, s3, 7
B_nr1:
  s_cmp_lg_u32 s71, 0
  v_pk_fma_f32 v[80:81], v[82:83], v[70:71], v[84:85] op_sel:[1,1,0] op_sel_hi:[0,1,1] neg_lo:[1,0,0]
  v_cvt_pk_bf16_f32 v102, v48, v49
  v_cvt_pk_bf16_f32 v103, v80, v81
  ds_write_b64 v24, v[96:97] offset:4752
  ds_write_b64 v24, v[98:99] offset:5280
  ds_write_b64 v24, v[100:101] offset:5808
  ds_write_b64 v24, v[102:103] offset:6336
  v_pk_mul_f32 v[52:53], v[48:49], v[38:39] op_sel:[0,0] op_sel_hi:[1,0]
  v_pk_mul_f32 v[84:85], v[80:81], v[70:71] op_sel:[0,0] op_sel_hi:[1,0]
  v_pk_fma_f32 v[50:51], v[48:49], v[38:39], v[52:53] op_sel:[1,1,0] op_sel_hi:[0,1,1] neg_lo:[1,0,0]
  v_pk_fma_f32 v[82:83], v[80:81], v[70:71], v[84:85] op_sel:[1,1,0] op_sel_hi:[0,1,1] neg_lo:[1,0,0]
  v_cvt_pk_bf16_f32 v96, v50, v51
  v_cvt_pk_bf16_f32 v97, v82, v83
  v_pk_mul_f32 v[52:53], v[50:51], v[38:39] op_sel:[0,0] op_sel_hi:[1,0]
  v_pk_mul_f32 v[84:85], v[82:83], v[70:71] op_sel:[0,0] op_sel_hi:[1,0]
  v_pk_fma_f32 v[48:49], v[50:51], v[38:39], v[52:53] op_sel:[1,1,0] op_sel_hi:[0,1,1] neg_lo:[1,0,0]
  v_pk_fma_f32 v[80:81], v[82:83], v[70:71], v[84:85] op_sel:[1,1,0] op_sel_hi:[0,1,1] neg_lo:[1,0,0]
  v_cvt_pk_bf16_f32 v98, v48, v49
  v_cvt_pk_bf16_f32 v99, v80, v81
  v_pk_mul_f32 v[52:53], v[48:49], v[38:39] op_sel:[0,0] op_sel_hi:[1,0]
  v_pk_mul_f32 v[84:85], v[80:81], v[70:71] op_sel:[0,0] op_sel_hi:[1,0]
  v_pk_fma_f32 v[50:51], v[48:49], v[38:39], v[52:53] op_sel:[1,1,0] op_sel_hi:[0,1,1] neg_lo:[1,0,0]
  v_pk_fma_f32 v[82:83], v[80:81], v[70:71], v[84:85] op_sel:[1,1,0] op_sel_hi:[0,1,1] neg_lo:[1,0,0]
  v_cvt_pk_bf16_f32 v100, v50, v51
  v_cvt_pk_bf16_f32 v101, v82, v83
  v_pk_mul_f32 v[52:53], v[50:51], v[38:39] op_sel:[0,0] op_sel_hi:[1,0]
  v_pk_mul_f32 v[84:85], v[82:83], v[70:71] op_sel:[0,0] op_sel_hi:[1,0]
  v_pk_fma_f32 v[48:49], v[50:51], v[38:39], v[52:53] op_sel:[1,1,0] op_sel_hi:[0,1,1] neg_lo:[1,0,0]
  v_pk_fma_f32 v[80:81], v[82:83], v[70:71], v[84:85] op_sel:[1,1,0] op_sel_hi:[0,1,1] neg_lo:[1,0,0]
  v_cvt_pk_bf16_f32 v102, v48, v49
  v_cvt_pk_bf16_f32 v103, v80, v81
  ds_write_b64 v24, v[96:97] offset:6864
  ds_write_b64 v24, v[98:99] offset:7392
  ds_write_b64 v24, v[100:101] offset:7920
  ds_write_b64 v24, v[102:103] offset:33792
  v_pk_mul_f32 v[52:53], v[48:49], v[38:39] op_sel:[0,0] op_sel_hi:[1,0]
  v_pk_mul_f32 v[84:85], v[80:81], v[70:71] op_sel:[0,0] op_sel_hi:[1,0]
  v_pk_fma_f32 v[50:51], v[48:49], v[38:39], v[52:53] op_sel:[1,1,0] op_sel_hi:[0,1,1] neg_lo:[1,0,0]
  v_pk_fma_f32 v[82:83], v[80:81], v[70:71], v[84:85] op_sel:[1,1,0] op_sel_hi:[0,1,1] neg_lo:[1,0,0]
  v_cvt_pk_bf16_f32 v96, v50, v51
  v_cvt_pk_bf16_f32 v97, v82, v83
  v_pk_mul_f32 v[52:53], v[50:51], v[38:39] op_sel:[0,0] op_sel_hi:[1,0]
  v_pk_mul_f32 v[84:85], v[82:83], v[70:71] op_sel:[0,0] op_sel_hi:[1,0]
  v_pk_fma_f32 v[48:49], v[50:51], v[38:39], v[52:53] op_sel:[1,1,0] op_sel_hi:[0,1,1] neg_lo:[1,0,0]
  v_pk_fma_f32 v[80:81], v[82:83], v[70:71], v[84:85] op_sel:[1,1,0] op_sel_hi:[0,1,1] neg_lo:[1,0,0]
  v_cvt_pk_bf16_f32 v98, v48, v49
  v_cvt_pk_bf16_f32 v99, v80, v81
  v_pk_mul_f32 v[52:53], v[48:49], v[38:39] op_sel:[0,0] op_sel_hi:[1,0]
  v_pk_mul_f32 v[84:85], v[80:81], v[70:71] op_sel:[0,0] op_sel_hi:[1,0]
  v_pk_fma_f32 v[50:51], v[48:49], v[38:39], v[52:53] op_sel:[1,1,0] op_sel_hi:[0,1,1] neg_lo:[1,0,0]
  v_pk_fma_f32 v[82:83], v[80:81], v[70:71], v[84:85] op_sel:[1,1,0] op_sel_hi:[0,1,1] neg_lo:[1,0,0]
  v_cvt_pk_bf16_f32 v100, v50, v51
  v_cvt_pk_bf16_f32 v101, v82, v83
  s_cbranch_scc1 B_nr2
  s_lshl_b32 s11, s3, 10
  s_add_u32 m0, s11, s15
  s_mul_i32 s11, s3, 81920
  s_add_u32 s11, s11, s69
  buffer_load_dwordx4 v31, s[44:47], s11 offen lds
  s_add_u32 s3, s3, 1
  s_and_b32 s3, s3, 7
B_nr2:
  s_cmp_lg_u32 s71, 0
  v_pk_mul_f32 v[52:53], v[50:51], v[38:39] op_sel:[0,0] op_sel_hi:[1,0]
  v_pk_mul_f32 v[84:85], v[82:83], v[70:71] op_sel:[0,0] op_sel_hi:[1,0]
  v_pk_fma_f32 v[48:49], v[50:51], v[38:39], v[52:53] op_sel:[1,1,0] op_sel_hi:[0,1,1] neg_lo:[1,0,0]
  v_pk_fma_f32 v[80:81], v[82:83], v[70:71], v[84:85] op_sel:[1,1,0] op_sel_hi:[0,1,1] neg_lo:[1,0,0]
  v_cvt_pk_bf16_f32 v102, v48, v49
  v_cvt_pk_bf16_f32 v103, v80, v81
  ds_write_b64 v24, v[96:97] offset:34320
  ds_write_b64 v24, v[98:99] offset:34848
  ds_write_b64 v24, v[100:101] offset:35376
  ds_write_b64 v24, v[102:103] offset:35904
  v_pk_mul_f32 v[52:53], v[48:49], v[38:39] op_sel:[0,0] op_sel_hi:[1,0]
  v_pk_mul_f32 v[84:85], v[80:81], v[70:71] op_sel:[0,0] op_sel_hi:[1,0]
  v_pk_fma_f32 v[50:51], v[48:49], v[38:39], v[52:53] op_sel:[1,1,0] op_sel_hi:[0,1,1] neg_lo:[1,0,0]
  v_pk_fma_f32 v[82:83], v[80:81], v[70:71], v[84:85] op_sel:[1,1,0] op_sel_hi:[0,1,1] neg_lo:[1,0,0]
  v_cvt_pk_bf16_f32 v96, v50, v51
  v_cvt_pk_bf16_f32 v97, v82, v83
  v_pk_mul_f32 v[52:53], v[50:51], v[38:39] op_sel:[0,0] op_sel_hi:[1,0]
  v_pk_mul_f32 v[84:85], v[82:83], v[70:71] op_sel:[0,0] op_sel_hi:[1,0]
  v_pk_fma_f32 v[48:49], v[50:51], v[38:39], v[52:53] op_sel:[1,1,0] op_sel_hi:[0,1,1] neg_lo:[1,0,0]
  v_pk_fma_f32 v[80:81], v[82:83], v[70:71], v[84:85] op_sel:[1,1,0] op_sel_hi:[0,1,1] neg_lo:[1,0,0]
  v_cvt_pk_bf16_f32 v98, v48, v49
  v_cvt_pk_bf16_f32 v99, v80, v81
  v_pk_mul_f32 v[52:53], v[48:49], v[38:39] op_sel:[0,0] op_sel_hi:[1,0]
  v_pk_mul_f32 v[84:85], v[80:81], v[70:71] op_sel:[0,0] op_sel_hi:[1,0]
  v_pk_fma_f32 v[50:51], v[48:49], v[38:39], v[52:53] op_sel:[1,1,0] op_sel_hi:[0,1,1] neg_lo:[1,0,0]
  v_pk_fma_f32 v[82:83], v[80:81], v[70:71], v[84:85] op_sel:[1,1,0] op_sel_hi:[0,1,1] neg_lo:[1,0,0]
  v_cvt_pk_bf16_f32 v100, v50, v51
  v_cvt_pk_bf16_f32 v101, v82, v83
  v_pk_mul_f32 v[52:53], v[50:51], v[38:39] op_sel:[0,0] op_sel_hi:[1,0]
  v_pk_mul_f32 v[84:85], v[82:83], v[70:71] op_sel:[0,0] op_sel_hi:[1,0]
  v_pk_fma_f32 v[48:49], v[50:51], v[38:39], v[52:53] op_sel:[1,1,0] op_sel_hi:[0,1,1] neg_lo:[1,0,0]
  v_pk_fma_f32 v[80:81], v[82:83], v[70:71], v[84:85] op_sel:[1,1,0] op_sel_hi:[0,1,1] neg_lo:[1,0,0]
  v_cvt_pk_bf16_f32 v102, v48, v49
  v_cvt_pk_bf16_f32 v103, v80, v81
  ds_write_b64 v24, v[96:97] offset:36432
  ds_write_b64 v24, v[98:99] offset:36960
  ds_write_b64 v24, v[100:101] offset:37488
  ds_write_b64 v24, v[102:103] offset:38016
  v_pk_mul_f32 v[52:53], v[48:49], v[38:39] op_sel:[0,0] op_sel_hi:[1,0]
  v_pk_mul_f32 v[84:85], v[80:81], v[70:71] op_sel:[0,0] op_sel_hi:[1,0]
  v_pk_fma_f32 v[50:51], v[48:49], v[38:39], v[52:53] op_sel:[1,1,0] op_sel_hi:[0,1,1] neg_lo:[1,0,0]
  v_pk_fma_f32 v[82:83], v[80:81], v[70:71], v[84:85] op_sel:[1,1,0] op_sel_hi:[0,1,1] neg_lo:[1,0,0]
  v_cvt_pk_bf16_f32 v96, v50, v51
  v_cvt_pk_bf16_f32 v97, v82, v83
  v_pk_mul_f32 v[52:53], v[50:51], v[38:39] op_sel:[0,0] op_sel_hi:[1,0]
  v_pk_mul_f32 v[84:85], v[82:83], v[70:71] op_sel:[0,0] op_sel_hi:[1,0]
  v_pk_fma_f32 v[48:49], v[50:51], v[38:39], v[52:53] op_sel:[1,1,0] op_sel_hi:[0,1,1] neg_lo:[1,0,0]
  v_pk_fma_f32 v[80:81], v[82:83], v[70:71], v[84:85] op_sel:[1,1,0] op_sel_hi:[0,1,1] neg_lo:[1,0,0]
  v_cvt_pk_bf16_f32 v98, v48, v49
  v_cvt_pk_bf16_f32 v99, v80, v81
  v_pk_mul_f32 v[52:53], v[48:49], v[38:39] op_sel:[0,0] op_sel_hi:[1,0]
  v_pk_mul_f32 v[84:85], v[80:81], v[70:71] op_sel:[0,0] op_sel_hi:[1,0]
  v_pk_fma_f32 v[50:51], v[48:49], v[38:39], v[52:53] op_sel:[1,1,0] op_sel_hi:[0,1,1] neg_lo:[1,0,0]
  s_cbranch_scc1 B_nr3
  s_lshl_b32 s11, s3, 10
  s_add_u32 m0, s11, s15
  s_mul_i32 s11, s3, 81920
  s_add_u32 s11, s11, s69
  buffer_load_dwordx4 v31, s[44:47], s11 offen lds
  s_add_u32 s3, s3, 1
  s_and_b32 s3, s3, 7
B_nr3:
  s_cmp_lg_u32 s71, 0
  v_pk_fma_f32 v[82:83], v[80:81], v[70:71], v[84:85] op_sel:[1,1,0] op_sel_hi:[0,1,1] neg_lo:[1,0,0]
  v_cvt_pk_bf16_f32 v100, v50, v51
  v_cvt_pk_bf16_f32 v101, v82, v83
  v_pk_mul_f32 v[52:53], v[50:51], v[38:39] op_sel:[0,0] op_sel_hi:[1,0]
  v_pk_mul_f32 v[84:85], v[82:83], v[70:71] op_sel:[0,0] op_sel_hi:[1,0]
  v_pk_fma_f32 v[48:49], v[50:51], v[38:39], v[52:53] op_sel:[1,1,0] op_sel_hi:[0,1,1] neg_lo:[1,0,0]
  v_pk_fma_f32 v[80:81], v[82:83], v[70:71], v[84:85] op_sel:[1,1,0] op_sel_hi:[0,1,1] neg_lo:[1,0,0]
  v_cvt_pk_bf16_f32 v102, v48, v49
  v_cvt_pk_bf16_f32 v103, v80, v81
  ds_write_b64 v24, v[96:97] offset:38544
  ds_write_b64 v24, v[98:99] offset:39072
  ds_write_b64 v24, v[100:101] offset:39600
  ds_write_b64 v24, v[102:103] offset:40128
  v_pk_mul_f32 v[52:53], v[48:49], v[38:39] op_sel:[0,0] op_sel_hi:[1,0]
  v_pk_mul_f32 v[84:85], v[80:81], v[70:71] op_sel:[0,0] op_sel_hi:[1,0]
  v_pk_fma_f32 v[50:51], v[48:49], v[38:39], v[52:53] op_sel:[1,1,0] op_sel_hi:[0,1,1] neg_lo:[1,0,0]
  v_pk_fma_f32 v[82:83], v[80:81], v[70:71], v[84:85] op_sel:[1,1,0] op_sel_hi:[0,1,1] neg_lo:[1,0,0]
  v_cvt_pk_bf16_f32 v96, v50, v51
  v_cvt_pk_bf16_f32 v97, v82, v83
  v_pk_mul_f32 v[52:53], v[50:51], v[38:39] op_sel:[0,0] op_sel_hi:[1,0]
  v_pk_mul_f32 v[84:85], v[82:83], v[70:71] op_sel:[0,0] op_sel_hi:[1,0]
  v_pk_fma_f32 v[48:49], v[50:51], v[38:39], v[52:53] op_sel:[1,1,0] op_sel_hi:[0,1,1] neg_lo:[1,0,0]
  v_pk_fma_f32 v[80:81], v[82:83], v[70:71], v[84:85] op_sel:[1,1,0] op_sel_hi:[0,1,1] neg_lo:[1,0,0]
  v_cvt_pk_bf16_f32 v98, v48, v49
  v_cvt_pk_bf16_f32 v99, v80, v81
  v_pk_mul_f32 v[52:53], v[48:49], v[38:39] op_sel:[0,0] op_sel_hi:[1,0]
  v_pk_mul_f32 v[84:85], v[80:81], v[70:71] op_sel:[0,0] op_sel_hi:[1,0]
  v_pk_fma_f32 v[50:51], v[48:49], v[38:39], v[52:53] op_sel:[1,1,0] op_sel_hi:[0,1,1] neg_lo:[1,0,0]
  v_pk_fma_f32 v[82:83], v[80:81], v[70:71], v[84:85] op_sel:[1,1,0] op_sel_hi:[0,1,1] neg_lo:[1,0,0]
  v_cvt_pk_bf16_f32 v100, v50, v51
  v_cvt_pk_bf16_f32 v101, v82, v83
  ds_write_b64 v24, v[96:97] offset:40656
  ds_write_b64 v24, v[98:99] offset:41184
  ds_write_b64 v24, v[100:101] offset:41712
  ds_read_b128 a[64:67], v3 offset:0
  ds_read_b128 a[68:71], v3 offset:32
  ds_read_b128 a[72:75], v3 offset:64
  ds_read_b128 a[76:79], v3 offset:96
  ds_read_b128 a[80:83], v3 offset:128
  ds_read_b128 a[84:87], v3 offset:160
  ds_read_b128 a[88:91], v3 offset:192
  ds_read_b128 a[92:95], v3 offset:224
  ds_read_b128 a[96:99], v3 offset:256
  ds_read_b128 a[100:103], v3 offset:288
  ds_read_b128 a[104:107], v3 offset:320
  ds_read_b128 a[108:111], v3 offset:352
  ds_read_b128 a[112:115], v3 offset:384
  ds_read_b128 a[116:119], v3 offset:416
  ds_read_b128 a[120:123], v3 offset:448
  ds_read_b128 a[124:127], v3 offset:480
  v_cvt_pk_bf16_f32 v96, v34, -v35
  v_cvt_pk_bf16_f32 v97, v66, -v67
  v_pk_mul_f32 v[52:53], v[34:35], v[36:37] op_sel:[0,0] op_sel_hi:[1,0]
  v_pk_mul_f32 v[84:85], v[66:67], v[68:69] op_sel:[0,0] op_sel_hi:[1,0]
  v_pk_fma_f32 v[48:49], v[34:35], v[36:37], v[52:53] op_sel:[1,1,0] op_sel_hi:[0,1,1] neg_lo:[1,0,0]
  v_pk_fma_f32 v[80:81], v[66:67], v[68:69], v[84:85] op_sel:[1,1,0] op_sel_hi:[0,1,1] neg_lo:[1,0,0]
  v_cvt_pk_bf16_f32 v98, v48, -v49
  v_cvt_pk_bf16_f32 v99, v80, -v81
  v_pk_mul_f32 v[52:53], v[48:49], v[36:37] op_sel:[0,0] op_sel_hi:[1,0]
  v_pk_mul_f32 v[84:85], v[80:81], v[68:69] op_sel:[0,0] op_sel_hi:[1,0]
  v_pk_fma_f32 v[50:51], v[48:49], v[36:37], v[52:53] op_sel:[1,1,0] op_sel_hi:[0,1,1] neg_lo:[1,0,0]
  s_cbranch_scc1 B_nr4
  s_lshl_b32 s11, s3, 10
  s_add_u32 m0, s11, s15
  s_mul_i32 s11, s3, 81920
  s_add_u32 s11, s11, s69
  buffer_load_dwordx4 v31, s[44:47], s11 offen lds
  s_add_u32 s3, s3, 1
  s_and_b32 s3, s3, 7
B_nr4:
  s_cmp_lg_u32 s71, 0
  v_pk_fma_f32 v[82:83], v[80:81], v[68:69], v[84:85] op_sel:[1,1,0] op_sel_hi:[0,1,1] neg_lo:[1,0,0]
  v_cvt_pk_bf16_f32 v100, v50, -v51
  v_cvt_pk_bf16_f32 v101, v82, -v83
  v_pk_mul_f32 v[52:53], v[50:51], v[36:37] op_sel:[0,0] op_sel_hi:[1,0]
  v_pk_mul_f32 v[84:85], v[82:83], v[68:69] op_sel:[0,0] op_sel_hi:[1,0]
  v_pk_fma_f32 v[48:49], v[50:51], v[36:37], v[52:53] op_sel:[1,1,0] op_sel_hi:[0,1,1] neg_lo:[1,0,0]
  v_pk_fma_f32 v[80:81], v[82:83], v[68:69], v[84:85] op_sel:[1,1,0] op_sel_hi:[0,1,1] neg_lo:[1,0,0]
  v_cvt_pk_bf16_f32 v102, v48, -v49
  v_cvt_pk_bf16_f32 v103, v80, -v81
  ds_write_b64 v24, v[96:97] offset:0
  ds_write_b64 v24, v[98:99] offset:528
  ds_write_b64 v24, v[100:101] offset:1056
  ds_write_b64 v24, v[102:103] offset:1584
  v_pk_mul_f32 v[52:53], v[48:49], v[36:37] op_sel:[0,0] op_sel_hi:[1,0]
  v_pk_mul_f32 v[84:85], v[80:81], v[68:69] op_sel:[0,0] op_sel_hi:[1,0]
  v_pk_fma_f32 v[50:51], v[48:49], v[36:37], v[52:53] op_sel:[1,1,0] op_sel_hi:[0,1,1] neg_lo:[1,0,0]
  v_pk_fma_f32 v[82:83], v[80:81], v[68:69], v[84:85] op_sel:[1,1,0] op_sel_hi:[0,1,1] neg_lo:[1,0,0]
  v_cvt_pk_bf16_f32 v96, v50, -v51
  v_cvt_pk_bf16_f32 v97, v82, -v83
  v_pk_mul_f32 v[52:53], v[50:51], v[36:37] op_sel:[0,0] op_sel_hi:[1,0]
  v_pk_mul_f32 v[84:85], v[82:83], v[68:69] op_sel:[0,0] op_sel_hi:[1,0]
  v_pk_fma_f32 v[48:49], v[50:51], v[36:37], v[52:53] op_sel:[1,1,0] op_sel_hi:[0,1,1] neg_lo:[1,0,0]
  v_pk_fma_f32 v[80:81], v[82:83], v[68:69], v[84:85] op_sel:[1,1,0] op_sel_hi:[0,1,1] neg_lo:[1,0,0]
  v_cvt_pk_bf16_f32 v98, v48, -v49
  v_cvt_pk_bf16_f32 v99, v80, -v81
  v_pk_mul_f32 v[52:53], v[48:49], v[36:37] op_sel:[0,0] op_sel_hi:[1,0]
  v_pk_mul_f32 v[84:85], v[80:81], v[68:69] op_sel:[0,0] op_sel_hi:[1,0]
  v_pk_fma_f32 v[50:51], v[48:49], v[36:37], v[52:53] op_sel:[1,1,0] op_sel_hi:[0,1,1] neg_lo:[1,0,0]
  v_pk_fma_f32 v[82:83], v[80:81], v[68:69], v[84:85] op_sel:[1,1,0] op_sel_hi:[0,1,1] neg_lo:[1,0,0]
  v_cvt_pk_bf16_f32 v100, v50, -v51
  v_cvt_pk_bf16_f32 v101, v82, -v83
  v_pk_mul_f32 v[52:53], v[50:51], v[36:37] op_sel:[0,0] op_sel_hi:[1,0]
  v_pk_mul_f32 v[84:85], v[82:83], v[68:69] op_sel:[0,0] op_sel_hi:[1,0]
  v_pk_fma_f32 v[48:49], v[50:51], v[36:37], v[52:53] op_sel:[1,1,0] op_sel_hi:[0,1,1] neg_lo:[1,0,0]
  v_pk_fma_f32 v[80:81], v[82:83], v[68:69], v[84:85] op_sel:[1,1,0] op_sel_hi:[0,1,1] neg_lo:[1,0,0]
  v_cvt_pk_bf16_f32 v102, v48, -v49
  v_cvt_pk_bf16_f32 v103, v80, -v81
  ds_write_b64 v24, v[96:97] offset:2112
  ds_write_b64 v24, v[98:99] offset:2640
  ds_write_b64 v24, v[100:101] offset:3168
  ds_write_b64 v24, v[102:103] offset:3696
  v_pk_mul_f32 v[52:53], v[36:37], v[36:37] op_sel:[0,0] op_sel_hi:[1,0]
  v_pk_mul_f32 v[84:85], v[68:69], v[68:69] op_sel:[0,0] op_sel_hi:[1,0]
  v_pk_fma_f32 v[42:43], v[36:37], v[36:37], v[52:53] op_sel:[1,1,0] op_sel_hi:[0,1,1] neg_lo:[1,0,0]
  v_pk_fma_f32 v[74:75], v[68:69], v[68:69], v[84:85] op_sel:[1,1,0] op_sel_hi:[0,1,1] neg_lo:[1,0,0]
  v_pk_mul_f32 v[52:53], v[42:43], v[42:43] op_sel:[0,0] op_sel_hi:[1,0]
  v_pk_mul_f32 v[84:85], v[74:75], v[74:75] op_sel:[0,0] op_sel_hi:[1,0]
  v_pk_fma_f32 v[44:45], v[42:43], v[42:43], v[52:53] op_sel:[1,1,0] op_sel_hi:[0,1,1] neg_lo:[1,0,0]
  v_pk_fma_f32 v[76:77], v[74:75], v[74:75], v[84:85] op_sel:[1,1,0] op_sel_hi:[0,1,1] neg_lo:[1,0,0]
  v_pk_mul_f32 v[52:53], v[44:45], v[42:43] op_sel:[0,0] op_sel_hi:[1,0]
  v_pk_mul_f32 v[84:85], v[76:77], v[74:75] op_sel:[0,0] op_sel_hi:[1,0]
  v_pk_fma_f32 v[46:47], v[44:45], v[42:43], v[52:53] op_sel:[1,1,0] op_sel_hi:[0,1,1] neg_lo:[1,0,0]
  v_pk_fma_f32 v[78:79], v[76:77], v[74:75], v[84:85] op_sel:[1,1,0] op_sel_hi:[0,1,1] neg_lo:[1,0,0]
  v_pk_mul_f32 v[52:53], v[34:35], v[40:41] op_sel:[0,0] op_sel_hi:[1,0]
  s_cbranch_scc1 B_nr5
  s_lshl_b32 s11, s3, 10
  s_add_u32 m0, s11, s15
  s_mul_i32 s11, s3, 81920
  s_add_u32 s11, s11, s69
  buffer_load_dwordx4 v31, s[44:47], s11 offen lds
  s_add_u32 s3, s3, 1
  s_and_b32 s3, s3, 7
B_nr5:
  s_cmp_lg_u32 s71, 0
  v_pk_mul_f32 v[84:85], v[66:67], v[72:73] op_sel:[0,0] op_sel_hi:[1,0]
  v_pk_fma_f32 v[54:55], v[34:35], v[40:41], v[52:53] op_sel:[1,1,0] op_sel_hi:[0,1,1] neg_lo:[1,0,0]
  v_pk_fma_f32 v[86:87], v[66:67], v[72:73], v[84:85] op_sel:[1,1,0] op_sel_hi:[0,1,1] neg_lo:[1,0,0]
  v_cvt_pk_bf16_f32 v96, v54, -v55
  v_cvt_pk_bf16_f32 v97, v86, -v87
  v_pk_mul_f32 v[52:53], v[54:55], v[42:43] op_sel:[0,0] op_sel_hi:[1,0]
  v_pk_mul_f32 v[84:85], v[86:87], v[74:75] op_sel:[0,0] op_sel_hi:[1,0]
  v_pk_fma_f32 v[50:51], v[54:55], v[42:43], v[52:53] op_sel:[1,1,0] op_sel_hi:[0,1,1] neg_lo:[1,0,0]
  v_pk_fma_f32 v[82:83], v[86:87], v[74:75], v[84:85] op_sel:[1,1,0] op_sel_hi:[0,1,1] neg_lo:[1,0,0]
  v_cvt_pk_bf16_f32 v98, v50, -v51
  v_cvt_pk_bf16_f32 v99, v82, -v83
  v_pk_mul_f32 v[52:53], v[54:55], v[44:45] op_sel:[0,0] op_sel_hi:[1,0]
  v_pk_mul_f32 v[84:85], v[86:87], v[76:77] op_sel:[0,0] op_sel_hi:[1,0]
  v_pk_fma_f32 v[48:49], v[54:55], v[44:45], v[52:53] op_sel:[1,1,0] op_sel_hi:[0,1,1] neg_lo:[1,0,0]
  v_pk_fma_f32 v[80:81], v[86:87], v[76:77], v[84:85] op_sel:[1,1,0] op_sel_hi:[0,1,1] neg_lo:[1,0,0]
  v_cvt_pk_bf16_f32 v100, v48, -v49
  v_cvt_pk_bf16_f32 v101, v80, -v81
  v_pk_mul_f32 v[52:53], v[54:55], v[46:47] op_sel:[0,0] op_sel_hi:[1,0]
  v_pk_mul_f32 v[84:85], v[86:87], v[78:79] op_sel:[0,0] op_sel_hi:[1,0]
  v_pk_fma_f32 v[50:51], v[54:55], v[46:47], v[52:53] op_sel:[1,1,0] op_sel_hi:[0,1,1] neg_lo:[1,0,0]
  v_pk_fma_f32 v[82:83], v[86:87], v[78:79], v[84:85] op_sel:[1,1,0] op_sel_hi:[0,1,1] neg_lo:[1,0,0]
  v_cvt_pk_bf16_f32 v102, v50, -v51
  v_cvt_pk_bf16_f32 v103, v82, -v83
  ds_write_b64 v24, v[96:97] offset:4224
  ds_write_b64 v24, v[98:99] offset:4752
  ds_write_b64 v24, v[100:101] offset:5280
  ds_write_b64 v24, v[102:103] offset:5808
  v_pk_mul_f32 v[52:53], v[54:55], v[38:39] op_sel:[0,0] op_sel_hi:[1,0]
  v_pk_mul_f32 v[84:85], v[86:87], v[70:71] op_sel:[0,0] op_sel_hi:[1,0]
  v_pk_fma_f32 v[48:49], v[54:55], v[38:39], v[52:53] op_sel:[1,1,0] op_sel_hi:[0,1,1] neg_lo:[1,0,0]
  v_pk_fma_f32 v[80:81], v[86:87], v[70:71], v[84:85] op_sel:[1,1,0] op_sel_hi:[0,1,1] neg_lo:[1,0,0]
  v_cvt_pk_bf16_f32 v96, v48, -v49
  v_cvt_pk_bf16_f32 v97, v80, -v81
  v_pk_mul_f32 v[52:53], v[54:55], v[40:41] op_sel:[0,0] op_sel_hi:[1,0]
  v_pk_mul_f32 v[84:85], v[86:87], v[72:73] op_sel:[0,0] op_sel_hi:[1,0]
  v_pk_fma_f32 v[56:57], v[54:55], v[40:41], v[52:53] op_sel:[1,1,0] op_sel_hi:[0,1,1] neg_lo:[1,0,0]
  v_pk_fma_f32 v[88:89], v[86:87], v[72:73], v[84:85] op_sel:[1,1,0] op_sel_hi:[0,1,1] neg_lo:[1,0,0]
  v_cvt_pk_bf16_f32 v98, v56, -v57
  v_cvt_pk_bf16_f32 v99, v88, -v89
  v_pk_mul_f32 v[52:53], v[56:57], v[44:45] op_sel:[0,0] op_sel_hi:[1,0]
  v_pk_mul_f32 v[84:85], v[88:89], v[76:77] op_sel:[0,0] op_sel_hi:[1,0]
  v_pk_fma_f32 v[50:51], v[56:57], v[44:45], v[52:53] op_sel:[1,1,0] op_sel_hi:[0,1,1] neg_lo:[1,0,0]
  v_pk_fma_f32 v[82:83], v[88:89], v[76:77], v[84:85] op_sel:[1,1,0] op_sel_hi:[0,1,1] neg_lo:[1,0,0]
  v_cvt_pk_bf16_f32 v100, v50, -v51
  v_cvt_pk_bf16_f32 v101, v82, -v83
  v_pk_mul_f32 v[52:53], v[56:57], v[38:39] op_sel:[0,0] op_sel_hi:[1,0]
  v_pk_mul_f32 v[84:85], v[88:89], v[70:71] op_sel:[0,0] op_sel_hi:[1,0]
  v_pk_fma_f32 v[48:49], v[56:57], v[38:39], v[52:53] op_sel:[1,1,0] op_sel_hi:[0,1,1] neg_lo:[1,0,0]
  v_pk_fma_f32 v[80:81], v[88:89], v[70:71], v[84:85] op_sel:[1,1,0] op_sel_hi:[0,1,1] neg_lo:[1,0,0]
  v_cvt_pk_bf16_f32 v102, v48, -v49
  v_cvt_pk_bf16_f32 v103, v80, -v81
  s_cbranch_scc1 B_nr6
  s_lshl_b32 s11, s3, 10
  s_add_u32 m0, s11, s15
  s_mul_i32 s11, s3, 81920
  s_add_u32 s11, s11, s69
  buffer_load_dwordx4 v31, s[44:47], s11 offen lds
  s_add_u32 s3, s3, 1
  s_and_b32 s3, s3, 7
B_nr6:
  s_cmp_lg_u32 s71, 0
  ds_write_b64 v24, v[96:97] offset:6336
  ds_write_b64 v24, v[98:99] offset:6864
  ds_write_b64 v24, v[100:101] offset:7392
  ds_write_b64 v24, v[102:103] offset:7920
  v_pk_mul_f32 v[52:53], v[56:57], v[40:41] op_sel:[0,0] op_sel_hi:[1,0]
  v_pk_mul_f32 v[84:85], v[88:89], v[72:73] op_sel:[0,0] op_sel_hi:[1,0]
  v_pk_fma_f32 v[54:55], v[56:57], v[40:41], v[52:53] op_sel:[1,1,0] op_sel_hi:[0,1,1] neg_lo:[1,0,0]
  v_pk_fma_f32 v[86:87], v[88:89], v[72:73], v[84:85] op_sel:[1,1,0] op_sel_hi:[0,1,1] neg_lo:[1,0,0]
  v_cvt_pk_bf16_f32 v96, v54, -v55
  v_cvt_pk_bf16_f32 v97, v86, -v87
  v_pk_mul_f32 v[52:53], v[54:55], v[44:45] op_sel:[0,0] op_sel_hi:[1,0]
  v_pk_mul_f32 v[84:85], v[86:87], v[76:77] op_sel:[0,0] op_sel_hi:[1,0]
  v_pk_fma_f32 v[50:51], v[54:55], v[44:45], v[52:53] op_sel:[1,1,0] op_sel_hi:[0,1,1] neg_lo:[1,0,0]
  v_pk_fma_f32 v[82:83], v[86:87], v[76:77], v[84:85] op_sel:[1,1,0] op_sel_hi:[0,1,1] neg_lo:[1,0,0]
  v_cvt_pk_bf16_f32 v98, v50, -v51
  v_cvt_pk_bf16_f32 v99, v82, -v83
  v_pk_mul_f32 v[52:53], v[54:55], v[38:39] op_sel:[0,0] op_sel_hi:[1,0]
  v_pk_mul_f32 v[84:85], v[86:87], v[70:71] op_sel:[0,0] op_sel_hi:[1,0]
  v_pk_fma_f32 v[48:49], v[54:55], v[38:39], v[52:53] op_sel:[1,1,0] op_sel_hi:[0,1,1] neg_lo:[1,0,0]
  v_pk_fma_f32 v[80:81], v[86:87], v[70:71], v[84:85] op_sel:[1,1,0] op_sel_hi:[0,1,1] neg_lo:[1,0,0]
  v_cvt_pk_bf16_f32 v100, v48, -v49
  v_cvt_pk_bf16_f32 v101, v80, -v81
  v_pk_mul_f32 v[52:53], v[54:55], v[40:41] op_sel:[0,0] op_sel_hi:[1,0]
  v_pk_mul_f32 v[84:85], v[86:87], v[72:73] op_sel:[0,0] op_sel_hi:[1,0]
  v_pk_fma_f32 v[56:57], v[54:55], v[40:41], v[52:53] op_sel:[1,1,0] op_sel_hi:[0,1,1] neg_lo:[1,0,0]
  v_pk_fma_f32 v[88:89], v[86:87], v[72:73], v[84:85] op_sel:[1,1,0] op_sel_hi:[0,1,1] neg_lo:[1,0,0]
  v_cvt_pk_bf16_f32 v102, v56, -v57
  v_cvt_pk_bf16_f32 v103, v88, -v89
  ds_write_b64 v24, v[96:97] offset:33792
  ds_write_b64 v24, v[98:99] offset:34320
  ds_write_b64 v24, v[100:101] offset:34848
  ds_write_b64 v24, v[102:103] offset:35376
  v_pk_mul_f32 v[52:53], v[56:57], v[38:39] op_sel:[0,0] op_sel_hi:[1,0]
  v_pk_mul_f32 v[84:85], v[88:89], v[70:71] op_sel:[0,0] op_sel_hi:[1,0]
  v_pk_fma_f32 v[50:51], v[56:57], v[38:39], v[52:53] op_sel:[1,1,0] op_sel_hi:[0,1,1] neg_lo:[1,0,0]
  v_pk_fma_f32 v[82:83], v[88:89], v[70:71], v[84:85] op_sel:[1,1,0] op_sel_hi:[0,1,1] neg_lo:[1,0,0]
  v_cvt_pk_bf16_f32 v96, v50, -v51
  v_cvt_pk_bf16_f32 v97, v82, -v83
  v_pk_mul_f32 v[52:53], v[56:57], v[40:41] op_sel:[0,0] op_sel_hi:[1,0]
  v_pk_mul_f32 v[84:85], v[88:89], v[72:73] op_sel:[0,0] op_sel_hi:[1,0]
  v_pk_fma_f32 v[54:55], v[56:57], v[40:41], v[52:53] op_sel:[1,1,0] op_sel_hi:[0,1,1] neg_lo:[1,0,0]
  v_pk_fma_f32 v[86:87], v[88:89], v[72:73], v[84:85] op_sel:[1,1,0] op_sel_hi:[0,1,1] neg_lo:[1,0,0]
  v_cvt_pk_bf16_f32 v98, v54, -v55
  v_cvt_pk_bf16_f32 v99, v86, -v87
  v_pk_mul_f32 v[52:53], v[54:55], v[38:39] op_sel:[0,0] op_sel_hi:[1,0]
  v_pk_mul_f32 v[84:85], v[86:87], v[70:71] op_sel:[0,0] op_sel_hi:[1,0]
  v_pk_fma_f32 v[50:51], v[54:55], v[38:39], v[52:53] op_sel:[1,1,0] op_sel_hi:[0,1,1] neg_lo:[1,0,0]
  v_pk_fma_f32 v[82:83], v[86:87], v[70:71], v[84:85] op_sel:[1,1,0] op_sel_hi:[0,1,1] neg_lo:[1,0,0]
  v_cvt_pk_bf16_f32 v100, v50, -v51
  v_cvt_pk_bf16_f32 v101, v82, -v83
  v_pk_mul_f32 v[52:53], v[54:55], v[40:41] op_sel:[0,0] op_sel_hi:[1,0]
  v_pk_mul_f32 v[84:85], v[86:87], v[72:73] op_sel:[0,0] op_sel_hi:[1,0]
  v_pk_fma_f32 v[56:57], v[54:55], v[40:41], v[52:53] op_sel:[1,1,0] op_sel_hi:[0,1,1] neg_lo:[1,0,0]
  s_cbranch_scc1 B_nr7
  s_lshl_b32 s11, s3, 10
  s_add_u32 m0, s11, s15
  s_mul_i32 s11, s3, 81920
  s_add_u32 s11, s11, s69
  buffer_load_dwordx4 v31, s[44:47], s11 offen lds
  s_add_u32 s3, s3, 1
  s_and_b32 s3, s3, 7
B_nr7:
  s_cmp_lg_u32 s71, 0
  v_pk_fma_f32 v[88:89], v[86:87], v[72:73], v[84:85] op_sel:[1,1,0] op_sel_hi:[0,1,1] neg_lo:[1,0,0]
  v_cvt_pk_bf16_f32 v102, v56, -v57
  v_cvt_pk_bf16_f32 v103, v88, -v89
  ds_write_b64 v24, v[96:97] offset:35904
  ds_write_b64 v24, v[98:99] offset:36432
  ds_write_b64 v24, v[100:101] offset:36960
  ds_write_b64 v24, v[102:103] offset:37488
  v_pk_mul_f32 v[52:53], v[56:57], v[38:39] op_sel:[0,0] op_sel_hi:[1,0]
  v_pk_mul_f32 v[84:85], v[88:89], v[70:71] op_sel:[0,0] op_sel_hi:[1,0]
  v_pk_fma_f32 v[50:51], v[56:57], v[38:39], v[52:53] op_sel:[1,1,0] op_sel_hi:[0,1,1] neg_lo:[1,0,0]
  v_pk_fma_f32 v[82:83], v[88:89], v[70:71], v[84:85] op_sel:[1,1,0] op_sel_hi:[0,1,1] neg_lo:[1,0,0]
  v_cvt_pk_bf16_f32 v96, v50, -v51
  v_cvt_pk_bf16_f32 v97, v82, -v83
  v_pk_mul_f32 v[52:53], v[56:57], v[40:41] op_sel:[0,0] op_sel_hi:[1,0]
  v_pk_mul_f32 v[84:85], v[88:89], v[72:73] op_sel:[0,0] op_sel_hi:[1,0]
  v_pk_fma_f32 v[54:55], v[56:57], v[40:41], v[52:53] op_sel:[1,1,0] op_sel_hi:[0,1,1] neg_lo:[1,0,0]
  v_pk_fma_f32 v[86:87], v[88:89], v[72:73], v[84:85] op_sel:[1,1,0] op_sel_hi:[0,1,1] neg_lo:[1,0,0]
  v_cvt_pk_bf16_f32 v98, v54, -v55
  v_cvt_pk_bf16_f32 v99, v86, -v87
  v_pk_mul_f32 v[52:53], v[54:55], v[38:39] op_sel:[0,0] op_sel_hi:[1,0]
  v_pk_mul_f32 v[84:85], v[86:87], v[70:71] op_sel:[0,0] op_sel_hi:[1,0]
  v_pk_fma_f32 v[50:51], v[54:55], v[38:39], v[52:53] op_sel:[1,1,0] op_sel_hi:[0,1,1] neg_lo:[1,0,0]
  v_pk_fma_f32 v[82:83], v[86:87], v[70:71], v[84:85] op_sel:[1,1,0] op_sel_hi:[0,1,1] neg_lo:[1,0,0]
  v_cvt_pk_bf16_f32 v100, v50, -v51
  v_cvt_pk_bf16_f32 v101, v82, -v83
  ds_write_b64 v24, v[96:97] offset:38016
  ds_write_b64 v24, v[98:99] offset:38544
  ds_write_b64 v24, v[100:101] offset:39072
  ds_read_b128 v[136:139], v2 offset:0
  ds_read_b128 v[140:143], v2 offset:32
  ds_read_b128 v[144:147], v2 offset:64
  ds_read_b128 v[148:151], v2 offset:96
  ds_read_b128 v[152:155], v2 offset:128
  ds_read_b128 v[156:159], v2 offset:160
  ds_read_b128 v[160:163], v2 offset:192
  ds_read_b128 v[164:167], v2 offset:224
  ds_read_b128 v[168:171], v2 offset:256
  ds_read_b128 v[172:175], v2 offset:288
  ds_read_b128 v[176:179], v2 offset:320
  ds_read_b128 v[180:183], v2 offset:352
  ds_read_b128 v[184:187], v2 offset:384
  ds_read_b128 v[188:191], v2 offset:416
  ds_read_b128 v[192:195], v2 offset:448
  ds_read_b128 v[196:199], v2 offset:480
  s_waitcnt lgkmcnt(15)
  v_mfma_f32_32x32x16_bf16 v[104:119], v[136:139], a[64:67], 0
  s_waitcnt lgkmcnt(14)
  v_mfma_f32_32x32x16_bf16 v[104:119], v[140:143], a[68:71], v[104:119]
  s_waitcnt lgkmcnt(13)
  v_mfma_f32_32x32x16_bf16 v[104:119], v[144:147], a[72:75], v[104:119]
  s_waitcnt lgkmcnt(12)
  v_mfma_f32_32x32x16_bf16 v[104:119], v[148:151], a[76:79], v[104:119]
  s_waitcnt lgkmcnt(11)
  v_mfma_f32_32x32x16_bf16 v[104:119], v[152:155], a[80:83], v[104:119]
  s_waitcnt lgkmcnt(10)
  v_mfma_f32_32x32x16_bf16 v[104:119], v[156:159], a[84:87], v[104:119]
  s_waitcnt lgkmcnt(9)
  v_mfma_f32_32x32x16_bf16 v[104:119], v[160:163], a[88:91], v[104:119]
  s_waitcnt lgkmcnt(8)
  v_mfma_f32_32x32x16_bf16 v[104:119], v[164:167], a[92:95], v[104:119]
  s_waitcnt lgkmcnt(7)
  v_mfma_f32_32x32x16_bf16 v[104:119], v[168:171], a[96:99], v[104:119]
  s_waitcnt lgkmcnt(6)
  v_mfma_f32_32x32x16_bf16 v[104:119], v[172:175], a[100:103], v[104:119]
  s_waitcnt lgkmcnt(5)
  v_mfma_f32_32x32x16_bf16 v[104:119], v[176:179], a[104:107], v[104:119]
  s_waitcnt lgkmcnt(4)
  v_mfma_f32_32x32x16_bf16 v[104:119], v[180:183], a[108:111], v[104:119]
  s_waitcnt lgkmcnt(3)
  v_mfma_f32_32x32x16_bf16 v[104:119], v[184:187], a[112:115], v[104:119]
  s_waitcnt lgkmcnt(2)
  v_mfma_f32_32x32x16_bf16 v[104:119], v[188:191], a[116:119], v[104:119]
  s_waitcnt lgkmcnt(1)
  v_mfma_f32_32x32x16_bf16 v[104:119], v[192:195], a[120:123], v[104:119]
  s_waitcnt lgkmcnt(0)
  v_mfma_f32_32x32x16_bf16 v[104:119], v[196:199], a[124:127], v[104:119]
  v_mov_b32 v16, v20
  v_mov_b32 v17, v21
  v_mov_b32 v18, v22
  v_mov_b32 v19, v23
  s_mov_b32 s56, s57
  s_mov_b32 s58, s59
  s_nop 5
  v_fmac_f32 v104, v26, v27
  v_cvt_pk_bf16_f32 v136, v111, v110
  v_cvt_pk_bf16_f32 v137, v109, v108
  v_cvt_pk_bf16_f32 v138, v107, v106
  v_cvt_pk_bf16_f32 v139, v105, v104
  v_cndmask_b32 v48, v113, v114, s[64:65]
  v_cndmask_b32 v49, v113, v112, s[62:63]
  v_cndmask_b32 v50, v112, v113, s[64:65]
  v_cvt_pk_bf16_f32 v140, v48, v48
  v_cvt_pk_bf16_f32 v141, v113, v49
  v_cvt_pk_bf16_f32 v142, v50, v112
  v_cvt_pk_bf16_f32 v143, v112, v112
  v_cndmask_b32 v48, v116, v117, s[64:65]
  v_cndmask_b32 v49, v116, v115, s[62:63]
  v_cndmask_b32 v50, v115, v116, s[64:65]
  v_cvt_pk_bf16_f32 v144, v48, v48
  v_cvt_pk_bf16_f32 v145, v116, v49
  v_cvt_pk_bf16_f32 v146, v50, v115
  v_cvt_pk_bf16_f32 v147, v115, v115
  v_cndmask_b32 v48, v119, v118, s[66:67]
  v_cvt_pk_bf16_f32 v148, v119, v119
  v_cvt_pk_bf16_f32 v149, v119, v48
  v_cvt_pk_bf16_f32 v150, v118, v118
  v_mov_b32 v151, v150
  s_mov_b64 exec, 0x1ffff
  ds_write_b128 v12, v[200:203]
  s_mov_b64 exec, -1
  ds_write_b128 v4, v[136:139] offset:0
  ds_write_b32 v4, v136 offset:4220
  ds_write_b32 v4, v137 offset:4224
  ds_write_b32 v4, v138 offset:4228
  ds_write_b32 v4, v139 offset:4232
  ds_write_b128 v5, v[140:143] offset:1024
  ds_write_b32 v5, v140 offset:5244
  ds_write_b32 v5, v141 offset:5248
  ds_write_b32 v5, v142 offset:5252
  ds_write_b32 v5, v143 offset:5256
  ds_write_b128 v5, v[144:147] offset:512
  ds_write_b32 v5, v144 offset:4732
  ds_write_b32 v5, v145 offset:4736
  ds_write_b32 v5, v146 offset:4740
  ds_write_b32 v5, v147 offset:4744
  ds_write_b128 v5, v[148:151] offset:0
  ds_write_b32 v5, v148 offset:4220
  ds_write_b32 v5, v149 offset:4224
  ds_write_b32 v5, v150 offset:4228
  ds_write_b32 v5, v151 offset:4232
  v_add_u32 v4, 33792, v4
  v_add_u32 v5, 33792, v5
  v_add_u32 v12, 33792, v12
  s_add_u32 s60, s60, 1
  s_cmp_le_u32 s60, s71
  s_cbranch_scc1 B_kgen_ch
  s_mov_b32 s64, s42
  s_mov_b32 s65, s43
  s_mov_b32 s66, 268435456
  s_mov_b32 s67, 0x20000
  s_lshl_b32 s53, s5, 2
  s_add_u32 s53, s53, s4
  s_mul_i32 s62, s53, 8448
  s_add_u32 s62, s62, 4194304
  s_lshl_b32 s63, s53, 6
  s_add_u32 s63, s63, 32768
  v_lshlrev_b32 v210, 4, v0
  s_cmp_eq_u32 s71, 0
  s_cbranch_scc1 B_main
  v_add_u32 v28, s68, v210
  ds_read_b128 v[136:139], v28 offset:0
  ds_read_b128 v[140:143], v28 offset:1024
  ds_read_b128 v[144:147], v28 offset:2048
  ds_read_b128 v[148:151], v28 offset:3072
  ds_read_b128 v[152:155], v28 offset:4096
  ds_read_b128 v[156:159], v28 offset:5120
  ds_read_b128 v[160:163], v28 offset:6144
  ds_read_b128 v[164:167], v28 offset:7168
  s_mov_b64 exec, 0xffff
  ds_read_b128 v[168:171], v28 offset:8192
  s_mov_b64 exec, -1
  s_waitcnt lgkmcnt(8)
  buffer_store_dwordx4 v[136:139], v210, s[64:67], s62 offen offset:0 sc1
  s_waitcnt lgkmcnt(7)
  buffer_store_dwordx4 v[140:143], v210, s[64:67], s62 offen offset:1024 sc1
  s_waitcnt lgkmcnt(6)
  buffer_store_dwordx4 v[144:147], v210, s[64:67], s62 offen offset:2048 sc1
  s_waitcnt lgkmcnt(5)
  buffer_store_dwordx4 v[148:151], v210, s[64:67], s62 offen offset:3072 sc1
  s_add_u32 s62, s62, 4096
  s_waitcnt lgkmcnt(4)
  buffer_store_dwordx4 v[152:155], v210, s[64:67], s62 offen offset:0 sc1
  s_waitcnt lgkmcnt(3)
  buffer_store_dwordx4 v[156:159], v210, s[64:67], s62 offen offset:1024 sc1
  s_waitcnt lgkmcnt(2)
  buffer_store_dwordx4 v[160:163], v210, s[64:67], s62 offen offset:2048 sc1
  s_waitcnt lgkmcnt(1)
  buffer_store_dwordx4 v[164:167], v210, s[64:67], s62 offen offset:3072 sc1
  s_mov_b64 exec, 0xffff
  s_add_u32 s62, s62, 4096
  s_waitcnt lgkmcnt(0)
  buffer_store_dwordx4 v[168:171], v210, s[64:67], s62 offen offset:0 sc1
  s_mov_b64 exec, -1
  s_add_u32 s62, s62, 25600
  ds_read_b128 v[136:139], v28 offset:33792
  ds_read_b128 v[140:143], v28 offset:34816
  ds_read_b128 v[144:147], v28 offset:35840
  ds_read_b128 v[148:151], v28 offset:36864
  ds_read_b128 v[152:155], v28 offset:37888
  ds_read_b128 v[156:159], v28 offset:38912
  ds_read_b128 v[160:163], v28 offset:39936
  ds_read_b128 v[164:167], v28 offset:40960
  s_mov_b64 exec, 0xffff
  ds_read_b128 v[168:171], v28 offset:41984
  s_mov_b64 exec, -1
  s_waitcnt lgkmcnt(8)
  buffer_store_dwordx4 v[136:139], v210, s[64:67], s62 offen offset:0 sc1
  s_waitcnt lgkmcnt(7)
  buffer_store_dwordx4 v[140:143], v210, s[64:67], s62 offen offset:1024 sc1
  s_waitcnt lgkmcnt(6)
  buffer_store_dwordx4 v[144:147], v210, s[64:67], s62 offen offset:2048 sc1
  s_waitcnt lgkmcnt(5)
  buffer_store_dwordx4 v[148:151], v210, s[64:67], s62 offen offset:3072 sc1
  s_add_u32 s62, s62, 4096
  s_waitcnt lgkmcnt(4)
  buffer_store_dwordx4 v[152:155], v210, s[64:67], s62 offen offset:0 sc1
  s_waitcnt lgkmcnt(3)
  buffer_store_dwordx4 v[156:159], v210, s[64:67], s62 offen offset:1024 sc1
  s_waitcnt lgkmcnt(2)
  buffer_store_dwordx4 v[160:163], v210, s[64:67], s62 offen offset:2048 sc1
  s_waitcnt lgkmcnt(1)
  buffer_store_dwordx4 v[164:167], v210, s[64:67], s62 offen offset:3072 sc1
  s_mov_b64 exec, 0xffff
  s_add_u32 s62, s62, 4096
  s_waitcnt lgkmcnt(0)
  buffer_store_dwordx4 v[168:171], v210, s[64:67], s62 offen offset:0 sc1
  s_mov_b64 exec, -1
  s_add_u32 s62, s62, 25600
  v_mov_b32 v28, s14
  v_mov_b32 v29, 0
  s_waitcnt vmcnt(0)
  s_mov_b64 exec, 1
  buffer_store_dword v28, v29, s[64:67], s63 offen sc1
  buffer_store_dword v28, v29, s[64:67], s63 offen offset:256 sc1
  s_mov_b64 exec, -1
  s_waitcnt lgkmcnt(0)
  s_barrier
  s_branch L_join
B_main:
  s_lshl_b32 s53, s4, 13
  v_add_u32 v8, s53, v8
  s_lshl_b32 s53, s4, 10
  s_add_u32 s53, s53, 100368
  v_add_u32 v9, s53, v9
  s_mul_i32 s53, s4, 9376
  s_add_u32 s53, s53, 100368
  v_add_u32 v7, s53, v7
  v_lshl_add_u32 v28, v0, 4, s53
  v_add_u32 v6, s68, v6
  s_lshl_b32 s53, s4, 6
  s_add_u32 s53, s53, s68
  v_add_u32 v10, s53, v10
  s_mov_b32 s60, 0
  s_waitcnt vmcnt(0) lgkmcnt(0)
  s_barrier
  s_cmp_lg_u32 s4, 0
  s_cbranch_scc1 B_arr
  v_mov_b32 v208, 1
  v_mov_b32 v209, 0
  s_mov_b64 exec, 1
  global_atomic_add v208, v209, v208, s[40:41] sc0
  s_mov_b64 exec, -1
B_arr:
  s_mov_b64 exec, 0xfffffff
  ds_write_b128 v28, v[200:203]
  ds_write_b128 v28, v[200:203] offset:4640
  s_mov_b64 exec, -1
  ds_read_b64_tr_b16 v[136:137], v8 offset:16
  ds_read_b64_tr_b16 v[138:139], v8 offset:0
  ds_read_b64_tr_b16 v[140:141], v8 offset:1040
  ds_read_b64_tr_b16 v[142:143], v8 offset:1024
  ds_read_b64_tr_b16 v[144:145], v8 offset:2064
  ds_read_b64_tr_b16 v[146:147], v8 offset:2048
  ds_read_b64_tr_b16 v[148:149], v8 offset:3088
  ds_read_b64_tr_b16 v[150:151], v8 offset:3072
  ds_read_b64_tr_b16 v[152:153], v8 offset:4112
  ds_read_b64_tr_b16 v[154:155], v8 offset:4096
  ds_read_b64_tr_b16 v[156:157], v8 offset:5136
  ds_read_b64_tr_b16 v[158:159], v8 offset:5120
  ds_read_b64_tr_b16 v[160:161], v8 offset:6160
  ds_read_b64_tr_b16 v[162:163], v8 offset:6144
  ds_read_b64_tr_b16 v[164:165], v8 offset:7184
  ds_read_b64_tr_b16 v[166:167], v8 offset:7168
  s_waitcnt lgkmcnt(15)
  ds_write_b64 v9, v[136:137] offset:0
  s_waitcnt lgkmcnt(15)
  ds_write_b64 v9, v[138:139] offset:4640
  s_waitcnt lgkmcnt(15)
  ds_write_b64 v9, v[140:141] offset:128
  s_waitcnt lgkmcnt(15)
  ds_write_b64 v9, v[142:143] offset:4768
  s_waitcnt lgkmcnt(15)
  ds_write_b64 v9, v[144:145] offset:256
  s_waitcnt lgkmcnt(15)
  ds_write_b64 v9, v[146:147] offset:4896
  s_waitcnt lgkmcnt(15)
  ds_write_b64 v9, v[148:149] offset:384
  s_waitcnt lgkmcnt(15)
  ds_write_b64 v9, v[150:151] offset:5024
  s_waitcnt lgkmcnt(15)
  ds_write_b64 v9, v[152:153] offset:512
  s_waitcnt lgkmcnt(15)
  ds_write_b64 v9, v[154:155] offset:5152
  s_waitcnt lgkmcnt(15)
  ds_write_b64 v9, v[156:157] offset:640
  s_waitcnt lgkmcnt(15)
  ds_write_b64 v9, v[158:159] offset:5280
  s_waitcnt lgkmcnt(15)
  ds_write_b64 v9, v[160:161] offset:768
  s_waitcnt lgkmcnt(15)
  ds_write_b64 v9, v[162:163] offset:5408
  s_waitcnt lgkmcnt(15)
  ds_write_b64 v9, v[164:165] offset:896
  s_waitcnt lgkmcnt(15)
  ds_write_b64 v9, v[166:167] offset:5536
  ds_read_b64_tr_b16 a[64:65], v8 offset:24
  ds_read_b64_tr_b16 a[66:67], v8 offset:8
  ds_read_b64_tr_b16 a[68:69], v8 offset:1048
  ds_read_b64_tr_b16 a[70:71], v8 offset:1032
  ds_read_b64_tr_b16 a[72:73], v8 offset:2072
  ds_read_b64_tr_b16 a[74:75], v8 offset:2056
  ds_read_b64_tr_b16 a[76:77], v8 offset:3096
  ds_read_b64_tr_b16 a[78:79], v8 offset:3080
  ds_read_b64_tr_b16 a[80:81], v8 offset:4120
  ds_read_b64_tr_b16 a[82:83], v8 offset:4104
  ds_read_b64_tr_b16 a[84:85], v8 offset:5144
  ds_read_b64_tr_b16 a[86:87], v8 offset:5128
  ds_read_b64_tr_b16 a[88:89], v8 offset:6168
  ds_read_b64_tr_b16 a[90:91], v8 offset:6152
  ds_read_b64_tr_b16 a[92:93], v8 offset:7192
  ds_read_b64_tr_b16 a[94:95], v8 offset:7176
  v_mov_b32 v104, 0
  v_mov_b32 v105, 0
  v_mov_b32 v106, 0
  v_mov_b32 v107, 0
  v_mov_b32 v108, 0
  v_mov_b32 v109, 0
  v_mov_b32 v110, 0
  v_mov_b32 v111, 0
  v_mov_b32 v112, 0
  v_mov_b32 v113, 0
  v_mov_b32 v114, 0
  v_mov_b32 v115, 0
  v_mov_b32 v116, 0
  v_mov_b32 v117, 0
  v_mov_b32 v118, 0
  v_mov_b32 v119, 0
  v_mov_b32 v120, 0
  v_mov_b32 v121, 0
  v_mov_b32 v122, 0
  v_mov_b32 v123, 0
  v_mov_b32 v124, 0
  v_mov_b32 v125, 0
  v_mov_b32 v126, 0
  v_mov_b32 v127, 0
  v_mov_b32 v128, 0
  v_mov_b32 v129, 0
  v_mov_b32 v130, 0
  v_mov_b32 v131, 0
  v_mov_b32 v132, 0
  v_mov_b32 v133, 0
  v_mov_b32 v134, 0
  v_mov_b32 v135, 0
  s_mov_b32 s15, 0
  v_mov_b32 v29, 0
  v_not_b32 v28, s14
  s_waitcnt lgkmcnt(0)
  s_barrier
B_round:
  v_mov_b32 v14, v6
  v_mov_b32 v15, v7
  ds_read_b64 v[136:137], v14 offset:3584
  ds_read_b64 v[138:139], v14 offset:3592
  ds_read_b128 v[168:171], v15 offset:0
  ds_read_b128 v[172:175], v15 offset:512
  ds_read_b128 v[176:179], v15 offset:1024
  ds_read_b128 v[180:183], v15 offset:1536
  ds_read_b128 v[184:187], v15 offset:2048
  ds_read_b128 v[188:191], v15 offset:2560
  ds_read_b128 v[192:195], v15 offset:3072
  ds_read_b128 v[196:199], v15 offset:3584
  ds_read_b64 v[140:141], v14 offset:3072
  ds_read_b64 v[142:143], v14 offset:3080
  ds_read_b64 v[144:145], v14 offset:2560
  ds_read_b64 v[146:147], v14 offset:2568
  ds_read_b64 v[148:149], v14 offset:2048
  ds_read_b64 v[150:151], v14 offset:2056
  ds_read_b64 v[152:153], v14 offset:1536
  ds_read_b64 v[154:155], v14 offset:1544
  ds_read_b64 v[156:157], v14 offset:1024
  ds_read_b64 v[158:159], v14 offset:1032
  ds_read_b64 v[160:161], v14 offset:512
  ds_read_b64 v[162:163], v14 offset:520
  ds_read_b64 v[164:165], v14 offset:0
  ds_read_b64 v[166:167], v14 offset:8
  s_mov_b32 s61, 0
B_conv:
  s_cmp_lg_u32 s15, 0
  s_cbranch_scc1 B_cf
  s_waitcnt vmcnt(0)
  v_readfirstlane_b32 s53, v28
  s_nop 0
  s_cmp_lg_u32 s53, s14
  s_cbranch_scc1 B_cf
  s_add_u32 m0, s68, 33792
  s_mov_b32 s15, 1
  buffer_load_dwordx4 v210, s[64:67], s62 offen offset:0 sc1 lds
  buffer_load_dwordx4 v210, s[64:67], s62 offen offset:1024 sc1 lds
  buffer_load_dwordx4 v210, s[64:67], s62 offen offset:2048 sc1 lds
  buffer_load_dwordx4 v210, s[64:67], s62 offen offset:3072 sc1 lds
  s_add_u32 s62, s62, 4096
  s_addk_i32 m0, 0x1000
  s_nop 0
  buffer_load_dwordx4 v210, s[64:67], s62 offen offset:0 sc1 lds
  buffer_load_dwordx4 v210, s[64:67], s62 offen offset:1024 sc1 lds
  buffer_load_dwordx4 v210, s[64:67], s62 offen offset:2048 sc1 lds
  buffer_load_dwordx4 v210, s[64:67], s62 offen offset:3072 sc1 lds
  s_add_u32 s62, s62, 4096
  s_addk_i32 m0, 0x1000
  s_mov_b64 exec, 0xffff
  buffer_load_dwordx4 v210, s[64:67], s62 offen offset:0 sc1 lds
  s_mov_b64 exec, -1
B_cf:
  v_subrev_u32 v14, 64, v14
  v_subrev_u32 v15, 64, v15
  s_waitcnt lgkmcnt(15)
  v_mfma_f32_16x16x32_bf16 v[104:107], v[136:139], v[168:171], v[104:107]
  v_mfma_f32_16x16x32_bf16 v[108:111], v[136:139], v[172:175], v[108:111]
  ds_read_b64 a[0:1], v14 offset:3584
  v_mfma_f32_16x16x32_bf16 v[112:115], v[136:139], v[176:179], v[112:115]
  ds_read_b64 a[2:3], v14 offset:3592
  v_mfma_f32_16x16x32_bf16 v[116:119], v[136:139], v[180:183], v[116:119]
  ds_read_b128 a[32:35], v15 offset:0
  v_mfma_f32_16x16x32_bf16 v[120:123], v[136:139], v[184:187], v[120:123]
  ds_read_b128 a[36:39], v15 offset:512
  v_mfma_f32_16x16x32_bf16 v[124:127], v[136:139], v[188:191], v[124:127]
  ds_read_b128 a[40:43], v15 offset:1024
  v_mfma_f32_16x16x32_bf16 v[128:131], v[136:139], v[192:195], v[128:131]
  ds_read_b128 a[44:47], v15 offset:1536
  s_waitcnt lgkmcnt(15)
  v_mfma_f32_16x16x32_bf16 v[132:135], v[136:139], v[196:199], v[132:135]
  ds_read_b128 a[48:51], v15 offset:2048
  v_mfma_f32_16x16x32_bf16 v[108:111], v[140:143], v[168:171], v[108:111]
  ds_read_b128 a[52:55], v15 offset:2560
  v_mfma_f32_16x16x32_bf16 v[112:115], v[140:143], v[172:175], v[112:115]
  ds_read_b128 a[56:59], v15 offset:3072
  v_mfma_f32_16x16x32_bf16 v[116:119], v[140:143], v[176:179], v[116:119]
  ds_read_b128 a[60:63], v15 offset:3584
  v_mfma_f32_16x16x32_bf16 v[120:123], v[140:143], v[180:183], v[120:123]
  ds_read_b64 a[4:5], v14 offset:3072
  v_mfma_f32_16x16x32_bf16 v[124:127], v[140:143], v[184:187], v[124:127]
  ds_read_b64 a[6:7], v14 offset:3080
  v_mfma_f32_16x16x32_bf16 v[128:131], v[140:143], v[188:191], v[128:131]
  ds_read_b64 a[8:9], v14 offset:2560
  v_mfma_f32_16x16x32_bf16 v[132:135], v[140:143], v[192:195], v[132:135]
  ds_read_b64 a[10:11], v14 offset:2568
  v_mfma_f32_16x16x32_bf16 v[112:115], v[144:147], v[168:171], v[112:115]
  ds_read_b64 a[12:13], v14 offset:2048
  v_mfma_f32_16x16x32_bf16 v[116:119], v[144:147], v[172:175], v[116:119]
  ds_read_b64 a[14:15], v14 offset:2056
  v_mfma_f32_16x16x32_bf16 v[120:123], v[144:147], v[176:179], v[120:123]
  ds_read_b64 a[16:17], v14 offset:1536
  v_mfma_f32_16x16x32_bf16 v[124:127], v[144:147], v[180:183], v[124:127]
  ds_read_b64 a[18:19], v14 offset:1544
  v_mfma_f32_16x16x32_bf16 v[128:131], v[144:147], v[184:187], v[128:131]
  ds_read_b64 a[20:21], v14 offset:1024
  v_mfma_f32_16x16x32_bf16 v[132:135], v[144:147], v[188:191], v[132:135]
  ds_read_b64 a[22:23], v14 offset:1032
  s_waitcnt lgkmcnt(15)
  v_mfma_f32_16x16x32_bf16 v[116:119], v[148:151], v[168:171], v[116:119]
  ds_read_b64 a[24:25], v14 offset:512
  v_mfma_f32_16x16x32_bf16 v[120:123], v[148:151], v[172:175], v[120:123]
  ds_read_b64 a[26:27], v14 offset:520
  v_mfma_f32_16x16x32_bf16 v[124:127], v[148:151], v[176:179], v[124:127]
  ds_read_b64 a[28:29], v14 offset:0
  v_mfma_f32_16x16x32_bf16 v[128:131], v[148:151], v[180:183], v[128:131]
  ds_read_b64 a[30:31], v14 offset:8
  v_mfma_f32_16x16x32_bf16 v[132:135], v[148:151], v[184:187], v[132:135]
  v_mfma_f32_16x16x32_bf16 v[120:123], v[152:155], v[168:171], v[120:123]
  v_mfma_f32_16x16x32_bf16 v[124:127], v[152:155], v[172:175], v[124:127]
  v_mfma_f32_16x16x32_bf16 v[128:131], v[152:155], v[176:179], v[128:131]
  v_mfma_f32_16x16x32_bf16 v[132:135], v[152:155], v[180:183], v[132:135]
  v_mfma_f32_16x16x32_bf16 v[124:127], v[156:159], v[168:171], v[124:127]
  buffer_load_dword v28, v29, s[64:67], s63 offen sc1
  v_mfma_f32_16x16x32_bf16 v[128:131], v[156:159], v[172:175], v[128:131]
  v_mfma_f32_16x16x32_bf16 v[132:135], v[156:159], v[176:179], v[132:135]
  v_mfma_f32_16x16x32_bf16 v[128:131], v[160:163], v[168:171], v[128:131]
  v_mfma_f32_16x16x32_bf16 v[132:135], v[160:163], v[172:175], v[132:135]
  v_mfma_f32_16x16x32_bf16 v[132:135], v[164:167], v[168:171], v[132:135]
  v_subrev_u32 v14, 64, v14
  v_subrev_u32 v15, 64, v15
  v_mfma_f32_16x16x32_bf16 v[104:107], a[0:3], a[32:35], v[104:107]
  v_mfma_f32_16x16x32_bf16 v[108:111], a[0:3], a[36:39], v[108:111]
  ds_read_b64 v[136:137], v14 offset:3584
  v_mfma_f32_16x16x32_bf16 v[112:115], a[0:3], a[40:43], v[112:115]
  ds_read_b64 v[138:139], v14 offset:3592
  s_waitcnt lgkmcnt(15)
  v_mfma_f32_16x16x32_bf16 v[116:119], a[0:3], a[44:47], v[116:119]
  ds_read_b128 v[168:171], v15 offset:0
  v_mfma_f32_16x16x32_bf16 v[120:123], a[0:3], a[48:51], v[120:123]
  ds_read_b128 v[172:175], v15 offset:512
  v_mfma_f32_16x16x32_bf16 v[124:127], a[0:3], a[52:55], v[124:127]
  ds_read_b128 v[176:179], v15 offset:1024
  v_mfma_f32_16x16x32_bf16 v[128:131], a[0:3], a[56:59], v[128:131]
  ds_read_b128 v[180:183], v15 offset:1536
  v_mfma_f32_16x16x32_bf16 v[132:135], a[0:3], a[60:63], v[132:135]
  ds_read_b128 v[184:187], v15 offset:2048
  s_waitcnt lgkmcnt(15)
  v_mfma_f32_16x16x32_bf16 v[108:111], a[4:7], a[32:35], v[108:111]
  ds_read_b128 v[188:191], v15 offset:2560
  v_mfma_f32_16x16x32_bf16 v[112:115], a[4:7], a[36:39], v[112:115]
  ds_read_b128 v[192:195], v15 offset:3072
  v_mfma_f32_16x16x32_bf16 v[116:119], a[4:7], a[40:43], v[116:119]
  ds_read_b128 v[196:199], v15 offset:3584
  v_mfma_f32_16x16x32_bf16 v[120:123], a[4:7], a[44:47], v[120:123]
  ds_read_b64 v[140:141], v14 offset:3072
  v_mfma_f32_16x16x32_bf16 v[124:127], a[4:7], a[48:51], v[124:127]
  ds_read_b64 v[142:143], v14 offset:3080
  v_mfma_f32_16x16x32_bf16 v[128:131], a[4:7], a[52:55], v[128:131]
  ds_read_b64 v[144:145], v14 offset:2560
  v_mfma_f32_16x16x32_bf16 v[132:135], a[4:7], a[56:59], v[132:135]
  ds_read_b64 v[146:147], v14 offset:2568
  v_mfma_f32_16x16x32_bf16 v[112:115], a[8:11], a[32:35], v[112:115]
  ds_read_b64 v[148:149], v14 offset:2048
  v_mfma_f32_16x16x32_bf16 v[116:119], a[8:11], a[36:39], v[116:119]
  ds_read_b64 v[150:151], v14 offset:2056
  v_mfma_f32_16x16x32_bf16 v[120:123], a[8:11], a[40:43], v[120:123]
  ds_read_b64 v[152:153], v14 offset:1536
  v_mfma_f32_16x16x32_bf16 v[124:127], a[8:11], a[44:47], v[124:127]
  ds_read_b64 v[154:155], v14 offset:1544
  v_mfma_f32_16x16x32_bf16 v[128:131], a[8:11], a[48:51], v[128:131]
  ds_read_b64 v[156:157], v14 offset:1024
  v_mfma_f32_16x16x32_bf16 v[132:135], a[8:11], a[52:55], v[132:135]
  ds_read_b64 v[158:159], v14 offset:1032
  v_mfma_f32_16x16x32_bf16 v[116:119], a[12:15], a[32:35], v[116:119]
  ds_read_b64 v[160:161], v14 offset:512
  v_mfma_f32_16x16x32_bf16 v[120:123], a[12:15], a[36:39], v[120:123]
  ds_read_b64 v[162:163], v14 offset:520
  v_mfma_f32_16x16x32_bf16 v[124:127], a[12:15], a[40:43], v[124:127]
  ds_read_b64 v[164:165], v14 offset:0
  v_mfma_f32_16x16x32_bf16 v[128:131], a[12:15], a[44:47], v[128:131]
  ds_read_b64 v[166:167], v14 offset:8
  v_mfma_f32_16x16x32_bf16 v[132:135], a[12:15], a[48:51], v[132:135]
  s_waitcnt lgkmcnt(15)
  v_mfma_f32_16x16x32_bf16 v[120:123], a[16:19], a[32:35], v[120:123]
  v_mfma_f32_16x16x32_bf16 v[124:127], a[16:19], a[36:39], v[124:127]
  v_mfma_f32_16x16x32_bf16 v[128:131], a[16:19], a[40:43], v[128:131]
  v_mfma_f32_16x16x32_bf16 v[132:135], a[16:19], a[44:47], v[132:135]
  v_mfma_f32_16x16x32_bf16 v[124:127], a[20:23], a[32:35], v[124:127]
  v_mfma_f32_16x16x32_bf16 v[128:131], a[20:23], a[36:39], v[128:131]
  v_mfma_f32_16x16x32_bf16 v[132:135], a[20:23], a[40:43], v[132:135]
  v_mfma_f32_16x16x32_bf16 v[128:131], a[24:27], a[32:35], v[128:131]
  v_mfma_f32_16x16x32_bf16 v[132:135], a[24:27], a[36:39], v[132:135]
  v_mfma_f32_16x16x32_bf16 v[132:135], a[28:31], a[32:35], v[132:135]
  s_add_u32 s61, s61, 1
  s_cmp_lt_u32 s61, 4
  s_cbranch_scc1 B_conv
  s_cmp_lg_u32 s60, 0
  s_cbranch_scc1 B_last
  s_waitcnt vmcnt(0)
  s_cmp_lg_u32 s15, 0
  s_cbranch_scc1 B_fk_done
  s_mov_b32 s61, 0
B_fk:
  v_readfirstlane_b32 s53, v28
  s_add_u32 s61, s61, 1
  s_cmp_eq_u32 s53, s14
  s_cbranch_scc1 B_fk_ok
  s_sleep 1
  buffer_load_dword v28, v29, s[64:67], s63 offen sc1
  s_waitcnt vmcnt(0)
  s_cmp_lt_u32 s61, 0x40000
  s_cbranch_scc1 B_fk
B_fk_ok:
  s_add_u32 m0, s68, 33792
  s_mov_b32 s15, 1
  buffer_load_dwordx4 v210, s[64:67], s62 offen offset:0 sc1 lds
  buffer_load_dwordx4 v210, s[64:67], s62 offen offset:1024 sc1 lds
  buffer_load_dwordx4 v210, s[64:67], s62 offen offset:2048 sc1 lds
  buffer_load_dwordx4 v210, s[64:67], s62 offen offset:3072 sc1 lds
  s_add_u32 s62, s62, 4096
  s_addk_i32 m0, 0x1000
  s_nop 0
  buffer_load_dwordx4 v210, s[64:67], s62 offen offset:0 sc1 lds
  buffer_load_dwordx4 v210, s[64:67], s62 offen offset:1024 sc1 lds
  buffer_load_dwordx4 v210, s[64:67], s62 offen offset:2048 sc1 lds
  buffer_load_dwordx4 v210, s[64:67], s62 offen offset:3072 sc1 lds
  s_add_u32 s62, s62, 4096
  s_addk_i32 m0, 0x1000
  s_mov_b64 exec, 0xffff
  buffer_load_dwordx4 v210, s[64:67], s62 offen offset:0 sc1 lds
  s_mov_b64 exec, -1
B_fk_done:
  s_waitcnt lgkmcnt(0)
  s_barrier
  ds_write_b64 v9, a[64:65] offset:0
  ds_write_b64 v9, a[66:67] offset:4640
  ds_write_b64 v9, a[68:69] offset:128
  ds_write_b64 v9, a[70:71] offset:4768
  v_mov_b32 v34, v104
  v_mov_b32 v38, v108
  v_mov_b32 v35, v105
  v_mov_b32 v39, v109
  v_mov_b32_dpp v34, v106 row_ror:8 row_mask:0xf bank_mask:0x3
  v_mov_b32_dpp v38, v110 row_ror:8 row_mask:0xf bank_mask:0x3
  v_mov_b32_dpp v35, v107 row_ror:8 row_mask:0xf bank_mask:0x3
  v_mov_b32_dpp v39, v111 row_ror:8 row_mask:0xf bank_mask:0x3
  v_mov_b32_dpp v106, v104 row_ror:8 row_mask:0xf bank_mask:0xc
  v_mov_b32_dpp v110, v108 row_ror:8 row_mask:0xf bank_mask:0xc
  v_mov_b32_dpp v107, v105 row_ror:8 row_mask:0xf bank_mask:0xc
  v_mov_b32_dpp v111, v109 row_ror:8 row_mask:0xf bank_mask:0xc
  v_cvt_pk_bf16_f32 v32, v34, v106
  v_cvt_pk_bf16_f32 v36, v38, v110
  v_cvt_pk_bf16_f32 v33, v35, v107
  v_cvt_pk_bf16_f32 v37, v39, v111
  v_mov_b32 v104, 0
  v_mov_b32 v108, 0
  v_mov_b32 v105, 0
  v_mov_b32 v109, 0
  v_mov_b32 v106, 0
  v_mov_b32 v110, 0
  v_mov_b32 v107, 0
  v_mov_b32 v111, 0
  ds_write_b64 v9, a[72:73] offset:256
  ds_write_b64 v9, a[74:75] offset:4896
  ds_write_b64 v9, a[76:77] offset:384
  ds_write_b64 v9, a[78:79] offset:5024
  v_mov_b32 v42, v112
  v_mov_b32 v46, v116
  v_mov_b32 v43, v113
  v_mov_b32 v47, v117
  v_mov_b32_dpp v42, v114 row_ror:8 row_mask:0xf bank_mask:0x3
  v_mov_b32_dpp v46, v118 row_ror:8 row_mask:0xf bank_mask:0x3
  v_mov_b32_dpp v43, v115 row_ror:8 row_mask:0xf bank_mask:0x3
  v_mov_b32_dpp v47, v119 row_ror:8 row_mask:0xf bank_mask:0x3
  v_mov_b32_dpp v114, v112 row_ror:8 row_mask:0xf bank_mask:0xc
  v_mov_b32_dpp v118, v116 row_ror:8 row_mask:0xf bank_mask:0xc
  v_mov_b32_dpp v115, v113 row_ror:8 row_mask:0xf bank_mask:0xc
  v_mov_b32_dpp v119, v117 row_ror:8 row_mask:0xf bank_mask:0xc
  v_cvt_pk_bf16_f32 v40, v42, v114
  v_cvt_pk_bf16_f32 v44, v46, v118
  v_cvt_pk_bf16_f32 v41, v43, v115
  v_cvt_pk_bf16_f32 v45, v47, v119
  v_mov_b32 v112, 0
  v_mov_b32 v116, 0
  v_mov_b32 v113, 0
  v_mov_b32 v117, 0
  v_mov_b32 v114, 0
  v_mov_b32 v118, 0
  v_mov_b32 v115, 0
  v_mov_b32 v119, 0
  ds_write_b64 v9, a[80:81] offset:512
  ds_write_b64 v9, a[82:83] offset:5152
  ds_write_b64 v9, a[84:85] offset:640
  ds_write_b64 v9, a[86:87] offset:5280
  v_mov_b32 v50, v120
  v_mov_b32 v54, v124
  v_mov_b32 v51, v121
  v_mov_b32 v55, v125
  v_mov_b32_dpp v50, v122 row_ror:8 row_mask:0xf bank_mask:0x3
  v_mov_b32_dpp v54, v126 row_ror:8 row_mask:0xf bank_mask:0x3
  v_mov_b32_dpp v51, v123 row_ror:8 row_mask:0xf bank_mask:0x3
  v_mov_b32_dpp v55, v127 row_ror:8 row_mask:0xf bank_mask:0x3
  v_mov_b32_dpp v122, v120 row_ror:8 row_mask:0xf bank_mask:0xc
  v_mov_b32_dpp v126, v124 row_ror:8 row_mask:0xf bank_mask:0xc
  v_mov_b32_dpp v123, v121 row_ror:8 row_mask:0xf bank_mask:0xc
  v_mov_b32_dpp v127, v125 row_ror:8 row_mask:0xf bank_mask:0xc
  v_cvt_pk_bf16_f32 v48, v50, v122
  v_cvt_pk_bf16_f32 v52, v54, v126
  v_cvt_pk_bf16_f32 v49, v51, v123
  v_cvt_pk_bf16_f32 v53, v55, v127
  v_mov_b32 v120, 0
  v_mov_b32 v124, 0
  v_mov_b32 v121, 0
  v_mov_b32 v125, 0
  v_mov_b32 v122, 0
  v_mov_b32 v126, 0
  v_mov_b32 v123, 0
  v_mov_b32 v127, 0
  ds_write_b64 v9, a[88:89] offset:768
  ds_write_b64 v9, a[90:91] offset:5408
  ds_write_b64 v9, a[92:93] offset:896
  ds_write_b64 v9, a[94:95] offset:5536
  v_mov_b32 v58, v128
  v_mov_b32 v62, v132
  v_mov_b32 v59, v129
  v_mov_b32 v63, v133
  v_mov_b32_dpp v58, v130 row_ror:8 row_mask:0xf bank_mask:0x3
  v_mov_b32_dpp v62, v134 row_ror:8 row_mask:0xf bank_mask:0x3
  v_mov_b32_dpp v59, v131 row_ror:8 row_mask:0xf bank_mask:0x3
  v_mov_b32_dpp v63, v135 row_ror:8 row_mask:0xf bank_mask:0x3
  v_mov_b32_dpp v130, v128 row_ror:8 row_mask:0xf bank_mask:0xc
  v_mov_b32_dpp v134, v132 row_ror:8 row_mask:0xf bank_mask:0xc
  v_mov_b32_dpp v131, v129 row_ror:8 row_mask:0xf bank_mask:0xc
  v_mov_b32_dpp v135, v133 row_ror:8 row_mask:0xf bank_mask:0xc
  v_cvt_pk_bf16_f32 v56, v58, v130
  v_cvt_pk_bf16_f32 v60, v62, v134
  v_cvt_pk_bf16_f32 v57, v59, v131
  v_cvt_pk_bf16_f32 v61, v63, v135
  v_mov_b32 v128, 0
  v_mov_b32 v132, 0
  v_mov_b32 v129, 0
  v_mov_b32 v133, 0
  v_mov_b32 v130, 0
  v_mov_b32 v134, 0
  v_mov_b32 v131, 0
  v_mov_b32 v135, 0
  ds_write_b64 v10, v[32:33] offset:0
  ds_write_b64 v10, v[36:37] offset:640
  ds_write_b64 v10, v[40:41] offset:1280
  ds_write_b64 v10, v[44:45] offset:1920
  ds_write_b64 v10, v[48:49] offset:2560
  ds_write_b64 v10, v[52:53] offset:3200
  ds_write_b64 v10, v[56:57] offset:3840
  ds_write_b64 v10, v[60:61] offset:4480
  v_add_u32 v6, 33792, v6
  v_add_u32 v10, 33792, v10
  s_mov_b32 s60, 1
  s_waitcnt vmcnt(0) lgkmcnt(0)
  s_barrier
  s_branch B_round
B_last:
  s_nop 7
  v_mov_b32 v34, v104
  v_mov_b32 v38, v108
  v_mov_b32 v35, v105
  v_mov_b32 v39, v109
  v_mov_b32_dpp v34, v106 row_ror:8 row_mask:0xf bank_mask:0x3
  v_mov_b32_dpp v38, v110 row_ror:8 row_mask:0xf bank_mask:0x3
  v_mov_b32_dpp v35, v107 row_ror:8 row_mask:0xf bank_mask:0x3
  v_mov_b32_dpp v39, v111 row_ror:8 row_mask:0xf bank_mask:0x3
  v_mov_b32_dpp v106, v104 row_ror:8 row_mask:0xf bank_mask:0xc
  v_mov_b32_dpp v110, v108 row_ror:8 row_mask:0xf bank_mask:0xc
  v_mov_b32_dpp v107, v105 row_ror:8 row_mask:0xf bank_mask:0xc
  v_mov_b32_dpp v111, v109 row_ror:8 row_mask:0xf bank_mask:0xc
  v_cvt_pk_bf16_f32 v32, v34, v106
  v_cvt_pk_bf16_f32 v36, v38, v110
  v_cvt_pk_bf16_f32 v33, v35, v107
  v_cvt_pk_bf16_f32 v37, v39, v111
  v_mov_b32 v42, v112
  v_mov_b32 v46, v116
  v_mov_b32 v43, v113
  v_mov_b32 v47, v117
  v_mov_b32_dpp v42, v114 row_ror:8 row_mask:0xf bank_mask:0x3
  v_mov_b32_dpp v46, v118 row_ror:8 row_mask:0xf bank_mask:0x3
  v_mov_b32_dpp v43, v115 row_ror:8 row_mask:0xf bank_mask:0x3
  v_mov_b32_dpp v47, v119 row_ror:8 row_mask:0xf bank_mask:0x3
  v_mov_b32_dpp v114, v112 row_ror:8 row_mask:0xf bank_mask:0xc
  v_mov_b32_dpp v118, v116 row_ror:8 row_mask:0xf bank_mask:0xc
  v_mov_b32_dpp v115, v113 row_ror:8 row_mask:0xf bank_mask:0xc
  v_mov_b32_dpp v119, v117 row_ror:8 row_mask:0xf bank_mask:0xc
  v_cvt_pk_bf16_f32 v40, v42, v114
  v_cvt_pk_bf16_f32 v44, v46, v118
  v_cvt_pk_bf16_f32 v41, v43, v115
  v_cvt_pk_bf16_f32 v45, v47, v119
  v_mov_b32 v50, v120
  v_mov_b32 v54, v124
  v_mov_b32 v51, v121
  v_mov_b32 v55, v125
  v_mov_b32_dpp v50, v122 row_ror:8 row_mask:0xf bank_mask:0x3
  v_mov_b32_dpp v54, v126 row_ror:8 row_mask:0xf bank_mask:0x3
  v_mov_b32_dpp v51, v123 row_ror:8 row_mask:0xf bank_mask:0x3
  v_mov_b32_dpp v55, v127 row_ror:8 row_mask:0xf bank_mask:0x3
  v_mov_b32_dpp v122, v120 row_ror:8 row_mask:0xf bank_mask:0xc
  v_mov_b32_dpp v126, v124 row_ror:8 row_mask:0xf bank_mask:0xc
  v_mov_b32_dpp v123, v121 row_ror:8 row_mask:0xf bank_mask:0xc
  v_mov_b32_dpp v127, v125 row_ror:8 row_mask:0xf bank_mask:0xc
  v_cvt_pk_bf16_f32 v48, v50, v122
  v_cvt_pk_bf16_f32 v52, v54, v126
  v_cvt_pk_bf16_f32 v49, v51, v123
  v_cvt_pk_bf16_f32 v53, v55, v127
  v_mov_b32 v58, v128
  v_mov_b32 v62, v132
  v_mov_b32 v59, v129
  v_mov_b32 v63, v133
  v_mov_b32_dpp v58, v130 row_ror:8 row_mask:0xf bank_mask:0x3
  v_mov_b32_dpp v62, v134 row_ror:8 row_mask:0xf bank_mask:0x3
  v_mov_b32_dpp v59, v131 row_ror:8 row_mask:0xf bank_mask:0x3
  v_mov_b32_dpp v63, v135 row_ror:8 row_mask:0xf bank_mask:0x3
  v_mov_b32_dpp v130, v128 row_ror:8 row_mask:0xf bank_mask:0xc
  v_mov_b32_dpp v134, v132 row_ror:8 row_mask:0xf bank_mask:0xc
  v_mov_b32_dpp v131, v129 row_ror:8 row_mask:0xf bank_mask:0xc
  v_mov_b32_dpp v135, v133 row_ror:8 row_mask:0xf bank_mask:0xc
  v_cvt_pk_bf16_f32 v56, v58, v130
  v_cvt_pk_bf16_f32 v60, v62, v134
  v_cvt_pk_bf16_f32 v57, v59, v131
  v_cvt_pk_bf16_f32 v61, v63, v135
  ds_write_b64 v10, v[32:33] offset:0
  ds_write_b64 v10, v[36:37] offset:640
  ds_write_b64 v10, v[40:41] offset:1280
  ds_write_b64 v10, v[44:45] offset:1920
  ds_write_b64 v10, v[48:49] offset:2560
  ds_write_b64 v10, v[52:53] offset:3200
  ds_write_b64 v10, v[56:57] offset:3840
  ds_write_b64 v10, v[60:61] offset:4480
  s_waitcnt vmcnt(0)
  s_waitcnt lgkmcnt(0)
  s_barrier
  s_mul_i32 s53, s4, 1280
  s_add_u32 s53, s53, 32784
  v_add_u32 v11, s53, v11
  s_mov_b32 s53, 2560
  v_mul_lo_u32 v28, v0, s53
  s_mul_i32 s54, s4, 1310720
  s_lshl_b32 s55, s5, 4
  s_add_u32 s54, s54, s55
  s_add_u32 s54, s54, 1280
  ds_read_b64_tr_b16 v[136:137], v11 offset:0
  ds_read_b64_tr_b16 v[138:139], v11 offset:33792
  ds_read_b64_tr_b16 v[140:141], v11 offset:160
  ds_read_b64_tr_b16 v[142:143], v11 offset:33952
  ds_read_b64_tr_b16 v[144:145], v11 offset:320
  ds_read_b64_tr_b16 v[146:147], v11 offset:34112
  ds_read_b64_tr_b16 v[148:149], v11 offset:480
  ds_read_b64_tr_b16 v[150:151], v11 offset:34272
  ds_read_b64_tr_b16 v[152:153], v11 offset:640
  ds_read_b64_tr_b16 v[154:155], v11 offset:34432
  ds_read_b64_tr_b16 v[156:157], v11 offset:800
  ds_read_b64_tr_b16 v[158:159], v11 offset:34592
  ds_read_b64_tr_b16 v[160:161], v11 offset:960
  ds_read_b64_tr_b16 v[162:163], v11 offset:34752
  ds_read_b64_tr_b16 v[164:165], v11 offset:1120
  ds_read_b64_tr_b16 v[166:167], v11 offset:34912
  s_waitcnt lgkmcnt(0)
  s_barrier
  buffer_store_dwordx4 v[136:139], v28, s[48:51], s54 offen
  s_add_u32 s54, s54, 163840
  buffer_store_dwordx4 v[140:143], v28, s[48:51], s54 offen
  s_add_u32 s54, s54, 163840
  buffer_store_dwordx4 v[144:147], v28, s[48:51], s54 offen
  s_add_u32 s54, s54, 163840
  buffer_store_dwordx4 v[148:151], v28, s[48:51], s54 offen
  s_add_u32 s54, s54, 163840
  buffer_store_dwordx4 v[152:155], v28, s[48:51], s54 offen
  s_add_u32 s54, s54, 163840
  buffer_store_dwordx4 v[156:159], v28, s[48:51], s54 offen
  s_add_u32 s54, s54, 163840
  buffer_store_dwordx4 v[160:163], v28, s[48:51], s54 offen
  s_add_u32 s54, s54, 163840
  buffer_store_dwordx4 v[164:167], v28, s[48:51], s54 offen
  s_cmp_lg_u32 s4, 0
  s_cbranch_scc1 B_end
  v_readfirstlane_b32 s54, v208
  s_nop 0
  s_cmp_lg_u32 s54, 255
  s_cbranch_scc1 B_end
  v_mov_b32 v208, s14
  v_mov_b32 v209, 0
  s_mov_b64 exec, 1
  global_store_dword v209, v208, s[42:43] sc1
B_end:
  s_endpgm
L_join:
  s_cmp_ge_u32 s8, 6
  s_cselect_b32 s9, 8, 0
  s_sub_u32 s9, s12, s9
  s_lshr_b32 s5, s8, 1
  s_lshl_b32 s5, s5, 2
  s_and_b32 s71, s9, 3
  s_add_u32 s5, s5, s71
  s_and_b32 s10, s8, 1
  s_lshl_b32 s10, s10, 2
  s_lshr_b32 s9, s9, 2
  s_add_u32 s10, s10, s9
  s_mov_b32 s52, s42
  s_mov_b32 s53, s43
  s_mov_b32 s54, 268435456
  s_mov_b32 s55, 0x20000
  s_mov_b32 s56, s38
  s_mov_b32 s57, s39
  s_mov_b32 s58, 5242880
  s_mov_b32 s59, 0x20000
  s_mov_b32 s64, s22
  s_mov_b32 s65, s23
  s_mov_b32 s66, 819200
  s_mov_b32 s67, 0x20000
  v_add_u32 v19, 0, v0
  v_mul_u32_u24 v20, 6554, v19
  v_lshrrev_b32 v20, 16, v20
  v_mul_u32_u24 v21, 1120, v20
  v_lshl_add_u32 v252, v19, 4, v21
  v_add_u32 v19, 64, v0
  v_mul_u32_u24 v20, 6554, v19
  v_lshrrev_b32 v20, 16, v20
  v_mul_u32_u24 v21, 1120, v20
  v_lshl_add_u32 v253, v0, 4, v21
  v_add_u32 v19, 128, v0
  v_mul_u32_u24 v20, 6554, v19
  v_lshrrev_b32 v20, 16, v20
  v_mul_u32_u24 v21, 1120, v20
  v_lshl_add_u32 v254, v0, 4, v21
  v_add_u32 v19, 192, v0
  v_mul_u32_u24 v20, 6554, v19
  v_lshrrev_b32 v20, 16, v20
  v_mul_u32_u24 v21, 1120, v20
  v_lshl_add_u32 v255, v0, 4, v21
  v_add_u32 v19, 256, v0
  v_mul_u32_u24 v20, 6554, v19
  v_lshrrev_b32 v20, 16, v20
  v_mul_u32_u24 v21, 1120, v20
  v_lshl_add_u32 v26, v19, 4, v21
  s_mul_i32 s3, s4, 5120
  s_mul_i32 s6, s4, 40960
  s_mul_i32 s71, s10, 160
  s_add_u32 s6, s6, s71
  s_add_u32 m0, s3, 0
  s_add_u32 s7, s6, 0
  buffer_load_dwordx4 v252, s[64:67], s7 offen offset:0 lds
  buffer_load_dwordx4 v253, s[64:67], s7 offen offset:1024 lds
  buffer_load_dwordx4 v254, s[64:67], s7 offen offset:2048 lds
  buffer_load_dwordx4 v255, s[64:67], s7 offen offset:3072 lds
  s_addk_i32 m0, 0x1000
  s_nop 0
  buffer_load_dwordx4 v26, s[64:67], s7 offen offset:0 lds
  s_add_u32 m0, s3, 20480
  s_add_u32 s7, s6, 163840
  buffer_load_dwordx4 v252, s[64:67], s7 offen offset:0 lds
  buffer_load_dwordx4 v253, s[64:67], s7 offen offset:1024 lds
  buffer_load_dwordx4 v254, s[64:67], s7 offen offset:2048 lds
  buffer_load_dwordx4 v255, s[64:67], s7 offen offset:3072 lds
  s_addk_i32 m0, 0x1000
  s_nop 0
  buffer_load_dwordx4 v26, s[64:67], s7 offen offset:0 lds
  s_add_u32 m0, s3, 40960
  s_add_u32 s7, s6, 327680
  buffer_load_dwordx4 v252, s[64:67], s7 offen offset:0 lds
  buffer_load_dwordx4 v253, s[64:67], s7 offen offset:1024 lds
  buffer_load_dwordx4 v254, s[64:67], s7 offen offset:2048 lds
  buffer_load_dwordx4 v255, s[64:67], s7 offen offset:3072 lds
  s_addk_i32 m0, 0x1000
  s_nop 0
  buffer_load_dwordx4 v26, s[64:67], s7 offen offset:0 lds
  s_add_u32 m0, s3, 61440
  s_add_u32 s7, s6, 491520
  buffer_load_dwordx4 v252, s[64:67], s7 offen offset:0 lds
  buffer_load_dwordx4 v253, s[64:67], s7 offen offset:1024 lds
  buffer_load_dwordx4 v254, s[64:67], s7 offen offset:2048 lds
  buffer_load_dwordx4 v255, s[64:67], s7 offen offset:3072 lds
  s_addk_i32 m0, 0x1000
  s_nop 0
  buffer_load_dwordx4 v26, s[64:67], s7 offen offset:0 lds
  s_add_u32 m0, s3, 81920
  s_add_u32 s7, s6, 655360
  buffer_load_dwordx4 v252, s[64:67], s7 offen offset:0 lds
  buffer_load_dwordx4 v253, s[64:67], s7 offen offset:1024 lds
  buffer_load_dwordx4 v254, s[64:67], s7 offen offset:2048 lds
  buffer_load_dwordx4 v255, s[64:67], s7 offen offset:3072 lds
  s_addk_i32 m0, 0x1000
  s_nop 0
  buffer_load_dwordx4 v26, s[64:67], s7 offen offset:0 lds
  s_mov_b32 s15, 1
  s_mov_b32 s13, 0
  s_waitcnt vmcnt(0)
  s_barrier
  s_branch A3_entry
L_end:
  s_endpgm
.p2align 8
TABLES:
.long 0, 528, 1056, 1584, 4224, 4224, 4752, 5280, 2112, 2640, 3168, 3696, 5280, 5280, 5808, 6336, 36432, 36960, 0, 37488, 6864, 7392, 7920, 33792, 38016, 0, 38544, 39072, 34320, 34848, 35376, 35904, 16, 544, 1072, 1600, 4240, 4240, 4768, 5296, 2128, 2656, 3184, 3712, 5296, 5296, 5824, 6352, 36448, 36976, 16, 37504, 6880, 7408, 7936, 33808, 38032, 16, 38560, 39088, 34336, 34864, 35392, 35920
.long 0, 528, 1056, 1584, 2112, 2640, 3168, 3696, 4224, 4752, 5280, 5808, 6336, 6864, 7392, 7920, 33792, 34320, 34848, 35376, 35904, 36432, 36960, 37488, 38016, 38544, 39072, 39600, 40128, 40656, 41184, 41712, 16, 544, 1072, 1600, 2128, 2656, 3184, 3712, 4240, 4768, 5296, 5824, 6352, 6880, 7408, 7936, 33808, 34336, 34864, 35392, 35920, 36448, 36976, 37504, 38032, 38560, 39088, 39616, 40144, 40672, 41200, 41728
.long 4080, 4064, 4048, 4032, 4016, 4000, 3984, 3968, 3952, 3936, 3920, 3904, 3888, 3872, 3856, 3840, 3824, 3808, 3792, 3776, 3760, 3744, 3728, 3712, 3696, 3680, 3664, 3648, 3632, 3616, 3600, 3584, 3568, 3552, 3536, 3520, 3504, 3488, 3472, 3456, 3440, 3424, 3408, 3392, 3376, 3360, 3344, 3328, 3312, 3296, 3280, 3264, 3248, 3232, 3216, 3200, 3184, 3168, 3152, 3136, 3120, 3104, 3088, 3072
.long 496, 480, 464, 448, 432, 416, 400, 384, 368, 352, 336, 320, 304, 288, 272, 256, 240, 224, 208, 192, 176, 160, 144, 128, 112, 96, 80, 64, 48, 32, 16, 0, 2032, 2016, 2000, 1984, 1968, 1952, 1936, 1920, 1904, 1888, 1872, 1856, 1840, 1824, 1808, 1792, 1776, 1760, 1744, 1728, 1712, 1696, 1680, 1664, 1648, 1632, 1616, 1600, 1584, 1568, 1552, 1536
.long 4728, 504, 4720, 496, 4712, 488, 4704, 480, 4696, 472, 4688, 464, 4680, 456, 4672, 448, 4744, 520, 4736, 512, 4728, 504, 4720, 496, 4712, 488, 4704, 480, 4696, 472, 4688, 464, 4760, 536, 4752, 528, 4744, 520, 4736, 512, 4728, 504, 4720, 496, 4712, 488, 4704, 480, 4776, 552, 4768, 544, 4760, 536, 4752, 528, 4744, 520, 4736, 512, 4728, 504, 4720, 496
.long 448, 512, 576, 640, 704, 768, 832, 896, 5088, 5152, 5216, 5280, 5344, 5408, 5472, 5536, 464, 528, 592, 656, 720, 784, 848, 912, 5104, 5168, 5232, 5296, 5360, 5424, 5488, 5552, 480, 544, 608, 672, 736, 800, 864, 928, 5120, 5184, 5248, 5312, 5376, 5440, 5504, 5568, 496, 560, 624, 688, 752, 816, 880, 944, 5136, 5200, 5264, 5328, 5392, 5456, 5520, 5584
.long 0, 64, 128, 192, 16, 80, 144, 208, 32, 96, 160, 224, 48, 112, 176, 240, 256, 320, 384, 448, 272, 336, 400, 464, 288, 352, 416, 480, 304, 368, 432, 496, 512, 576, 640, 704, 528, 592, 656, 720, 544, 608, 672, 736, 560, 624, 688, 752, 768, 832, 896, 960, 784, 848, 912, 976, 800, 864, 928, 992, 816, 880, 944, 1008
.long 448, 9824, 19200, 28576, 456, 9832, 19208, 28584, 464, 9840, 19216, 28592, 472, 9848, 19224, 28600, 480, 9856, 19232, 28608, 488, 9864, 19240, 28616, 496, 9872, 19248, 28624, 504, 9880, 19256, 28632, 512, 9888, 19264, 28640, 520, 9896, 19272, 28648, 528, 9904, 19280, 28656, 536, 9912, 19288, 28664, 544, 9920, 19296, 28672, 552, 9928, 19304, 28680, 560, 9936, 19312, 28688, 568, 9944, 19320, 28696
.long 8, 88, 168, 248, 328, 408, 488, 568, 0, 80, 160, 240, 320, 400, 480, 560, 24, 104, 184, 264, 344, 424, 504, 584, 16, 96, 176, 256, 336, 416, 496, 576, 40, 120, 200, 280, 360, 440, 520, 600, 32, 112, 192, 272, 352, 432, 512, 592, 56, 136, 216, 296, 376, 456, 536, 616, 48, 128, 208, 288, 368, 448, 528, 608
.long 0, 8, 16, 24, 8512, 8520, 8528, 8536, 17024, 17032, 17040, 17048, 25536, 25544, 25552, 25560, 32, 40, 48, 56, 8544, 8552, 8560, 8568, 17056, 17064, 17072, 17080, 25568, 25576, 25584, 25592, 80, 88, 96, 104, 8592, 8600, 8608, 8616, 17104, 17112, 17120, 17128, 25616, 25624, 25632, 25640, 112, 120, 128, 136, 8624, 8632, 8640, 8648, 17136, 17144, 17152, 17160, 25648, 25656, 25664, 25672
.long 4096, 4112, 4128, 4144, 4160, 4176, 4192, 4208, 8304, 8320, 8336, 8352, 8368, 8384, 8400, 8416, 8432, 8448, 8464, 8480, 8496, 8512, 8528, 8544, 8560, 8576, 8592, 8608, 8624, 8640, 8656, 8672, 8688, 8704, 8720, 8736, 8752, 8768, 8784, 8800, 8816, 8832, 8848, 8864, 8880, 8896, 8912, 8928, 8944, 8960, 8976, 8992, 9008, 9024, 9040, 9056, 9072, 9088, 9104, 9120, 9136, 9152, 9168, 9184
TABLE_A:
.long 154624, 154632, 154640, 154648, 155008, 155016, 155024, 155032, 155392, 155400, 155408, 155416, 155776, 155784, 155792, 155800, 154720, 154728, 154736, 154744, 155104, 155112, 155120, 155128, 155488, 155496, 155504, 155512, 155872, 155880, 155888, 155896, 154816, 154824, 154832, 154840, 155200, 155208, 155216, 155224, 155584, 155592, 155600, 155608, 155968, 155976, 155984, 155992, 154912, 154920, 154928, 154936, 155296, 155304, 155312, 155320, 155680, 155688, 155696, 155704, 156064, 156072, 156080, 156088
.long 154656, 154664, 154672, 154680, 155040, 155048, 155056, 155064, 155424, 155432, 155440, 155448, 155808, 155816, 155824, 155832, 154752, 154760, 154768, 154776, 155136, 155144, 155152, 155160, 155520, 155528, 155536, 155544, 155904, 155912, 155920, 155928, 154848, 154856, 154864, 154872, 155232, 155240, 155248, 155256, 155616, 155624, 155632, 155640, 156000, 156008, 156016, 156024, 154944, 154952, 154960, 154968, 155328, 155336, 155344, 155352, 155712, 155720, 155728, 155736, 156096, 156104, 156112, 156120
.long 154688, 154696, 154784, 154792, 155072, 155080, 155168, 155176, 155456, 155464, 155552, 155560, 155840, 155848, 155936, 155944, 154880, 154888, 154976, 154984, 155264, 155272, 155360, 155368, 155648, 155656, 155744, 155752, 156032, 156040, 156128, 156136, 156160, 156168, 156176, 156184, 156544, 156552, 156560, 156568, 156256, 156264, 156272, 156280, 156352, 156360, 156368, 156376, 156192, 156200, 156208, 156216, 156576, 156584, 156592, 156600, 156288, 156296, 156304, 156312, 156384, 156392, 156400, 156408
.long 156224, 156232, 156240, 156248, 156608, 156616, 156624, 156632, 156320, 156328, 156336, 156344, 156416, 156424, 156432, 156440, 156448, 156456, 156464, 156472, 156480, 156488, 156496, 156504, 156512, 156520, 156528, 156536, 156736, 156744, 156752, 156760, 156736, 156744, 156752, 156760, 156736, 156744, 156752, 156760, 156736, 156744, 156752, 156760, 156736, 156744, 156752, 156760, 156736, 156744, 156752, 156760, 156736, 156744, 156752, 156760, 156736, 156744, 156752, 156760, 156736, 156744, 156752, 156760
.section .rodata,"a"
.p2align 6
.amdhsa_kernel concat_heads__linear_kernel_hedgehog__ssm_conv_s4d__prompt_kernel
  .amdhsa_next_free_vgpr 512
  .amdhsa_next_free_sgpr 102
  .amdhsa_accum_offset 256
  .amdhsa_group_segment_fixed_size 0
  .amdhsa_kernarg_size 112
  .amdhsa_user_sgpr_count 2
  .amdhsa_user_sgpr_kernarg_segment_ptr 1
  .amdhsa_system_sgpr_workgroup_id_x 1
.end_amdhsa_kernel
```
